```python
import torch

def _softmax(x, axis=-1):
    return torch.softmax(x, dim=axis)
def _gelu(x):
    return torch.nn.functional.gelu(x, approximate="tanh")
def _silu(x):
    return torch.nn.functional.silu(x)
def _sigmoid(x):
    return torch.sigmoid(x)
def _layernorm(x, axis=-1, eps=1e-5):
    m = x.mean(dim=axis, keepdim=True)
    v = x.var(dim=axis, keepdim=True, unbiased=False)
    return (x - m) / torch.sqrt(v + eps)
def _scatter_add(tgt, idx, src, axis=0):
    return tgt.clone().index_add_(axis, idx, src)
def _segment_sum(src, seg, n):
    out = torch.zeros((n,) + src.shape[1:], dtype=src.dtype)
    return out.index_add_(0, seg, src)
def _pad(x, pw):
    flat = tuple(v for pair in reversed(pw) for v in pair)
    return torch.nn.functional.pad(x, flat)

kernel_name = 'concat_heads__gqa_block_cached__mha_block_cached__near_ridge'

def setup_inputs():

    _w = (lambda a: (lambda t: t.to(torch.bfloat16) if t.is_floating_point() else t)(torch.as_tensor(a)))
    def _A_setup():
        B, Sq, D = 32, 48, 512
        Hq, Hkv, Sk, Dh = 32, 8, 512, 128
        assert Hq % Hkv == 0, (Hq, Hkv)
        return {
            "x": _w((lambda *s: torch.randn(*s, dtype=torch.bfloat16) * 0.8)(B, Sq, D)),
            "k_cache": _w((lambda *s: torch.randn(*s, dtype=torch.bfloat16) * 0.8)(B, Hkv, Sk, Dh)),
            "v_cache": _w((lambda *s: torch.randn(*s, dtype=torch.bfloat16) * 0.05)(B, Hkv, Sk, Dh)),
            "wq": _w((lambda *s: torch.randn(*s, dtype=torch.bfloat16) * 0.8)(D, Hq * Dh) * (D ** -0.5)),
            "wo": _w((lambda *s: torch.randn(*s, dtype=torch.bfloat16) * 0.05)(Hq * Dh, D) * ((Hq * Dh) ** -0.5)),
        }
    _A_in = _A_setup()

    def _B_setup():
        B, Sq, D = 32, 48, 512
        H, Sk, Dh = 32, 512, 128
        return {
            "x": _w((lambda *s: torch.randn(*s, dtype=torch.bfloat16) * 0.8)(B, Sq, D)),
            "k_cache": _w((lambda *s: torch.randn(*s, dtype=torch.bfloat16) * 0.8)(B, H, Sk, Dh)),
            "v_cache": _w((lambda *s: torch.randn(*s, dtype=torch.bfloat16) * 0.05)(B, H, Sk, Dh)),
            "wq": _w((lambda *s: torch.randn(*s, dtype=torch.bfloat16) * 0.8)(D, H * Dh) * (D ** -0.5)),
            "wo": _w((lambda *s: torch.randn(*s, dtype=torch.bfloat16) * 0.05)(H * Dh, D) * ((H * Dh) ** -0.5)),
        }
    _B_in = _B_setup()

    return {
        "A_x": _A_in["x"],
        "A_k_cache": _A_in["k_cache"],
        "A_v_cache": _A_in["v_cache"],
        "A_wq": _A_in["wq"],
        "A_wo": _A_in["wo"],
        "B_x": _B_in["x"],
        "B_k_cache": _B_in["k_cache"],
        "B_v_cache": _B_in["v_cache"],
        "B_wq": _B_in["wq"],
        "B_wo": _B_in["wo"],
    }

def reference(A_x, A_k_cache, A_v_cache, A_wq, A_wo, B_x, B_k_cache, B_v_cache, B_wq, B_wo):
    def _A_ref(x, k_cache, v_cache, wq, wo):
        B, Sq, D = x.shape
        Hq, Dh = 32, 128
        Hkv = k_cache.shape[1]
        rep = Hq // Hkv
        q = (lambda x, *d: x.permute(*d))((x @ wq).reshape(B, Sq, Hq, Dh), 0, 2, 1, 3)
        k = (lambda x, n, axis: torch.repeat_interleave(x, n, dim=axis))(k_cache, rep, axis=1)
        v = (lambda x, n, axis: torch.repeat_interleave(x, n, dim=axis))(v_cache, rep, axis=1)
        scores = torch.einsum("bhqd,bhkd->bhqk", q, k) * (Dh ** -0.5)
        p = _softmax(scores, axis=-1)
        o = torch.einsum("bhqk,bhkd->bhqd", p, v)
        return (lambda x, *d: x.permute(*d))(o, 0, 2, 1, 3).reshape(B, Sq, Hq * Dh) @ wo

    def _B_ref(x, k_cache, v_cache, wq, wo):
        B, Sq, D = x.shape
        H, Dh = 32, 128
        q = (lambda x, *d: x.permute(*d))((x @ wq).reshape(B, Sq, H, Dh), 0, 2, 1, 3)
        scores = torch.einsum("bhqd,bhkd->bhqk", q, k_cache) * (Dh ** -0.5)
        p = _softmax(scores, axis=-1)
        o = torch.einsum("bhqk,bhkd->bhqd", p, v_cache)
        return (lambda x, *d: x.permute(*d))(o, 0, 2, 1, 3).reshape(B, Sq, H * Dh) @ wo

    a = _A_ref(A_x, A_k_cache, A_v_cache, A_wq, A_wo)
    b = _B_ref(B_x, B_k_cache, B_v_cache, B_wq, B_wo)
    return torch.concatenate([a, b], axis=-1)
```

```asm
; @launch grid=(256,1,1) block=(512,1,1) lds=163840
.amdgcn_target "amdgcn-amd-amdhsa--gfx950"
.text
.globl concat_heads__gqa_block_cached__mha_block_cached__near_ridge_kernel
.p2align 8
.type concat_heads__gqa_block_cached__mha_block_cached__near_ridge_kernel,@function
concat_heads__gqa_block_cached__mha_block_cached__near_ridge_kernel:
    s_cmp_lt_u32 s2, 256
    s_cbranch_scc1 L_start
    s_endpgm
L_start:
    s_load_dwordx16 s[36:51], s[0:1], 0
    s_load_dwordx8 s[52:59], s[0:1], 64
    s_load_dwordx2 s[60:61], s[0:1], 96
    s_getpc_b64 s[78:79]
L_pc:
    s_sub_u32 s78, s78, L_pc-concat_heads__gqa_block_cached__mha_block_cached__near_ridge_kernel
    s_subb_u32 s79, s79, 0
    s_lshr_b32 s65, s2, 3
    s_lshl_b32 s65, s65, 4
    s_sub_u32 s65, s65, 448
    v_add_u32 v30, s65, v0
    v_lshlrev_b32 v30, 7, v30
    v_and_b32 v31, 0x1f0, v0
    v_cmp_eq_u32 vcc, 0x1c0, v31
    s_mov_b64 s[80:81], vcc
    v_cmp_gt_u32 vcc, L_code_end-concat_heads__gqa_block_cached__mha_block_cached__near_ridge_kernel, v30
    s_and_b64 exec, vcc, s[80:81]
    s_cbranch_execz L_nopf
    global_load_dword v31, v30, s[78:79]
L_nopf:
    s_mov_b64 exec, -1
    v_lshrrev_b32 v14, 6, v0
    s_nop 0
    v_readfirstlane_b32 s3, v14
    v_and_b32 v0, 63, v0
    s_lshr_b32 s4, s2, 3
    s_and_b32 s5, s2, 7
    s_and_b32 s6, s3, 3
    v_lshrrev_b32 v14, 4, v0
    v_and_b32 v15, 15, v0
    v_lshlrev_b32 v1, 4, v0
    v_bfe_u32 v16, v0, 2, 3
    v_mul_u32_u24 v2, 1056, v16
    v_lshrrev_b32 v16, 5, v0
    v_lshlrev_b32 v16, 9, v16
    v_add_u32 v2, v2, v16
    v_and_b32 v16, 3, v0
    v_lshlrev_b32 v16, 3, v16
    v_add_u32 v2, v2, v16
    v_lshrrev_b32 v16, 3, v15
    v_and_b32 v17, 3, v15
    v_lshl_add_u32 v17, v16, 2, v17
    v_mul_u32_u24 v3, 1056, v17
    v_bfe_u32 v17, v15, 2, 1
    v_xor_b32 v17, v17, v16
    v_lshlrev_b32 v17, 8, v17
    v_add_u32 v3, v3, v17
    v_lshl_add_u32 v3, v14, 4, v3
    v_and_b32 v16, 6, v15
    v_xor_b32 v16, v16, v14
    v_lshlrev_b32 v16, 4, v16
    v_lshl_add_u32 v245, v15, 7, v16
    v_lshrrev_b32 v16, 3, v0
    v_and_b32 v17, 6, v16
    v_and_b32 v18, 7, v0
    v_xor_b32 v17, v17, v18
    v_lshlrev_b32 v17, 4, v17
    v_lshl_add_u32 v246, v16, 10, v17
    v_and_b32 v16, 1, v14
    v_lshrrev_b32 v17, 1, v14
    v_lshlrev_b32 v18, 4, v15
    v_lshlrev_b32 v19, 12, v17
    v_add_u32 v19, v19, v18
    v_lshl_add_u32 v4, v16, 10, v19
    v_lshlrev_b32 v20, 10, v16
    v_sub_u32 v20, 2048, v20
    v_add_u32 v5, v19, v20
    v_lshlrev_b32 v19, 4, v16
    v_lshl_add_u32 v19, v17, 3, v19
    v_lshl_add_u32 v6, v19, 8, v18
    v_lshl_add_u32 v7, v19, 10, v18
    v_lshlrev_b32 v19, 2, v16
    v_lshl_add_u32 v19, v17, 4, v19
    v_lshl_add_u32 v19, v19, 13, v18
    v_add_u32 v184, 0, v19
    v_add_u32 v185, 7136, v19
    v_add_u32 v186, 14272, v19
    v_add_u32 v187, 21408, v19
    v_add_u32 v188, 65536, v19
    v_add_u32 v189, 72672, v19
    v_add_u32 v190, 79808, v19
    v_add_u32 v191, 86944, v19
    s_mov_b32 s88, 0x3e0293ee
    s_add_u32 s86, s4, s5
    s_and_b32 s86, s86, 7
    s_bfe_u32 s82, s4, 0x10003
    s_xor_b32 s83, s82, 1
    s_mul_i32 s71, s4, 49152
    s_lshl_b32 s65, s5, 2
    s_add_u32 s65, s65, s6
    s_lshl_b32 s69, s65, 8
    s_and_b32 s66, s6, 1
    s_mul_i32 s66, s66, 16896
    s_add_u32 s75, s66, 130048
    s_add_u32 s76, s66, 28672
    s_waitcnt lgkmcnt(0)
    s_cmp_ge_u32 s3, 4
    s_cselect_b32 s20, s42, s52
    s_cselect_b32 s21, s43, s53
    s_mov_b32 s22, 0x400000
    s_mov_b32 s23, 0x20000
    s_cselect_b32 s8, s36, s46
    s_cselect_b32 s9, s37, s47
    s_mov_b32 s10, 0x180000
    s_mov_b32 s11, 0x20000
    s_cselect_b32 s24, s44, s54
    s_cselect_b32 s25, s45, s55
    s_mov_b32 s26, 0x400000
    s_mov_b32 s27, 0x20000
    s_mov_b32 s12, s48
    s_mov_b32 s13, s49
    s_mov_b32 s14, 0x8000000
    s_mov_b32 s15, 0x20000
    s_mov_b32 s16, s50
    s_mov_b32 s17, s51
    s_mov_b32 s18, 0x8000000
    s_mov_b32 s19, 0x20000
    s_mov_b32 s28, s60
    s_mov_b32 s29, s61
    s_mov_b32 s30, 0x20000000
    s_mov_b32 s31, 0x20000
    s_mov_b32 s32, s40
    s_mov_b32 s33, s41
    s_mov_b32 s34, 0x2000000
    s_mov_b32 s35, 0x20000
    s_cmp_ge_u32 s3, 4
    s_cbranch_scc1 L_A
    s_cmp_ge_u32 s3, 2
    s_cbranch_scc1 L_G1
    s_mul_i32 s65, s6, 24576
    s_add_u32 s71, s71, s65
    s_mul_i32 s87, s6, 3072
    s_mov_b32 s72, s86
    s_mov_b32 s7, s75
    s_add_u32 s62, s76, 67584
    s_add_u32 s63, s75, 8448
    s_add_u32 s64, s72, 0
    s_and_b32 s64, s64, 7
    s_lshl_b32 s64, s64, 1
    s_add_u32 s64, s64, s82
    s_lshl_b32 s64, s64, 18
    s_add_u32 s64, s64, s69
    s_add_u32 m0, s7, 0
    s_nop 0
    buffer_load_dwordx4 v184, s[20:23], s64 offen offset:0 lds
    buffer_load_dwordx4 v185, s[20:23], s64 offen offset:1056 lds
    buffer_load_dwordx4 v186, s[20:23], s64 offen offset:2112 lds
    buffer_load_dwordx4 v187, s[20:23], s64 offen offset:3168 lds
    s_add_u32 m0, s7, 4224
    s_nop 0
    buffer_load_dwordx4 v188, s[20:23], s64 offen offset:0 lds
    buffer_load_dwordx4 v189, s[20:23], s64 offen offset:1056 lds
    buffer_load_dwordx4 v190, s[20:23], s64 offen offset:2112 lds
    buffer_load_dwordx4 v191, s[20:23], s64 offen offset:3168 lds
    s_add_u32 s73, s72, 0
    s_and_b32 s73, s73, 7
    s_lshl_b32 s67, s73, 7
    s_add_u32 s67, s67, s71
    s_add_u32 m0, s87, 0
    s_add_u32 s67, s67, 0
    buffer_load_dwordx4 v246, s[8:11], s67 offen lds
    s_lshl_b32 s67, s73, 7
    s_add_u32 s67, s67, s71
    s_add_u32 m0, s87, 1024
    s_add_u32 s67, s67, 8192
    buffer_load_dwordx4 v246, s[8:11], s67 offen lds
    s_lshl_b32 s67, s73, 7
    s_add_u32 s67, s67, s71
    s_add_u32 m0, s87, 2048
    s_add_u32 s67, s67, 16384
    buffer_load_dwordx4 v246, s[8:11], s67 offen lds
    v_mov_b32 v8, 0
    v_mov_b32 v9, 0
    v_mov_b32 v10, 0
    v_mov_b32 v11, 0
    v_mov_b32 v12, 0
    v_mov_b32 v13, 0
    v_mov_b32 v14, 0
    v_mov_b32 v15, 0
    v_mov_b32 v16, 0
    v_mov_b32 v17, 0
    v_mov_b32 v18, 0
    v_mov_b32 v19, 0
    v_mov_b32 v20, 0
    v_mov_b32 v21, 0
    v_mov_b32 v22, 0
    v_mov_b32 v23, 0
    v_mov_b32 v24, 0
    v_mov_b32 v25, 0
    v_mov_b32 v26, 0
    v_mov_b32 v27, 0
    v_mov_b32 v28, 0
    v_mov_b32 v29, 0
    v_mov_b32 v30, 0
    v_mov_b32 v31, 0
    v_mov_b32 v32, 0
    v_mov_b32 v33, 0
    v_mov_b32 v34, 0
    v_mov_b32 v35, 0
    v_mov_b32 v36, 0
    v_mov_b32 v37, 0
    v_mov_b32 v38, 0
    v_mov_b32 v39, 0
    v_mov_b32 v40, 0
    v_mov_b32 v41, 0
    v_mov_b32 v42, 0
    v_mov_b32 v43, 0
    v_mov_b32 v44, 0
    v_mov_b32 v45, 0
    v_mov_b32 v46, 0
    v_mov_b32 v47, 0
    v_mov_b32 v48, 0
    v_mov_b32 v49, 0
    v_mov_b32 v50, 0
    v_mov_b32 v51, 0
    v_mov_b32 v52, 0
    v_mov_b32 v53, 0
    v_mov_b32 v54, 0
    v_mov_b32 v55, 0
    v_mov_b32 v56, 0
    v_mov_b32 v57, 0
    v_mov_b32 v58, 0
    v_mov_b32 v59, 0
    v_mov_b32 v60, 0
    v_mov_b32 v61, 0
    v_mov_b32 v62, 0
    v_mov_b32 v63, 0
    v_mov_b32 v64, 0
    v_mov_b32 v65, 0
    v_mov_b32 v66, 0
    v_mov_b32 v67, 0
    v_mov_b32 v68, 0
    v_mov_b32 v69, 0
    v_mov_b32 v70, 0
    v_mov_b32 v71, 0
    v_mov_b32 v72, 0
    v_mov_b32 v73, 0
    v_mov_b32 v74, 0
    v_mov_b32 v75, 0
    v_mov_b32 v76, 0
    v_mov_b32 v77, 0
    v_mov_b32 v78, 0
    v_mov_b32 v79, 0
    v_mov_b32 v80, 0
    v_mov_b32 v81, 0
    v_mov_b32 v82, 0
    v_mov_b32 v83, 0
    v_mov_b32 v84, 0
    v_mov_b32 v85, 0
    v_mov_b32 v86, 0
    v_mov_b32 v87, 0
    v_mov_b32 v88, 0
    v_mov_b32 v89, 0
    v_mov_b32 v90, 0
    v_mov_b32 v91, 0
    v_mov_b32 v92, 0
    v_mov_b32 v93, 0
    v_mov_b32 v94, 0
    v_mov_b32 v95, 0
    v_mov_b32 v96, 0
    v_mov_b32 v97, 0
    v_mov_b32 v98, 0
    v_mov_b32 v99, 0
    v_mov_b32 v100, 0
    v_mov_b32 v101, 0
    v_mov_b32 v102, 0
    v_mov_b32 v103, 0
    s_add_u32 s64, s72, 0
    s_and_b32 s64, s64, 7
    s_lshl_b32 s64, s64, 1
    s_add_u32 s64, s64, s83
    s_lshl_b32 s64, s64, 18
    s_add_u32 s64, s64, s69
    s_add_u32 m0, s62, 0
    s_nop 0
    buffer_load_dwordx4 v184, s[20:23], s64 offen offset:0 lds
    buffer_load_dwordx4 v185, s[20:23], s64 offen offset:1056 lds
    buffer_load_dwordx4 v186, s[20:23], s64 offen offset:2112 lds
    buffer_load_dwordx4 v187, s[20:23], s64 offen offset:3168 lds
    s_add_u32 m0, s62, 4224
    s_nop 0
    buffer_load_dwordx4 v188, s[20:23], s64 offen offset:0 lds
    buffer_load_dwordx4 v189, s[20:23], s64 offen offset:1056 lds
    buffer_load_dwordx4 v190, s[20:23], s64 offen offset:2112 lds
    buffer_load_dwordx4 v191, s[20:23], s64 offen offset:3168 lds
    s_add_u32 s73, s72, 1
    s_and_b32 s73, s73, 7
    s_lshl_b32 s67, s73, 7
    s_add_u32 s67, s67, s71
    s_add_u32 m0, s87, 6144
    s_add_u32 s67, s67, 0
    buffer_load_dwordx4 v246, s[8:11], s67 offen lds
    s_lshl_b32 s67, s73, 7
    s_add_u32 s67, s67, s71
    s_add_u32 m0, s87, 7168
    s_add_u32 s67, s67, 8192
    buffer_load_dwordx4 v246, s[8:11], s67 offen lds
    s_lshl_b32 s67, s73, 7
    s_add_u32 s67, s67, s71
    s_add_u32 m0, s87, 8192
    s_add_u32 s67, s67, 16384
    buffer_load_dwordx4 v246, s[8:11], s67 offen lds
    s_add_u32 s64, s72, 1
    s_and_b32 s64, s64, 7
    s_lshl_b32 s64, s64, 1
    s_add_u32 s64, s64, s82
    s_lshl_b32 s64, s64, 18
    s_add_u32 s64, s64, s69
    s_add_u32 m0, s63, 0
    s_nop 0
    buffer_load_dwordx4 v184, s[20:23], s64 offen offset:0 lds
    buffer_load_dwordx4 v185, s[20:23], s64 offen offset:1056 lds
    buffer_load_dwordx4 v186, s[20:23], s64 offen offset:2112 lds
    buffer_load_dwordx4 v187, s[20:23], s64 offen offset:3168 lds
    s_add_u32 m0, s63, 4224
    s_nop 0
    buffer_load_dwordx4 v188, s[20:23], s64 offen offset:0 lds
    buffer_load_dwordx4 v189, s[20:23], s64 offen offset:1056 lds
    buffer_load_dwordx4 v190, s[20:23], s64 offen offset:2112 lds
    buffer_load_dwordx4 v191, s[20:23], s64 offen offset:3168 lds
    s_add_u32 s73, s72, 2
    s_and_b32 s73, s73, 7
    s_lshl_b32 s67, s73, 7
    s_add_u32 s67, s67, s71
    s_add_u32 m0, s87, 12288
    s_add_u32 s67, s67, 0
    buffer_load_dwordx4 v246, s[8:11], s67 offen lds
    s_lshl_b32 s67, s73, 7
    s_add_u32 s67, s67, s71
    s_add_u32 m0, s87, 13312
    s_add_u32 s67, s67, 8192
    buffer_load_dwordx4 v246, s[8:11], s67 offen lds
    s_lshl_b32 s67, s73, 7
    s_add_u32 s67, s67, s71
    s_add_u32 m0, s87, 14336
    s_add_u32 s67, s67, 16384
    buffer_load_dwordx4 v246, s[8:11], s67 offen lds
    s_lshl_b32 s65, s82, 6
    v_xor_b32 v248, s65, v245
    v_add_u32 v249, s7, v2
    s_waitcnt vmcnt(22)
    s_barrier
    ds_read_b128 v[208:211], v248 offset:0
    ds_read_b128 v[212:215], v248 offset:2048
    ds_read_b128 v[216:219], v248 offset:4096
    ds_read_b64_tr_b16 v[152:153], v249 offset:0
    ds_read_b64_tr_b16 v[154:155], v249 offset:256
    ds_read_b64_tr_b16 v[156:157], v249 offset:32
    ds_read_b64_tr_b16 v[158:159], v249 offset:288
    ds_read_b64_tr_b16 v[160:161], v249 offset:64
    ds_read_b64_tr_b16 v[162:163], v249 offset:320
    ds_read_b64_tr_b16 v[164:165], v249 offset:96
    ds_read_b64_tr_b16 v[166:167], v249 offset:352
    ds_read_b64_tr_b16 v[168:169], v249 offset:128
    ds_read_b64_tr_b16 v[170:171], v249 offset:384
    ds_read_b64_tr_b16 v[172:173], v249 offset:160
    ds_read_b64_tr_b16 v[174:175], v249 offset:416
    ds_read_b64_tr_b16 v[176:177], v249 offset:192
    ds_read_b64_tr_b16 v[178:179], v249 offset:448
    ds_read_b64_tr_b16 v[180:181], v249 offset:224
    ds_read_b64_tr_b16 v[182:183], v249 offset:480
    s_lshl_b32 s65, s83, 6
    v_xor_b32 v248, s65, v245
    v_add_u32 v249, s62, v2
    s_waitcnt vmcnt(14)
    s_waitcnt lgkmcnt(0)
    v_mfma_f32_16x16x32_bf16 v[8:11], v[152:155], v[208:211], v[8:11]
    ds_read_b128 v[136:139], v248 offset:0
    ds_read_b128 v[140:143], v248 offset:2048
    s_add_u32 s64, s72, 1
    s_and_b32 s64, s64, 7
    v_mfma_f32_16x16x32_bf16 v[12:15], v[152:155], v[212:215], v[12:15]
    ds_read_b128 v[144:147], v248 offset:4096
    s_lshl_b32 s64, s64, 1
    s_add_u32 s64, s64, s83
    v_mfma_f32_16x16x32_bf16 v[16:19], v[152:155], v[216:219], v[16:19]
    ds_read_b64_tr_b16 v[104:105], v249 offset:0
    v_mfma_f32_16x16x32_bf16 v[20:23], v[156:159], v[208:211], v[20:23]
    ds_read_b64_tr_b16 v[106:107], v249 offset:256
    s_lshl_b32 s64, s64, 18
    s_add_u32 s64, s64, s69
    v_mfma_f32_16x16x32_bf16 v[24:27], v[156:159], v[212:215], v[24:27]
    ds_read_b64_tr_b16 v[108:109], v249 offset:32
    v_mfma_f32_16x16x32_bf16 v[28:31], v[156:159], v[216:219], v[28:31]
    ds_read_b64_tr_b16 v[110:111], v249 offset:288
    s_add_u32 m0, s7, 0
    v_mfma_f32_16x16x32_bf16 v[32:35], v[160:163], v[208:211], v[32:35]
    ds_read_b64_tr_b16 v[112:113], v249 offset:64
    v_mfma_f32_16x16x32_bf16 v[36:39], v[160:163], v[212:215], v[36:39]
    ds_read_b64_tr_b16 v[114:115], v249 offset:320
    buffer_load_dwordx4 v184, s[20:23], s64 offen offset:0 lds
    v_mfma_f32_16x16x32_bf16 v[40:43], v[160:163], v[216:219], v[40:43]
    ds_read_b64_tr_b16 v[116:117], v249 offset:96
    ds_read_b64_tr_b16 v[118:119], v249 offset:352
    v_mfma_f32_16x16x32_bf16 v[44:47], v[164:167], v[208:211], v[44:47]
    ds_read_b64_tr_b16 v[120:121], v249 offset:128
    buffer_load_dwordx4 v185, s[20:23], s64 offen offset:1056 lds
    v_mfma_f32_16x16x32_bf16 v[48:51], v[164:167], v[212:215], v[48:51]
    ds_read_b64_tr_b16 v[122:123], v249 offset:384
    v_mfma_f32_16x16x32_bf16 v[52:55], v[164:167], v[216:219], v[52:55]
    ds_read_b64_tr_b16 v[124:125], v249 offset:160
    buffer_load_dwordx4 v186, s[20:23], s64 offen offset:2112 lds
    v_mfma_f32_16x16x32_bf16 v[56:59], v[168:171], v[208:211], v[56:59]
    ds_read_b64_tr_b16 v[126:127], v249 offset:416
    buffer_load_dwordx4 v187, s[20:23], s64 offen offset:3168 lds
    v_mfma_f32_16x16x32_bf16 v[60:63], v[168:171], v[212:215], v[60:63]
    ds_read_b64_tr_b16 v[128:129], v249 offset:192
    v_mfma_f32_16x16x32_bf16 v[64:67], v[168:171], v[216:219], v[64:67]
    ds_read_b64_tr_b16 v[130:131], v249 offset:448
    s_add_u32 m0, s7, 4224
    v_mfma_f32_16x16x32_bf16 v[68:71], v[172:175], v[208:211], v[68:71]
    ds_read_b64_tr_b16 v[132:133], v249 offset:224
    v_mfma_f32_16x16x32_bf16 v[72:75], v[172:175], v[212:215], v[72:75]
    ds_read_b64_tr_b16 v[134:135], v249 offset:480
    buffer_load_dwordx4 v188, s[20:23], s64 offen offset:0 lds
    v_mfma_f32_16x16x32_bf16 v[76:79], v[172:175], v[216:219], v[76:79]
    v_mfma_f32_16x16x32_bf16 v[80:83], v[176:179], v[208:211], v[80:83]
    buffer_load_dwordx4 v189, s[20:23], s64 offen offset:1056 lds
    s_lshl_b32 s65, s82, 6
    v_mfma_f32_16x16x32_bf16 v[84:87], v[176:179], v[212:215], v[84:87]
    v_mfma_f32_16x16x32_bf16 v[88:91], v[176:179], v[216:219], v[88:91]
    buffer_load_dwordx4 v190, s[20:23], s64 offen offset:2112 lds
    v_xor_b32 v248, s65, v245
    v_mfma_f32_16x16x32_bf16 v[92:95], v[180:183], v[208:211], v[92:95]
    v_mfma_f32_16x16x32_bf16 v[96:99], v[180:183], v[212:215], v[96:99]
    buffer_load_dwordx4 v191, s[20:23], s64 offen offset:3168 lds
    v_add_u32 v249, s63, v2
    v_mfma_f32_16x16x32_bf16 v[100:103], v[180:183], v[216:219], v[100:103]
    s_waitcnt vmcnt(11)
    s_waitcnt lgkmcnt(0)
    s_barrier
    v_mfma_f32_16x16x32_bf16 v[8:11], v[104:107], v[136:139], v[8:11]
    ds_read_b128 v[208:211], v248 offset:6144
    ds_read_b128 v[212:215], v248 offset:8192
    s_add_u32 s64, s72, 2
    s_and_b32 s64, s64, 7
    v_mfma_f32_16x16x32_bf16 v[12:15], v[104:107], v[140:143], v[12:15]
    ds_read_b128 v[216:219], v248 offset:10240
    s_lshl_b32 s64, s64, 1
    s_add_u32 s64, s64, s82
    v_mfma_f32_16x16x32_bf16 v[16:19], v[104:107], v[144:147], v[16:19]
    ds_read_b64_tr_b16 v[152:153], v249 offset:0
    s_lshl_b32 s64, s64, 18
    s_add_u32 s64, s64, s69
    v_mfma_f32_16x16x32_bf16 v[20:23], v[108:111], v[136:139], v[20:23]
    ds_read_b64_tr_b16 v[154:155], v249 offset:256
    v_mfma_f32_16x16x32_bf16 v[24:27], v[108:111], v[140:143], v[24:27]
    ds_read_b64_tr_b16 v[156:157], v249 offset:32
    s_add_u32 m0, s62, 0
    v_mfma_f32_16x16x32_bf16 v[28:31], v[108:111], v[144:147], v[28:31]
    ds_read_b64_tr_b16 v[158:159], v249 offset:288
    buffer_load_dwordx4 v184, s[20:23], s64 offen offset:0 lds
    v_mfma_f32_16x16x32_bf16 v[32:35], v[112:115], v[136:139], v[32:35]
    ds_read_b64_tr_b16 v[160:161], v249 offset:64
    v_mfma_f32_16x16x32_bf16 v[36:39], v[112:115], v[140:143], v[36:39]
    ds_read_b64_tr_b16 v[162:163], v249 offset:320
    buffer_load_dwordx4 v185, s[20:23], s64 offen offset:1056 lds
    v_mfma_f32_16x16x32_bf16 v[40:43], v[112:115], v[144:147], v[40:43]
    ds_read_b64_tr_b16 v[164:165], v249 offset:96
    ds_read_b64_tr_b16 v[166:167], v249 offset:352
    buffer_load_dwordx4 v186, s[20:23], s64 offen offset:2112 lds
    v_mfma_f32_16x16x32_bf16 v[44:47], v[116:119], v[136:139], v[44:47]
    ds_read_b64_tr_b16 v[168:169], v249 offset:128
    buffer_load_dwordx4 v187, s[20:23], s64 offen offset:3168 lds
    v_mfma_f32_16x16x32_bf16 v[48:51], v[116:119], v[140:143], v[48:51]
    ds_read_b64_tr_b16 v[170:171], v249 offset:384
    v_mfma_f32_16x16x32_bf16 v[52:55], v[116:119], v[144:147], v[52:55]
    ds_read_b64_tr_b16 v[172:173], v249 offset:160
    s_add_u32 m0, s62, 4224
    v_mfma_f32_16x16x32_bf16 v[56:59], v[120:123], v[136:139], v[56:59]
    ds_read_b64_tr_b16 v[174:175], v249 offset:416
    buffer_load_dwordx4 v188, s[20:23], s64 offen offset:0 lds
    v_mfma_f32_16x16x32_bf16 v[60:63], v[120:123], v[140:143], v[60:63]
    ds_read_b64_tr_b16 v[176:177], v249 offset:192
    v_mfma_f32_16x16x32_bf16 v[64:67], v[120:123], v[144:147], v[64:67]
    ds_read_b64_tr_b16 v[178:179], v249 offset:448
    buffer_load_dwordx4 v189, s[20:23], s64 offen offset:1056 lds
    v_mfma_f32_16x16x32_bf16 v[68:71], v[124:127], v[136:139], v[68:71]
    ds_read_b64_tr_b16 v[180:181], v249 offset:224
    buffer_load_dwordx4 v190, s[20:23], s64 offen offset:2112 lds
    v_mfma_f32_16x16x32_bf16 v[72:75], v[124:127], v[140:143], v[72:75]
    ds_read_b64_tr_b16 v[182:183], v249 offset:480
    buffer_load_dwordx4 v191, s[20:23], s64 offen offset:3168 lds
    v_mfma_f32_16x16x32_bf16 v[76:79], v[124:127], v[144:147], v[76:79]
    v_mfma_f32_16x16x32_bf16 v[80:83], v[128:131], v[136:139], v[80:83]
    s_add_u32 s73, s72, 3
    s_and_b32 s73, s73, 7
    s_lshl_b32 s65, s83, 6
    v_mfma_f32_16x16x32_bf16 v[84:87], v[128:131], v[140:143], v[84:87]
    s_lshl_b32 s67, s73, 7
    s_add_u32 s67, s67, s71
    s_add_u32 m0, s87, 18432
    s_add_u32 s67, s67, 0
    buffer_load_dwordx4 v246, s[8:11], s67 offen lds
    v_mfma_f32_16x16x32_bf16 v[88:91], v[128:131], v[144:147], v[88:91]
    v_xor_b32 v248, s65, v245
    v_mfma_f32_16x16x32_bf16 v[92:95], v[132:135], v[136:139], v[92:95]
    s_lshl_b32 s67, s73, 7
    s_add_u32 s67, s67, s71
    s_add_u32 m0, s87, 19456
    s_add_u32 s67, s67, 8192
    buffer_load_dwordx4 v246, s[8:11], s67 offen lds
    v_mfma_f32_16x16x32_bf16 v[96:99], v[132:135], v[140:143], v[96:99]
    s_lshl_b32 s67, s73, 7
    s_add_u32 s67, s67, s71
    s_add_u32 m0, s87, 20480
    s_add_u32 s67, s67, 16384
    buffer_load_dwordx4 v246, s[8:11], s67 offen lds
    v_add_u32 v249, s7, v2
    v_mfma_f32_16x16x32_bf16 v[100:103], v[132:135], v[144:147], v[100:103]
    s_waitcnt vmcnt(11)
    s_waitcnt lgkmcnt(0)
    v_mfma_f32_16x16x32_bf16 v[8:11], v[152:155], v[208:211], v[8:11]
    ds_read_b128 v[136:139], v248 offset:6144
    ds_read_b128 v[140:143], v248 offset:8192
    s_add_u32 s64, s72, 2
    s_and_b32 s64, s64, 7
    v_mfma_f32_16x16x32_bf16 v[12:15], v[152:155], v[212:215], v[12:15]
    ds_read_b128 v[144:147], v248 offset:10240
    s_lshl_b32 s64, s64, 1
    s_add_u32 s64, s64, s83
    v_mfma_f32_16x16x32_bf16 v[16:19], v[152:155], v[216:219], v[16:19]
    ds_read_b64_tr_b16 v[104:105], v249 offset:0
    v_mfma_f32_16x16x32_bf16 v[20:23], v[156:159], v[208:211], v[20:23]
    ds_read_b64_tr_b16 v[106:107], v249 offset:256
    s_lshl_b32 s64, s64, 18
    s_add_u32 s64, s64, s69
    v_mfma_f32_16x16x32_bf16 v[24:27], v[156:159], v[212:215], v[24:27]
    ds_read_b64_tr_b16 v[108:109], v249 offset:32
    v_mfma_f32_16x16x32_bf16 v[28:31], v[156:159], v[216:219], v[28:31]
    ds_read_b64_tr_b16 v[110:111], v249 offset:288
    s_add_u32 m0, s63, 0
    v_mfma_f32_16x16x32_bf16 v[32:35], v[160:163], v[208:211], v[32:35]
    ds_read_b64_tr_b16 v[112:113], v249 offset:64
    v_mfma_f32_16x16x32_bf16 v[36:39], v[160:163], v[212:215], v[36:39]
    ds_read_b64_tr_b16 v[114:115], v249 offset:320
    buffer_load_dwordx4 v184, s[20:23], s64 offen offset:0 lds
    v_mfma_f32_16x16x32_bf16 v[40:43], v[160:163], v[216:219], v[40:43]
    ds_read_b64_tr_b16 v[116:117], v249 offset:96
    ds_read_b64_tr_b16 v[118:119], v249 offset:352
    v_mfma_f32_16x16x32_bf16 v[44:47], v[164:167], v[208:211], v[44:47]
    ds_read_b64_tr_b16 v[120:121], v249 offset:128
    buffer_load_dwordx4 v185, s[20:23], s64 offen offset:1056 lds
    v_mfma_f32_16x16x32_bf16 v[48:51], v[164:167], v[212:215], v[48:51]
    ds_read_b64_tr_b16 v[122:123], v249 offset:384
    v_mfma_f32_16x16x32_bf16 v[52:55], v[164:167], v[216:219], v[52:55]
    ds_read_b64_tr_b16 v[124:125], v249 offset:160
    buffer_load_dwordx4 v186, s[20:23], s64 offen offset:2112 lds
    v_mfma_f32_16x16x32_bf16 v[56:59], v[168:171], v[208:211], v[56:59]
    ds_read_b64_tr_b16 v[126:127], v249 offset:416
    buffer_load_dwordx4 v187, s[20:23], s64 offen offset:3168 lds
    v_mfma_f32_16x16x32_bf16 v[60:63], v[168:171], v[212:215], v[60:63]
    ds_read_b64_tr_b16 v[128:129], v249 offset:192
    v_mfma_f32_16x16x32_bf16 v[64:67], v[168:171], v[216:219], v[64:67]
    ds_read_b64_tr_b16 v[130:131], v249 offset:448
    s_add_u32 m0, s63, 4224
    v_mfma_f32_16x16x32_bf16 v[68:71], v[172:175], v[208:211], v[68:71]
    ds_read_b64_tr_b16 v[132:133], v249 offset:224
    v_mfma_f32_16x16x32_bf16 v[72:75], v[172:175], v[212:215], v[72:75]
    ds_read_b64_tr_b16 v[134:135], v249 offset:480
    buffer_load_dwordx4 v188, s[20:23], s64 offen offset:0 lds
    v_mfma_f32_16x16x32_bf16 v[76:79], v[172:175], v[216:219], v[76:79]
    v_mfma_f32_16x16x32_bf16 v[80:83], v[176:179], v[208:211], v[80:83]
    buffer_load_dwordx4 v189, s[20:23], s64 offen offset:1056 lds
    s_lshl_b32 s65, s82, 6
    v_mfma_f32_16x16x32_bf16 v[84:87], v[176:179], v[212:215], v[84:87]
    v_mfma_f32_16x16x32_bf16 v[88:91], v[176:179], v[216:219], v[88:91]
    buffer_load_dwordx4 v190, s[20:23], s64 offen offset:2112 lds
    v_xor_b32 v248, s65, v245
    v_mfma_f32_16x16x32_bf16 v[92:95], v[180:183], v[208:211], v[92:95]
    v_mfma_f32_16x16x32_bf16 v[96:99], v[180:183], v[212:215], v[96:99]
    buffer_load_dwordx4 v191, s[20:23], s64 offen offset:3168 lds
    v_add_u32 v249, s62, v2
    v_mfma_f32_16x16x32_bf16 v[100:103], v[180:183], v[216:219], v[100:103]
    s_waitcnt vmcnt(11)
    s_waitcnt lgkmcnt(0)
    s_barrier
    v_mfma_f32_16x16x32_bf16 v[8:11], v[104:107], v[136:139], v[8:11]
    ds_read_b128 v[208:211], v248 offset:12288
    ds_read_b128 v[212:215], v248 offset:14336
    s_add_u32 s64, s72, 3
    s_and_b32 s64, s64, 7
    v_mfma_f32_16x16x32_bf16 v[12:15], v[104:107], v[140:143], v[12:15]
    ds_read_b128 v[216:219], v248 offset:16384
    s_lshl_b32 s64, s64, 1
    s_add_u32 s64, s64, s82
    v_mfma_f32_16x16x32_bf16 v[16:19], v[104:107], v[144:147], v[16:19]
    ds_read_b64_tr_b16 v[152:153], v249 offset:0
    s_lshl_b32 s64, s64, 18
    s_add_u32 s64, s64, s69
    v_mfma_f32_16x16x32_bf16 v[20:23], v[108:111], v[136:139], v[20:23]
    ds_read_b64_tr_b16 v[154:155], v249 offset:256
    v_mfma_f32_16x16x32_bf16 v[24:27], v[108:111], v[140:143], v[24:27]
    ds_read_b64_tr_b16 v[156:157], v249 offset:32
    s_add_u32 m0, s7, 0
    v_mfma_f32_16x16x32_bf16 v[28:31], v[108:111], v[144:147], v[28:31]
    ds_read_b64_tr_b16 v[158:159], v249 offset:288
    buffer_load_dwordx4 v184, s[20:23], s64 offen offset:0 lds
    v_mfma_f32_16x16x32_bf16 v[32:35], v[112:115], v[136:139], v[32:35]
    ds_read_b64_tr_b16 v[160:161], v249 offset:64
    v_mfma_f32_16x16x32_bf16 v[36:39], v[112:115], v[140:143], v[36:39]
    ds_read_b64_tr_b16 v[162:163], v249 offset:320
    buffer_load_dwordx4 v185, s[20:23], s64 offen offset:1056 lds
    v_mfma_f32_16x16x32_bf16 v[40:43], v[112:115], v[144:147], v[40:43]
    ds_read_b64_tr_b16 v[164:165], v249 offset:96
    ds_read_b64_tr_b16 v[166:167], v249 offset:352
    buffer_load_dwordx4 v186, s[20:23], s64 offen offset:2112 lds
    v_mfma_f32_16x16x32_bf16 v[44:47], v[116:119], v[136:139], v[44:47]
    ds_read_b64_tr_b16 v[168:169], v249 offset:128
    buffer_load_dwordx4 v187, s[20:23], s64 offen offset:3168 lds
    v_mfma_f32_16x16x32_bf16 v[48:51], v[116:119], v[140:143], v[48:51]
    ds_read_b64_tr_b16 v[170:171], v249 offset:384
    v_mfma_f32_16x16x32_bf16 v[52:55], v[116:119], v[144:147], v[52:55]
    ds_read_b64_tr_b16 v[172:173], v249 offset:160
    s_add_u32 m0, s7, 4224
    v_mfma_f32_16x16x32_bf16 v[56:59], v[120:123], v[136:139], v[56:59]
    ds_read_b64_tr_b16 v[174:175], v249 offset:416
    buffer_load_dwordx4 v188, s[20:23], s64 offen offset:0 lds
    v_mfma_f32_16x16x32_bf16 v[60:63], v[120:123], v[140:143], v[60:63]
    ds_read_b64_tr_b16 v[176:177], v249 offset:192
    v_mfma_f32_16x16x32_bf16 v[64:67], v[120:123], v[144:147], v[64:67]
    ds_read_b64_tr_b16 v[178:179], v249 offset:448
    buffer_load_dwordx4 v189, s[20:23], s64 offen offset:1056 lds
    v_mfma_f32_16x16x32_bf16 v[68:71], v[124:127], v[136:139], v[68:71]
    ds_read_b64_tr_b16 v[180:181], v249 offset:224
    buffer_load_dwordx4 v190, s[20:23], s64 offen offset:2112 lds
    v_mfma_f32_16x16x32_bf16 v[72:75], v[124:127], v[140:143], v[72:75]
    ds_read_b64_tr_b16 v[182:183], v249 offset:480
    buffer_load_dwordx4 v191, s[20:23], s64 offen offset:3168 lds
    v_mfma_f32_16x16x32_bf16 v[76:79], v[124:127], v[144:147], v[76:79]
    v_mfma_f32_16x16x32_bf16 v[80:83], v[128:131], v[136:139], v[80:83]
    s_add_u32 s73, s72, 4
    s_and_b32 s73, s73, 7
    s_lshl_b32 s65, s83, 6
    v_mfma_f32_16x16x32_bf16 v[84:87], v[128:131], v[140:143], v[84:87]
    s_lshl_b32 s67, s73, 7
    s_add_u32 s67, s67, s71
    s_add_u32 m0, s87, 0
    s_add_u32 s67, s67, 0
    buffer_load_dwordx4 v246, s[8:11], s67 offen lds
    v_mfma_f32_16x16x32_bf16 v[88:91], v[128:131], v[144:147], v[88:91]
    v_xor_b32 v248, s65, v245
    v_mfma_f32_16x16x32_bf16 v[92:95], v[132:135], v[136:139], v[92:95]
    s_lshl_b32 s67, s73, 7
    s_add_u32 s67, s67, s71
    s_add_u32 m0, s87, 1024
    s_add_u32 s67, s67, 8192
    buffer_load_dwordx4 v246, s[8:11], s67 offen lds
    v_mfma_f32_16x16x32_bf16 v[96:99], v[132:135], v[140:143], v[96:99]
    s_lshl_b32 s67, s73, 7
    s_add_u32 s67, s67, s71
    s_add_u32 m0, s87, 2048
    s_add_u32 s67, s67, 16384
    buffer_load_dwordx4 v246, s[8:11], s67 offen lds
    v_add_u32 v249, s63, v2
    v_mfma_f32_16x16x32_bf16 v[100:103], v[132:135], v[144:147], v[100:103]
    s_waitcnt vmcnt(11)
    s_waitcnt lgkmcnt(0)
    v_mfma_f32_16x16x32_bf16 v[8:11], v[152:155], v[208:211], v[8:11]
    ds_read_b128 v[136:139], v248 offset:12288
    ds_read_b128 v[140:143], v248 offset:14336
    s_add_u32 s64, s72, 3
    s_and_b32 s64, s64, 7
    v_mfma_f32_16x16x32_bf16 v[12:15], v[152:155], v[212:215], v[12:15]
    ds_read_b128 v[144:147], v248 offset:16384
    s_lshl_b32 s64, s64, 1
    s_add_u32 s64, s64, s83
    v_mfma_f32_16x16x32_bf16 v[16:19], v[152:155], v[216:219], v[16:19]
    ds_read_b64_tr_b16 v[104:105], v249 offset:0
    v_mfma_f32_16x16x32_bf16 v[20:23], v[156:159], v[208:211], v[20:23]
    ds_read_b64_tr_b16 v[106:107], v249 offset:256
    s_lshl_b32 s64, s64, 18
    s_add_u32 s64, s64, s69
    v_mfma_f32_16x16x32_bf16 v[24:27], v[156:159], v[212:215], v[24:27]
    ds_read_b64_tr_b16 v[108:109], v249 offset:32
    v_mfma_f32_16x16x32_bf16 v[28:31], v[156:159], v[216:219], v[28:31]
    ds_read_b64_tr_b16 v[110:111], v249 offset:288
    s_add_u32 m0, s62, 0
    v_mfma_f32_16x16x32_bf16 v[32:35], v[160:163], v[208:211], v[32:35]
    ds_read_b64_tr_b16 v[112:113], v249 offset:64
    v_mfma_f32_16x16x32_bf16 v[36:39], v[160:163], v[212:215], v[36:39]
    ds_read_b64_tr_b16 v[114:115], v249 offset:320
    buffer_load_dwordx4 v184, s[20:23], s64 offen offset:0 lds
    v_mfma_f32_16x16x32_bf16 v[40:43], v[160:163], v[216:219], v[40:43]
    ds_read_b64_tr_b16 v[116:117], v249 offset:96
    ds_read_b64_tr_b16 v[118:119], v249 offset:352
    v_mfma_f32_16x16x32_bf16 v[44:47], v[164:167], v[208:211], v[44:47]
    ds_read_b64_tr_b16 v[120:121], v249 offset:128
    buffer_load_dwordx4 v185, s[20:23], s64 offen offset:1056 lds
    v_mfma_f32_16x16x32_bf16 v[48:51], v[164:167], v[212:215], v[48:51]
    ds_read_b64_tr_b16 v[122:123], v249 offset:384
    v_mfma_f32_16x16x32_bf16 v[52:55], v[164:167], v[216:219], v[52:55]
    ds_read_b64_tr_b16 v[124:125], v249 offset:160
    buffer_load_dwordx4 v186, s[20:23], s64 offen offset:2112 lds
    v_mfma_f32_16x16x32_bf16 v[56:59], v[168:171], v[208:211], v[56:59]
    ds_read_b64_tr_b16 v[126:127], v249 offset:416
    buffer_load_dwordx4 v187, s[20:23], s64 offen offset:3168 lds
    v_mfma_f32_16x16x32_bf16 v[60:63], v[168:171], v[212:215], v[60:63]
    ds_read_b64_tr_b16 v[128:129], v249 offset:192
    v_mfma_f32_16x16x32_bf16 v[64:67], v[168:171], v[216:219], v[64:67]
    ds_read_b64_tr_b16 v[130:131], v249 offset:448
    s_add_u32 m0, s62, 4224
    v_mfma_f32_16x16x32_bf16 v[68:71], v[172:175], v[208:211], v[68:71]
    ds_read_b64_tr_b16 v[132:133], v249 offset:224
    v_mfma_f32_16x16x32_bf16 v[72:75], v[172:175], v[212:215], v[72:75]
    ds_read_b64_tr_b16 v[134:135], v249 offset:480
    buffer_load_dwordx4 v188, s[20:23], s64 offen offset:0 lds
    v_mfma_f32_16x16x32_bf16 v[76:79], v[172:175], v[216:219], v[76:79]
    v_mfma_f32_16x16x32_bf16 v[80:83], v[176:179], v[208:211], v[80:83]
    buffer_load_dwordx4 v189, s[20:23], s64 offen offset:1056 lds
    s_lshl_b32 s65, s82, 6
    v_mfma_f32_16x16x32_bf16 v[84:87], v[176:179], v[212:215], v[84:87]
    v_mfma_f32_16x16x32_bf16 v[88:91], v[176:179], v[216:219], v[88:91]
    buffer_load_dwordx4 v190, s[20:23], s64 offen offset:2112 lds
    v_xor_b32 v248, s65, v245
    v_mfma_f32_16x16x32_bf16 v[92:95], v[180:183], v[208:211], v[92:95]
    v_mfma_f32_16x16x32_bf16 v[96:99], v[180:183], v[212:215], v[96:99]
    buffer_load_dwordx4 v191, s[20:23], s64 offen offset:3168 lds
    v_add_u32 v249, s7, v2
    v_mfma_f32_16x16x32_bf16 v[100:103], v[180:183], v[216:219], v[100:103]
    s_waitcnt vmcnt(11)
    s_waitcnt lgkmcnt(0)
    s_barrier
    v_mfma_f32_16x16x32_bf16 v[8:11], v[104:107], v[136:139], v[8:11]
    ds_read_b128 v[208:211], v248 offset:18432
    ds_read_b128 v[212:215], v248 offset:20480
    s_add_u32 s64, s72, 4
    s_and_b32 s64, s64, 7
    v_mfma_f32_16x16x32_bf16 v[12:15], v[104:107], v[140:143], v[12:15]
    ds_read_b128 v[216:219], v248 offset:22528
    s_lshl_b32 s64, s64, 1
    s_add_u32 s64, s64, s82
    v_mfma_f32_16x16x32_bf16 v[16:19], v[104:107], v[144:147], v[16:19]
    ds_read_b64_tr_b16 v[152:153], v249 offset:0
    s_lshl_b32 s64, s64, 18
    s_add_u32 s64, s64, s69
    v_mfma_f32_16x16x32_bf16 v[20:23], v[108:111], v[136:139], v[20:23]
    ds_read_b64_tr_b16 v[154:155], v249 offset:256
    v_mfma_f32_16x16x32_bf16 v[24:27], v[108:111], v[140:143], v[24:27]
    ds_read_b64_tr_b16 v[156:157], v249 offset:32
    s_add_u32 m0, s63, 0
    v_mfma_f32_16x16x32_bf16 v[28:31], v[108:111], v[144:147], v[28:31]
    ds_read_b64_tr_b16 v[158:159], v249 offset:288
    buffer_load_dwordx4 v184, s[20:23], s64 offen offset:0 lds
    v_mfma_f32_16x16x32_bf16 v[32:35], v[112:115], v[136:139], v[32:35]
    ds_read_b64_tr_b16 v[160:161], v249 offset:64
    v_mfma_f32_16x16x32_bf16 v[36:39], v[112:115], v[140:143], v[36:39]
    ds_read_b64_tr_b16 v[162:163], v249 offset:320
    buffer_load_dwordx4 v185, s[20:23], s64 offen offset:1056 lds
    v_mfma_f32_16x16x32_bf16 v[40:43], v[112:115], v[144:147], v[40:43]
    ds_read_b64_tr_b16 v[164:165], v249 offset:96
    ds_read_b64_tr_b16 v[166:167], v249 offset:352
    buffer_load_dwordx4 v186, s[20:23], s64 offen offset:2112 lds
    v_mfma_f32_16x16x32_bf16 v[44:47], v[116:119], v[136:139], v[44:47]
    ds_read_b64_tr_b16 v[168:169], v249 offset:128
    buffer_load_dwordx4 v187, s[20:23], s64 offen offset:3168 lds
    v_mfma_f32_16x16x32_bf16 v[48:51], v[116:119], v[140:143], v[48:51]
    ds_read_b64_tr_b16 v[170:171], v249 offset:384
    v_mfma_f32_16x16x32_bf16 v[52:55], v[116:119], v[144:147], v[52:55]
    ds_read_b64_tr_b16 v[172:173], v249 offset:160
    s_add_u32 m0, s63, 4224
    v_mfma_f32_16x16x32_bf16 v[56:59], v[120:123], v[136:139], v[56:59]
    ds_read_b64_tr_b16 v[174:175], v249 offset:416
    buffer_load_dwordx4 v188, s[20:23], s64 offen offset:0 lds
    v_mfma_f32_16x16x32_bf16 v[60:63], v[120:123], v[140:143], v[60:63]
    ds_read_b64_tr_b16 v[176:177], v249 offset:192
    v_mfma_f32_16x16x32_bf16 v[64:67], v[120:123], v[144:147], v[64:67]
    ds_read_b64_tr_b16 v[178:179], v249 offset:448
    buffer_load_dwordx4 v189, s[20:23], s64 offen offset:1056 lds
    v_mfma_f32_16x16x32_bf16 v[68:71], v[124:127], v[136:139], v[68:71]
    ds_read_b64_tr_b16 v[180:181], v249 offset:224
    buffer_load_dwordx4 v190, s[20:23], s64 offen offset:2112 lds
    v_mfma_f32_16x16x32_bf16 v[72:75], v[124:127], v[140:143], v[72:75]
    ds_read_b64_tr_b16 v[182:183], v249 offset:480
    buffer_load_dwordx4 v191, s[20:23], s64 offen offset:3168 lds
    v_mfma_f32_16x16x32_bf16 v[76:79], v[124:127], v[144:147], v[76:79]
    v_mfma_f32_16x16x32_bf16 v[80:83], v[128:131], v[136:139], v[80:83]
    s_add_u32 s73, s72, 5
    s_and_b32 s73, s73, 7
    s_lshl_b32 s65, s83, 6
    v_mfma_f32_16x16x32_bf16 v[84:87], v[128:131], v[140:143], v[84:87]
    s_lshl_b32 s67, s73, 7
    s_add_u32 s67, s67, s71
    s_add_u32 m0, s87, 6144
    s_add_u32 s67, s67, 0
    buffer_load_dwordx4 v246, s[8:11], s67 offen lds
    v_mfma_f32_16x16x32_bf16 v[88:91], v[128:131], v[144:147], v[88:91]
    v_xor_b32 v248, s65, v245
    v_mfma_f32_16x16x32_bf16 v[92:95], v[132:135], v[136:139], v[92:95]
    s_lshl_b32 s67, s73, 7
    s_add_u32 s67, s67, s71
    s_add_u32 m0, s87, 7168
    s_add_u32 s67, s67, 8192
    buffer_load_dwordx4 v246, s[8:11], s67 offen lds
    v_mfma_f32_16x16x32_bf16 v[96:99], v[132:135], v[140:143], v[96:99]
    s_lshl_b32 s67, s73, 7
    s_add_u32 s67, s67, s71
    s_add_u32 m0, s87, 8192
    s_add_u32 s67, s67, 16384
    buffer_load_dwordx4 v246, s[8:11], s67 offen lds
    v_add_u32 v249, s62, v2
    v_mfma_f32_16x16x32_bf16 v[100:103], v[132:135], v[144:147], v[100:103]
    s_waitcnt vmcnt(11)
    s_waitcnt lgkmcnt(0)
    v_mfma_f32_16x16x32_bf16 v[8:11], v[152:155], v[208:211], v[8:11]
    ds_read_b128 v[136:139], v248 offset:18432
    ds_read_b128 v[140:143], v248 offset:20480
    s_add_u32 s64, s72, 4
    s_and_b32 s64, s64, 7
    v_mfma_f32_16x16x32_bf16 v[12:15], v[152:155], v[212:215], v[12:15]
    ds_read_b128 v[144:147], v248 offset:22528
    s_lshl_b32 s64, s64, 1
    s_add_u32 s64, s64, s83
    v_mfma_f32_16x16x32_bf16 v[16:19], v[152:155], v[216:219], v[16:19]
    ds_read_b64_tr_b16 v[104:105], v249 offset:0
    v_mfma_f32_16x16x32_bf16 v[20:23], v[156:159], v[208:211], v[20:23]
    ds_read_b64_tr_b16 v[106:107], v249 offset:256
    s_lshl_b32 s64, s64, 18
    s_add_u32 s64, s64, s69
    v_mfma_f32_16x16x32_bf16 v[24:27], v[156:159], v[212:215], v[24:27]
    ds_read_b64_tr_b16 v[108:109], v249 offset:32
    v_mfma_f32_16x16x32_bf16 v[28:31], v[156:159], v[216:219], v[28:31]
    ds_read_b64_tr_b16 v[110:111], v249 offset:288
    s_add_u32 m0, s7, 0
    v_mfma_f32_16x16x32_bf16 v[32:35], v[160:163], v[208:211], v[32:35]
    ds_read_b64_tr_b16 v[112:113], v249 offset:64
    v_mfma_f32_16x16x32_bf16 v[36:39], v[160:163], v[212:215], v[36:39]
    ds_read_b64_tr_b16 v[114:115], v249 offset:320
    buffer_load_dwordx4 v184, s[20:23], s64 offen offset:0 lds
    v_mfma_f32_16x16x32_bf16 v[40:43], v[160:163], v[216:219], v[40:43]
    ds_read_b64_tr_b16 v[116:117], v249 offset:96
    ds_read_b64_tr_b16 v[118:119], v249 offset:352
    v_mfma_f32_16x16x32_bf16 v[44:47], v[164:167], v[208:211], v[44:47]
    ds_read_b64_tr_b16 v[120:121], v249 offset:128
    buffer_load_dwordx4 v185, s[20:23], s64 offen offset:1056 lds
    v_mfma_f32_16x16x32_bf16 v[48:51], v[164:167], v[212:215], v[48:51]
    ds_read_b64_tr_b16 v[122:123], v249 offset:384
    v_mfma_f32_16x16x32_bf16 v[52:55], v[164:167], v[216:219], v[52:55]
    ds_read_b64_tr_b16 v[124:125], v249 offset:160
    buffer_load_dwordx4 v186, s[20:23], s64 offen offset:2112 lds
    v_mfma_f32_16x16x32_bf16 v[56:59], v[168:171], v[208:211], v[56:59]
    ds_read_b64_tr_b16 v[126:127], v249 offset:416
    buffer_load_dwordx4 v187, s[20:23], s64 offen offset:3168 lds
    v_mfma_f32_16x16x32_bf16 v[60:63], v[168:171], v[212:215], v[60:63]
    ds_read_b64_tr_b16 v[128:129], v249 offset:192
    v_mfma_f32_16x16x32_bf16 v[64:67], v[168:171], v[216:219], v[64:67]
    ds_read_b64_tr_b16 v[130:131], v249 offset:448
    s_add_u32 m0, s7, 4224
    v_mfma_f32_16x16x32_bf16 v[68:71], v[172:175], v[208:211], v[68:71]
    ds_read_b64_tr_b16 v[132:133], v249 offset:224
    v_mfma_f32_16x16x32_bf16 v[72:75], v[172:175], v[212:215], v[72:75]
    ds_read_b64_tr_b16 v[134:135], v249 offset:480
    buffer_load_dwordx4 v188, s[20:23], s64 offen offset:0 lds
    v_mfma_f32_16x16x32_bf16 v[76:79], v[172:175], v[216:219], v[76:79]
    v_mfma_f32_16x16x32_bf16 v[80:83], v[176:179], v[208:211], v[80:83]
    buffer_load_dwordx4 v189, s[20:23], s64 offen offset:1056 lds
    s_lshl_b32 s65, s82, 6
    v_mfma_f32_16x16x32_bf16 v[84:87], v[176:179], v[212:215], v[84:87]
    v_mfma_f32_16x16x32_bf16 v[88:91], v[176:179], v[216:219], v[88:91]
    buffer_load_dwordx4 v190, s[20:23], s64 offen offset:2112 lds
    v_xor_b32 v248, s65, v245
    v_mfma_f32_16x16x32_bf16 v[92:95], v[180:183], v[208:211], v[92:95]
    v_mfma_f32_16x16x32_bf16 v[96:99], v[180:183], v[212:215], v[96:99]
    buffer_load_dwordx4 v191, s[20:23], s64 offen offset:3168 lds
    v_add_u32 v249, s63, v2
    v_mfma_f32_16x16x32_bf16 v[100:103], v[180:183], v[216:219], v[100:103]
    s_waitcnt vmcnt(11)
    s_waitcnt lgkmcnt(0)
    s_barrier
    v_mfma_f32_16x16x32_bf16 v[8:11], v[104:107], v[136:139], v[8:11]
    ds_read_b128 v[208:211], v248 offset:0
    ds_read_b128 v[212:215], v248 offset:2048
    s_add_u32 s64, s72, 5
    s_and_b32 s64, s64, 7
    v_mfma_f32_16x16x32_bf16 v[12:15], v[104:107], v[140:143], v[12:15]
    ds_read_b128 v[216:219], v248 offset:4096
    s_lshl_b32 s64, s64, 1
    s_add_u32 s64, s64, s82
    v_mfma_f32_16x16x32_bf16 v[16:19], v[104:107], v[144:147], v[16:19]
    ds_read_b64_tr_b16 v[152:153], v249 offset:0
    s_lshl_b32 s64, s64, 18
    s_add_u32 s64, s64, s69
    v_mfma_f32_16x16x32_bf16 v[20:23], v[108:111], v[136:139], v[20:23]
    ds_read_b64_tr_b16 v[154:155], v249 offset:256
    v_mfma_f32_16x16x32_bf16 v[24:27], v[108:111], v[140:143], v[24:27]
    ds_read_b64_tr_b16 v[156:157], v249 offset:32
    s_add_u32 m0, s62, 0
    v_mfma_f32_16x16x32_bf16 v[28:31], v[108:111], v[144:147], v[28:31]
    ds_read_b64_tr_b16 v[158:159], v249 offset:288
    buffer_load_dwordx4 v184, s[20:23], s64 offen offset:0 lds
    v_mfma_f32_16x16x32_bf16 v[32:35], v[112:115], v[136:139], v[32:35]
    ds_read_b64_tr_b16 v[160:161], v249 offset:64
    v_mfma_f32_16x16x32_bf16 v[36:39], v[112:115], v[140:143], v[36:39]
    ds_read_b64_tr_b16 v[162:163], v249 offset:320
    buffer_load_dwordx4 v185, s[20:23], s64 offen offset:1056 lds
    v_mfma_f32_16x16x32_bf16 v[40:43], v[112:115], v[144:147], v[40:43]
    ds_read_b64_tr_b16 v[164:165], v249 offset:96
    ds_read_b64_tr_b16 v[166:167], v249 offset:352
    buffer_load_dwordx4 v186, s[20:23], s64 offen offset:2112 lds
    v_mfma_f32_16x16x32_bf16 v[44:47], v[116:119], v[136:139], v[44:47]
    ds_read_b64_tr_b16 v[168:169], v249 offset:128
    buffer_load_dwordx4 v187, s[20:23], s64 offen offset:3168 lds
    v_mfma_f32_16x16x32_bf16 v[48:51], v[116:119], v[140:143], v[48:51]
    ds_read_b64_tr_b16 v[170:171], v249 offset:384
    v_mfma_f32_16x16x32_bf16 v[52:55], v[116:119], v[144:147], v[52:55]
    ds_read_b64_tr_b16 v[172:173], v249 offset:160
    s_add_u32 m0, s62, 4224
    v_mfma_f32_16x16x32_bf16 v[56:59], v[120:123], v[136:139], v[56:59]
    ds_read_b64_tr_b16 v[174:175], v249 offset:416
    buffer_load_dwordx4 v188, s[20:23], s64 offen offset:0 lds
    v_mfma_f32_16x16x32_bf16 v[60:63], v[120:123], v[140:143], v[60:63]
    ds_read_b64_tr_b16 v[176:177], v249 offset:192
    v_mfma_f32_16x16x32_bf16 v[64:67], v[120:123], v[144:147], v[64:67]
    ds_read_b64_tr_b16 v[178:179], v249 offset:448
    buffer_load_dwordx4 v189, s[20:23], s64 offen offset:1056 lds
    v_mfma_f32_16x16x32_bf16 v[68:71], v[124:127], v[136:139], v[68:71]
    ds_read_b64_tr_b16 v[180:181], v249 offset:224
    buffer_load_dwordx4 v190, s[20:23], s64 offen offset:2112 lds
    v_mfma_f32_16x16x32_bf16 v[72:75], v[124:127], v[140:143], v[72:75]
    ds_read_b64_tr_b16 v[182:183], v249 offset:480
    buffer_load_dwordx4 v191, s[20:23], s64 offen offset:3168 lds
    v_mfma_f32_16x16x32_bf16 v[76:79], v[124:127], v[144:147], v[76:79]
    v_mfma_f32_16x16x32_bf16 v[80:83], v[128:131], v[136:139], v[80:83]
    s_add_u32 s73, s72, 6
    s_and_b32 s73, s73, 7
    s_lshl_b32 s65, s83, 6
    v_mfma_f32_16x16x32_bf16 v[84:87], v[128:131], v[140:143], v[84:87]
    s_lshl_b32 s67, s73, 7
    s_add_u32 s67, s67, s71
    s_add_u32 m0, s87, 12288
    s_add_u32 s67, s67, 0
    buffer_load_dwordx4 v246, s[8:11], s67 offen lds
    v_mfma_f32_16x16x32_bf16 v[88:91], v[128:131], v[144:147], v[88:91]
    v_xor_b32 v248, s65, v245
    v_mfma_f32_16x16x32_bf16 v[92:95], v[132:135], v[136:139], v[92:95]
    s_lshl_b32 s67, s73, 7
    s_add_u32 s67, s67, s71
    s_add_u32 m0, s87, 13312
    s_add_u32 s67, s67, 8192
    buffer_load_dwordx4 v246, s[8:11], s67 offen lds
    v_mfma_f32_16x16x32_bf16 v[96:99], v[132:135], v[140:143], v[96:99]
    s_lshl_b32 s67, s73, 7
    s_add_u32 s67, s67, s71
    s_add_u32 m0, s87, 14336
    s_add_u32 s67, s67, 16384
    buffer_load_dwordx4 v246, s[8:11], s67 offen lds
    v_add_u32 v249, s7, v2
    v_mfma_f32_16x16x32_bf16 v[100:103], v[132:135], v[144:147], v[100:103]
    s_waitcnt vmcnt(11)
    s_waitcnt lgkmcnt(0)
    v_mfma_f32_16x16x32_bf16 v[8:11], v[152:155], v[208:211], v[8:11]
    ds_read_b128 v[136:139], v248 offset:0
    ds_read_b128 v[140:143], v248 offset:2048
    s_add_u32 s64, s72, 5
    s_and_b32 s64, s64, 7
    v_mfma_f32_16x16x32_bf16 v[12:15], v[152:155], v[212:215], v[12:15]
    ds_read_b128 v[144:147], v248 offset:4096
    s_lshl_b32 s64, s64, 1
    s_add_u32 s64, s64, s83
    v_mfma_f32_16x16x32_bf16 v[16:19], v[152:155], v[216:219], v[16:19]
    ds_read_b64_tr_b16 v[104:105], v249 offset:0
    v_mfma_f32_16x16x32_bf16 v[20:23], v[156:159], v[208:211], v[20:23]
    ds_read_b64_tr_b16 v[106:107], v249 offset:256
    s_lshl_b32 s64, s64, 18
    s_add_u32 s64, s64, s69
    v_mfma_f32_16x16x32_bf16 v[24:27], v[156:159], v[212:215], v[24:27]
    ds_read_b64_tr_b16 v[108:109], v249 offset:32
    v_mfma_f32_16x16x32_bf16 v[28:31], v[156:159], v[216:219], v[28:31]
    ds_read_b64_tr_b16 v[110:111], v249 offset:288
    s_add_u32 m0, s63, 0
    v_mfma_f32_16x16x32_bf16 v[32:35], v[160:163], v[208:211], v[32:35]
    ds_read_b64_tr_b16 v[112:113], v249 offset:64
    v_mfma_f32_16x16x32_bf16 v[36:39], v[160:163], v[212:215], v[36:39]
    ds_read_b64_tr_b16 v[114:115], v249 offset:320
    buffer_load_dwordx4 v184, s[20:23], s64 offen offset:0 lds
    v_mfma_f32_16x16x32_bf16 v[40:43], v[160:163], v[216:219], v[40:43]
    ds_read_b64_tr_b16 v[116:117], v249 offset:96
    ds_read_b64_tr_b16 v[118:119], v249 offset:352
    v_mfma_f32_16x16x32_bf16 v[44:47], v[164:167], v[208:211], v[44:47]
    ds_read_b64_tr_b16 v[120:121], v249 offset:128
    buffer_load_dwordx4 v185, s[20:23], s64 offen offset:1056 lds
    v_mfma_f32_16x16x32_bf16 v[48:51], v[164:167], v[212:215], v[48:51]
    ds_read_b64_tr_b16 v[122:123], v249 offset:384
    v_mfma_f32_16x16x32_bf16 v[52:55], v[164:167], v[216:219], v[52:55]
    ds_read_b64_tr_b16 v[124:125], v249 offset:160
    buffer_load_dwordx4 v186, s[20:23], s64 offen offset:2112 lds
    v_mfma_f32_16x16x32_bf16 v[56:59], v[168:171], v[208:211], v[56:59]
    ds_read_b64_tr_b16 v[126:127], v249 offset:416
    buffer_load_dwordx4 v187, s[20:23], s64 offen offset:3168 lds
    v_mfma_f32_16x16x32_bf16 v[60:63], v[168:171], v[212:215], v[60:63]
    ds_read_b64_tr_b16 v[128:129], v249 offset:192
    v_mfma_f32_16x16x32_bf16 v[64:67], v[168:171], v[216:219], v[64:67]
    ds_read_b64_tr_b16 v[130:131], v249 offset:448
    s_add_u32 m0, s63, 4224
    v_mfma_f32_16x16x32_bf16 v[68:71], v[172:175], v[208:211], v[68:71]
    ds_read_b64_tr_b16 v[132:133], v249 offset:224
    v_mfma_f32_16x16x32_bf16 v[72:75], v[172:175], v[212:215], v[72:75]
    ds_read_b64_tr_b16 v[134:135], v249 offset:480
    buffer_load_dwordx4 v188, s[20:23], s64 offen offset:0 lds
    v_mfma_f32_16x16x32_bf16 v[76:79], v[172:175], v[216:219], v[76:79]
    v_mfma_f32_16x16x32_bf16 v[80:83], v[176:179], v[208:211], v[80:83]
    buffer_load_dwordx4 v189, s[20:23], s64 offen offset:1056 lds
    s_lshl_b32 s65, s82, 6
    v_mfma_f32_16x16x32_bf16 v[84:87], v[176:179], v[212:215], v[84:87]
    v_mfma_f32_16x16x32_bf16 v[88:91], v[176:179], v[216:219], v[88:91]
    buffer_load_dwordx4 v190, s[20:23], s64 offen offset:2112 lds
    v_xor_b32 v248, s65, v245
    v_mfma_f32_16x16x32_bf16 v[92:95], v[180:183], v[208:211], v[92:95]
    v_mfma_f32_16x16x32_bf16 v[96:99], v[180:183], v[212:215], v[96:99]
    buffer_load_dwordx4 v191, s[20:23], s64 offen offset:3168 lds
    v_add_u32 v249, s62, v2
    v_mfma_f32_16x16x32_bf16 v[100:103], v[180:183], v[216:219], v[100:103]
    s_waitcnt vmcnt(11)
    s_waitcnt lgkmcnt(0)
    s_barrier
    v_mfma_f32_16x16x32_bf16 v[8:11], v[104:107], v[136:139], v[8:11]
    ds_read_b128 v[208:211], v248 offset:6144
    ds_read_b128 v[212:215], v248 offset:8192
    s_add_u32 s64, s72, 6
    s_and_b32 s64, s64, 7
    v_mfma_f32_16x16x32_bf16 v[12:15], v[104:107], v[140:143], v[12:15]
    ds_read_b128 v[216:219], v248 offset:10240
    s_lshl_b32 s64, s64, 1
    s_add_u32 s64, s64, s82
    v_mfma_f32_16x16x32_bf16 v[16:19], v[104:107], v[144:147], v[16:19]
    ds_read_b64_tr_b16 v[152:153], v249 offset:0
    s_lshl_b32 s64, s64, 18
    s_add_u32 s64, s64, s69
    v_mfma_f32_16x16x32_bf16 v[20:23], v[108:111], v[136:139], v[20:23]
    ds_read_b64_tr_b16 v[154:155], v249 offset:256
    v_mfma_f32_16x16x32_bf16 v[24:27], v[108:111], v[140:143], v[24:27]
    ds_read_b64_tr_b16 v[156:157], v249 offset:32
    s_add_u32 m0, s7, 0
    v_mfma_f32_16x16x32_bf16 v[28:31], v[108:111], v[144:147], v[28:31]
    ds_read_b64_tr_b16 v[158:159], v249 offset:288
    buffer_load_dwordx4 v184, s[20:23], s64 offen offset:0 lds
    v_mfma_f32_16x16x32_bf16 v[32:35], v[112:115], v[136:139], v[32:35]
    ds_read_b64_tr_b16 v[160:161], v249 offset:64
    v_mfma_f32_16x16x32_bf16 v[36:39], v[112:115], v[140:143], v[36:39]
    ds_read_b64_tr_b16 v[162:163], v249 offset:320
    buffer_load_dwordx4 v185, s[20:23], s64 offen offset:1056 lds
    v_mfma_f32_16x16x32_bf16 v[40:43], v[112:115], v[144:147], v[40:43]
    ds_read_b64_tr_b16 v[164:165], v249 offset:96
    ds_read_b64_tr_b16 v[166:167], v249 offset:352
    buffer_load_dwordx4 v186, s[20:23], s64 offen offset:2112 lds
    v_mfma_f32_16x16x32_bf16 v[44:47], v[116:119], v[136:139], v[44:47]
    ds_read_b64_tr_b16 v[168:169], v249 offset:128
    buffer_load_dwordx4 v187, s[20:23], s64 offen offset:3168 lds
    v_mfma_f32_16x16x32_bf16 v[48:51], v[116:119], v[140:143], v[48:51]
    ds_read_b64_tr_b16 v[170:171], v249 offset:384
    v_mfma_f32_16x16x32_bf16 v[52:55], v[116:119], v[144:147], v[52:55]
    ds_read_b64_tr_b16 v[172:173], v249 offset:160
    s_add_u32 m0, s7, 4224
    v_mfma_f32_16x16x32_bf16 v[56:59], v[120:123], v[136:139], v[56:59]
    ds_read_b64_tr_b16 v[174:175], v249 offset:416
    buffer_load_dwordx4 v188, s[20:23], s64 offen offset:0 lds
    v_mfma_f32_16x16x32_bf16 v[60:63], v[120:123], v[140:143], v[60:63]
    ds_read_b64_tr_b16 v[176:177], v249 offset:192
    v_mfma_f32_16x16x32_bf16 v[64:67], v[120:123], v[144:147], v[64:67]
    ds_read_b64_tr_b16 v[178:179], v249 offset:448
    buffer_load_dwordx4 v189, s[20:23], s64 offen offset:1056 lds
    v_mfma_f32_16x16x32_bf16 v[68:71], v[124:127], v[136:139], v[68:71]
    ds_read_b64_tr_b16 v[180:181], v249 offset:224
    buffer_load_dwordx4 v190, s[20:23], s64 offen offset:2112 lds
    v_mfma_f32_16x16x32_bf16 v[72:75], v[124:127], v[140:143], v[72:75]
    ds_read_b64_tr_b16 v[182:183], v249 offset:480
    buffer_load_dwordx4 v191, s[20:23], s64 offen offset:3168 lds
    v_mfma_f32_16x16x32_bf16 v[76:79], v[124:127], v[144:147], v[76:79]
    v_mfma_f32_16x16x32_bf16 v[80:83], v[128:131], v[136:139], v[80:83]
    s_add_u32 s73, s72, 7
    s_and_b32 s73, s73, 7
    s_lshl_b32 s65, s83, 6
    v_mfma_f32_16x16x32_bf16 v[84:87], v[128:131], v[140:143], v[84:87]
    s_lshl_b32 s67, s73, 7
    s_add_u32 s67, s67, s71
    s_add_u32 m0, s87, 18432
    s_add_u32 s67, s67, 0
    buffer_load_dwordx4 v246, s[8:11], s67 offen lds
    v_mfma_f32_16x16x32_bf16 v[88:91], v[128:131], v[144:147], v[88:91]
    v_xor_b32 v248, s65, v245
    v_mfma_f32_16x16x32_bf16 v[92:95], v[132:135], v[136:139], v[92:95]
    s_lshl_b32 s67, s73, 7
    s_add_u32 s67, s67, s71
    s_add_u32 m0, s87, 19456
    s_add_u32 s67, s67, 8192
    buffer_load_dwordx4 v246, s[8:11], s67 offen lds
    v_mfma_f32_16x16x32_bf16 v[96:99], v[132:135], v[140:143], v[96:99]
    s_lshl_b32 s67, s73, 7
    s_add_u32 s67, s67, s71
    s_add_u32 m0, s87, 20480
    s_add_u32 s67, s67, 16384
    buffer_load_dwordx4 v246, s[8:11], s67 offen lds
    v_add_u32 v249, s63, v2
    v_mfma_f32_16x16x32_bf16 v[100:103], v[132:135], v[144:147], v[100:103]
    s_waitcnt vmcnt(11)
    s_waitcnt lgkmcnt(0)
    v_mfma_f32_16x16x32_bf16 v[8:11], v[152:155], v[208:211], v[8:11]
    ds_read_b128 v[136:139], v248 offset:6144
    ds_read_b128 v[140:143], v248 offset:8192
    s_add_u32 s64, s72, 6
    s_and_b32 s64, s64, 7
    v_mfma_f32_16x16x32_bf16 v[12:15], v[152:155], v[212:215], v[12:15]
    ds_read_b128 v[144:147], v248 offset:10240
    s_lshl_b32 s64, s64, 1
    s_add_u32 s64, s64, s83
    v_mfma_f32_16x16x32_bf16 v[16:19], v[152:155], v[216:219], v[16:19]
    ds_read_b64_tr_b16 v[104:105], v249 offset:0
    v_mfma_f32_16x16x32_bf16 v[20:23], v[156:159], v[208:211], v[20:23]
    ds_read_b64_tr_b16 v[106:107], v249 offset:256
    s_lshl_b32 s64, s64, 18
    s_add_u32 s64, s64, s69
    v_mfma_f32_16x16x32_bf16 v[24:27], v[156:159], v[212:215], v[24:27]
    ds_read_b64_tr_b16 v[108:109], v249 offset:32
    v_mfma_f32_16x16x32_bf16 v[28:31], v[156:159], v[216:219], v[28:31]
    ds_read_b64_tr_b16 v[110:111], v249 offset:288
    s_add_u32 m0, s62, 0
    v_mfma_f32_16x16x32_bf16 v[32:35], v[160:163], v[208:211], v[32:35]
    ds_read_b64_tr_b16 v[112:113], v249 offset:64
    v_mfma_f32_16x16x32_bf16 v[36:39], v[160:163], v[212:215], v[36:39]
    ds_read_b64_tr_b16 v[114:115], v249 offset:320
    buffer_load_dwordx4 v184, s[20:23], s64 offen offset:0 lds
    v_mfma_f32_16x16x32_bf16 v[40:43], v[160:163], v[216:219], v[40:43]
    ds_read_b64_tr_b16 v[116:117], v249 offset:96
    ds_read_b64_tr_b16 v[118:119], v249 offset:352
    v_mfma_f32_16x16x32_bf16 v[44:47], v[164:167], v[208:211], v[44:47]
    ds_read_b64_tr_b16 v[120:121], v249 offset:128
    buffer_load_dwordx4 v185, s[20:23], s64 offen offset:1056 lds
    v_mfma_f32_16x16x32_bf16 v[48:51], v[164:167], v[212:215], v[48:51]
    ds_read_b64_tr_b16 v[122:123], v249 offset:384
    v_mfma_f32_16x16x32_bf16 v[52:55], v[164:167], v[216:219], v[52:55]
    ds_read_b64_tr_b16 v[124:125], v249 offset:160
    buffer_load_dwordx4 v186, s[20:23], s64 offen offset:2112 lds
    v_mfma_f32_16x16x32_bf16 v[56:59], v[168:171], v[208:211], v[56:59]
    ds_read_b64_tr_b16 v[126:127], v249 offset:416
    buffer_load_dwordx4 v187, s[20:23], s64 offen offset:3168 lds
    v_mfma_f32_16x16x32_bf16 v[60:63], v[168:171], v[212:215], v[60:63]
    ds_read_b64_tr_b16 v[128:129], v249 offset:192
    v_mfma_f32_16x16x32_bf16 v[64:67], v[168:171], v[216:219], v[64:67]
    ds_read_b64_tr_b16 v[130:131], v249 offset:448
    s_add_u32 m0, s62, 4224
    v_mfma_f32_16x16x32_bf16 v[68:71], v[172:175], v[208:211], v[68:71]
    ds_read_b64_tr_b16 v[132:133], v249 offset:224
    v_mfma_f32_16x16x32_bf16 v[72:75], v[172:175], v[212:215], v[72:75]
    ds_read_b64_tr_b16 v[134:135], v249 offset:480
    buffer_load_dwordx4 v188, s[20:23], s64 offen offset:0 lds
    v_mfma_f32_16x16x32_bf16 v[76:79], v[172:175], v[216:219], v[76:79]
    v_mfma_f32_16x16x32_bf16 v[80:83], v[176:179], v[208:211], v[80:83]
    buffer_load_dwordx4 v189, s[20:23], s64 offen offset:1056 lds
    s_lshl_b32 s65, s82, 6
    v_mfma_f32_16x16x32_bf16 v[84:87], v[176:179], v[212:215], v[84:87]
    v_mfma_f32_16x16x32_bf16 v[88:91], v[176:179], v[216:219], v[88:91]
    buffer_load_dwordx4 v190, s[20:23], s64 offen offset:2112 lds
    v_xor_b32 v248, s65, v245
    v_mfma_f32_16x16x32_bf16 v[92:95], v[180:183], v[208:211], v[92:95]
    v_mfma_f32_16x16x32_bf16 v[96:99], v[180:183], v[212:215], v[96:99]
    buffer_load_dwordx4 v191, s[20:23], s64 offen offset:3168 lds
    v_add_u32 v249, s7, v2
    v_mfma_f32_16x16x32_bf16 v[100:103], v[180:183], v[216:219], v[100:103]
    s_waitcnt vmcnt(11)
    s_waitcnt lgkmcnt(0)
    s_barrier
    v_mfma_f32_16x16x32_bf16 v[8:11], v[104:107], v[136:139], v[8:11]
    ds_read_b128 v[208:211], v248 offset:12288
    ds_read_b128 v[212:215], v248 offset:14336
    s_add_u32 s64, s72, 7
    s_and_b32 s64, s64, 7
    v_mfma_f32_16x16x32_bf16 v[12:15], v[104:107], v[140:143], v[12:15]
    ds_read_b128 v[216:219], v248 offset:16384
    s_lshl_b32 s64, s64, 1
    s_add_u32 s64, s64, s82
    v_mfma_f32_16x16x32_bf16 v[16:19], v[104:107], v[144:147], v[16:19]
    ds_read_b64_tr_b16 v[152:153], v249 offset:0
    v_mfma_f32_16x16x32_bf16 v[20:23], v[108:111], v[136:139], v[20:23]
    ds_read_b64_tr_b16 v[154:155], v249 offset:256
    s_lshl_b32 s64, s64, 18
    s_add_u32 s64, s64, s69
    v_mfma_f32_16x16x32_bf16 v[24:27], v[108:111], v[140:143], v[24:27]
    ds_read_b64_tr_b16 v[156:157], v249 offset:32
    v_mfma_f32_16x16x32_bf16 v[28:31], v[108:111], v[144:147], v[28:31]
    ds_read_b64_tr_b16 v[158:159], v249 offset:288
    s_add_u32 m0, s63, 0
    v_mfma_f32_16x16x32_bf16 v[32:35], v[112:115], v[136:139], v[32:35]
    ds_read_b64_tr_b16 v[160:161], v249 offset:64
    v_mfma_f32_16x16x32_bf16 v[36:39], v[112:115], v[140:143], v[36:39]
    ds_read_b64_tr_b16 v[162:163], v249 offset:320
    buffer_load_dwordx4 v184, s[20:23], s64 offen offset:0 lds
    v_mfma_f32_16x16x32_bf16 v[40:43], v[112:115], v[144:147], v[40:43]
    ds_read_b64_tr_b16 v[164:165], v249 offset:96
    ds_read_b64_tr_b16 v[166:167], v249 offset:352
    v_mfma_f32_16x16x32_bf16 v[44:47], v[116:119], v[136:139], v[44:47]
    ds_read_b64_tr_b16 v[168:169], v249 offset:128
    buffer_load_dwordx4 v185, s[20:23], s64 offen offset:1056 lds
    v_mfma_f32_16x16x32_bf16 v[48:51], v[116:119], v[140:143], v[48:51]
    ds_read_b64_tr_b16 v[170:171], v249 offset:384
    v_mfma_f32_16x16x32_bf16 v[52:55], v[116:119], v[144:147], v[52:55]
    ds_read_b64_tr_b16 v[172:173], v249 offset:160
    buffer_load_dwordx4 v186, s[20:23], s64 offen offset:2112 lds
    v_mfma_f32_16x16x32_bf16 v[56:59], v[120:123], v[136:139], v[56:59]
    ds_read_b64_tr_b16 v[174:175], v249 offset:416
    buffer_load_dwordx4 v187, s[20:23], s64 offen offset:3168 lds
    v_mfma_f32_16x16x32_bf16 v[60:63], v[120:123], v[140:143], v[60:63]
    ds_read_b64_tr_b16 v[176:177], v249 offset:192
    v_mfma_f32_16x16x32_bf16 v[64:67], v[120:123], v[144:147], v[64:67]
    ds_read_b64_tr_b16 v[178:179], v249 offset:448
    s_add_u32 m0, s63, 4224
    v_mfma_f32_16x16x32_bf16 v[68:71], v[124:127], v[136:139], v[68:71]
    ds_read_b64_tr_b16 v[180:181], v249 offset:224
    v_mfma_f32_16x16x32_bf16 v[72:75], v[124:127], v[140:143], v[72:75]
    ds_read_b64_tr_b16 v[182:183], v249 offset:480
    buffer_load_dwordx4 v188, s[20:23], s64 offen offset:0 lds
    v_mfma_f32_16x16x32_bf16 v[76:79], v[124:127], v[144:147], v[76:79]
    v_mfma_f32_16x16x32_bf16 v[80:83], v[128:131], v[136:139], v[80:83]
    buffer_load_dwordx4 v189, s[20:23], s64 offen offset:1056 lds
    s_lshl_b32 s65, s83, 6
    v_mfma_f32_16x16x32_bf16 v[84:87], v[128:131], v[140:143], v[84:87]
    v_mfma_f32_16x16x32_bf16 v[88:91], v[128:131], v[144:147], v[88:91]
    buffer_load_dwordx4 v190, s[20:23], s64 offen offset:2112 lds
    v_xor_b32 v248, s65, v245
    v_mfma_f32_16x16x32_bf16 v[92:95], v[132:135], v[136:139], v[92:95]
    v_mfma_f32_16x16x32_bf16 v[96:99], v[132:135], v[140:143], v[96:99]
    buffer_load_dwordx4 v191, s[20:23], s64 offen offset:3168 lds
    v_add_u32 v249, s62, v2
    v_mfma_f32_16x16x32_bf16 v[100:103], v[132:135], v[144:147], v[100:103]
    s_waitcnt vmcnt(8)
    s_waitcnt lgkmcnt(0)
    v_mfma_f32_16x16x32_bf16 v[8:11], v[152:155], v[208:211], v[8:11]
    ds_read_b128 v[136:139], v248 offset:12288
    ds_read_b128 v[140:143], v248 offset:14336
    s_add_u32 s64, s72, 7
    s_and_b32 s64, s64, 7
    v_mfma_f32_16x16x32_bf16 v[12:15], v[152:155], v[212:215], v[12:15]
    ds_read_b128 v[144:147], v248 offset:16384
    s_lshl_b32 s64, s64, 1
    s_add_u32 s64, s64, s83
    v_mfma_f32_16x16x32_bf16 v[16:19], v[152:155], v[216:219], v[16:19]
    ds_read_b64_tr_b16 v[104:105], v249 offset:0
    v_mfma_f32_16x16x32_bf16 v[20:23], v[156:159], v[208:211], v[20:23]
    ds_read_b64_tr_b16 v[106:107], v249 offset:256
    s_lshl_b32 s64, s64, 18
    s_add_u32 s64, s64, s69
    v_mfma_f32_16x16x32_bf16 v[24:27], v[156:159], v[212:215], v[24:27]
    ds_read_b64_tr_b16 v[108:109], v249 offset:32
    v_mfma_f32_16x16x32_bf16 v[28:31], v[156:159], v[216:219], v[28:31]
    ds_read_b64_tr_b16 v[110:111], v249 offset:288
    s_add_u32 m0, s7, 0
    v_mfma_f32_16x16x32_bf16 v[32:35], v[160:163], v[208:211], v[32:35]
    ds_read_b64_tr_b16 v[112:113], v249 offset:64
    v_mfma_f32_16x16x32_bf16 v[36:39], v[160:163], v[212:215], v[36:39]
    ds_read_b64_tr_b16 v[114:115], v249 offset:320
    buffer_load_dwordx4 v184, s[20:23], s64 offen offset:0 lds
    v_mfma_f32_16x16x32_bf16 v[40:43], v[160:163], v[216:219], v[40:43]
    ds_read_b64_tr_b16 v[116:117], v249 offset:96
    ds_read_b64_tr_b16 v[118:119], v249 offset:352
    v_mfma_f32_16x16x32_bf16 v[44:47], v[164:167], v[208:211], v[44:47]
    ds_read_b64_tr_b16 v[120:121], v249 offset:128
    buffer_load_dwordx4 v185, s[20:23], s64 offen offset:1056 lds
    v_mfma_f32_16x16x32_bf16 v[48:51], v[164:167], v[212:215], v[48:51]
    ds_read_b64_tr_b16 v[122:123], v249 offset:384
    v_mfma_f32_16x16x32_bf16 v[52:55], v[164:167], v[216:219], v[52:55]
    ds_read_b64_tr_b16 v[124:125], v249 offset:160
    buffer_load_dwordx4 v186, s[20:23], s64 offen offset:2112 lds
    v_mfma_f32_16x16x32_bf16 v[56:59], v[168:171], v[208:211], v[56:59]
    ds_read_b64_tr_b16 v[126:127], v249 offset:416
    buffer_load_dwordx4 v187, s[20:23], s64 offen offset:3168 lds
    v_mfma_f32_16x16x32_bf16 v[60:63], v[168:171], v[212:215], v[60:63]
    ds_read_b64_tr_b16 v[128:129], v249 offset:192
    v_mfma_f32_16x16x32_bf16 v[64:67], v[168:171], v[216:219], v[64:67]
    ds_read_b64_tr_b16 v[130:131], v249 offset:448
    s_add_u32 m0, s7, 4224
    v_mfma_f32_16x16x32_bf16 v[68:71], v[172:175], v[208:211], v[68:71]
    ds_read_b64_tr_b16 v[132:133], v249 offset:224
    v_mfma_f32_16x16x32_bf16 v[72:75], v[172:175], v[212:215], v[72:75]
    ds_read_b64_tr_b16 v[134:135], v249 offset:480
    buffer_load_dwordx4 v188, s[20:23], s64 offen offset:0 lds
    v_mfma_f32_16x16x32_bf16 v[76:79], v[172:175], v[216:219], v[76:79]
    v_mfma_f32_16x16x32_bf16 v[80:83], v[176:179], v[208:211], v[80:83]
    buffer_load_dwordx4 v189, s[20:23], s64 offen offset:1056 lds
    s_lshl_b32 s65, s82, 6
    v_mfma_f32_16x16x32_bf16 v[84:87], v[176:179], v[212:215], v[84:87]
    v_mfma_f32_16x16x32_bf16 v[88:91], v[176:179], v[216:219], v[88:91]
    buffer_load_dwordx4 v190, s[20:23], s64 offen offset:2112 lds
    v_xor_b32 v248, s65, v245
    v_mfma_f32_16x16x32_bf16 v[92:95], v[180:183], v[208:211], v[92:95]
    v_mfma_f32_16x16x32_bf16 v[96:99], v[180:183], v[212:215], v[96:99]
    buffer_load_dwordx4 v191, s[20:23], s64 offen offset:3168 lds
    v_add_u32 v249, s63, v2
    v_mfma_f32_16x16x32_bf16 v[100:103], v[180:183], v[216:219], v[100:103]
    s_waitcnt vmcnt(8)
    s_waitcnt lgkmcnt(0)
    s_barrier
    v_mfma_f32_16x16x32_bf16 v[8:11], v[104:107], v[136:139], v[8:11]
    ds_read_b128 v[208:211], v248 offset:18432
    ds_read_b128 v[212:215], v248 offset:20480
    v_mfma_f32_16x16x32_bf16 v[12:15], v[104:107], v[140:143], v[12:15]
    ds_read_b128 v[216:219], v248 offset:22528
    v_mfma_f32_16x16x32_bf16 v[16:19], v[104:107], v[144:147], v[16:19]
    ds_read_b64_tr_b16 v[152:153], v249 offset:0
    v_mfma_f32_16x16x32_bf16 v[20:23], v[108:111], v[136:139], v[20:23]
    ds_read_b64_tr_b16 v[154:155], v249 offset:256
    v_mfma_f32_16x16x32_bf16 v[24:27], v[108:111], v[140:143], v[24:27]
    ds_read_b64_tr_b16 v[156:157], v249 offset:32
    v_mfma_f32_16x16x32_bf16 v[28:31], v[108:111], v[144:147], v[28:31]
    ds_read_b64_tr_b16 v[158:159], v249 offset:288
    v_mfma_f32_16x16x32_bf16 v[32:35], v[112:115], v[136:139], v[32:35]
    ds_read_b64_tr_b16 v[160:161], v249 offset:64
    v_mfma_f32_16x16x32_bf16 v[36:39], v[112:115], v[140:143], v[36:39]
    ds_read_b64_tr_b16 v[162:163], v249 offset:320
    v_mfma_f32_16x16x32_bf16 v[40:43], v[112:115], v[144:147], v[40:43]
    ds_read_b64_tr_b16 v[164:165], v249 offset:96
    ds_read_b64_tr_b16 v[166:167], v249 offset:352
    v_mfma_f32_16x16x32_bf16 v[44:47], v[116:119], v[136:139], v[44:47]
    ds_read_b64_tr_b16 v[168:169], v249 offset:128
    v_mfma_f32_16x16x32_bf16 v[48:51], v[116:119], v[140:143], v[48:51]
    ds_read_b64_tr_b16 v[170:171], v249 offset:384
    v_mfma_f32_16x16x32_bf16 v[52:55], v[116:119], v[144:147], v[52:55]
    ds_read_b64_tr_b16 v[172:173], v249 offset:160
    v_mfma_f32_16x16x32_bf16 v[56:59], v[120:123], v[136:139], v[56:59]
    ds_read_b64_tr_b16 v[174:175], v249 offset:416
    v_mfma_f32_16x16x32_bf16 v[60:63], v[120:123], v[140:143], v[60:63]
    ds_read_b64_tr_b16 v[176:177], v249 offset:192
    v_mfma_f32_16x16x32_bf16 v[64:67], v[120:123], v[144:147], v[64:67]
    ds_read_b64_tr_b16 v[178:179], v249 offset:448
    v_mfma_f32_16x16x32_bf16 v[68:71], v[124:127], v[136:139], v[68:71]
    ds_read_b64_tr_b16 v[180:181], v249 offset:224
    v_mfma_f32_16x16x32_bf16 v[72:75], v[124:127], v[140:143], v[72:75]
    ds_read_b64_tr_b16 v[182:183], v249 offset:480
    v_mfma_f32_16x16x32_bf16 v[76:79], v[124:127], v[144:147], v[76:79]
    v_mfma_f32_16x16x32_bf16 v[80:83], v[128:131], v[136:139], v[80:83]
    s_lshl_b32 s65, s83, 6
    v_mfma_f32_16x16x32_bf16 v[84:87], v[128:131], v[140:143], v[84:87]
    v_mfma_f32_16x16x32_bf16 v[88:91], v[128:131], v[144:147], v[88:91]
    v_xor_b32 v248, s65, v245
    v_mfma_f32_16x16x32_bf16 v[92:95], v[132:135], v[136:139], v[92:95]
    v_mfma_f32_16x16x32_bf16 v[96:99], v[132:135], v[140:143], v[96:99]
    v_add_u32 v249, s7, v2
    v_mfma_f32_16x16x32_bf16 v[100:103], v[132:135], v[144:147], v[100:103]
    s_waitcnt vmcnt(0)
    s_waitcnt lgkmcnt(0)
    v_mfma_f32_16x16x32_bf16 v[8:11], v[152:155], v[208:211], v[8:11]
    ds_read_b128 v[136:139], v248 offset:18432
    ds_read_b128 v[140:143], v248 offset:20480
    v_mfma_f32_16x16x32_bf16 v[12:15], v[152:155], v[212:215], v[12:15]
    ds_read_b128 v[144:147], v248 offset:22528
    v_mfma_f32_16x16x32_bf16 v[16:19], v[152:155], v[216:219], v[16:19]
    ds_read_b64_tr_b16 v[104:105], v249 offset:0
    v_mfma_f32_16x16x32_bf16 v[20:23], v[156:159], v[208:211], v[20:23]
    ds_read_b64_tr_b16 v[106:107], v249 offset:256
    v_mfma_f32_16x16x32_bf16 v[24:27], v[156:159], v[212:215], v[24:27]
    ds_read_b64_tr_b16 v[108:109], v249 offset:32
    v_mfma_f32_16x16x32_bf16 v[28:31], v[156:159], v[216:219], v[28:31]
    ds_read_b64_tr_b16 v[110:111], v249 offset:288
    v_mfma_f32_16x16x32_bf16 v[32:35], v[160:163], v[208:211], v[32:35]
    ds_read_b64_tr_b16 v[112:113], v249 offset:64
    v_mfma_f32_16x16x32_bf16 v[36:39], v[160:163], v[212:215], v[36:39]
    ds_read_b64_tr_b16 v[114:115], v249 offset:320
    v_mfma_f32_16x16x32_bf16 v[40:43], v[160:163], v[216:219], v[40:43]
    ds_read_b64_tr_b16 v[116:117], v249 offset:96
    ds_read_b64_tr_b16 v[118:119], v249 offset:352
    v_mfma_f32_16x16x32_bf16 v[44:47], v[164:167], v[208:211], v[44:47]
    ds_read_b64_tr_b16 v[120:121], v249 offset:128
    v_mfma_f32_16x16x32_bf16 v[48:51], v[164:167], v[212:215], v[48:51]
    ds_read_b64_tr_b16 v[122:123], v249 offset:384
    v_mfma_f32_16x16x32_bf16 v[52:55], v[164:167], v[216:219], v[52:55]
    ds_read_b64_tr_b16 v[124:125], v249 offset:160
    v_mfma_f32_16x16x32_bf16 v[56:59], v[168:171], v[208:211], v[56:59]
    ds_read_b64_tr_b16 v[126:127], v249 offset:416
    v_mfma_f32_16x16x32_bf16 v[60:63], v[168:171], v[212:215], v[60:63]
    ds_read_b64_tr_b16 v[128:129], v249 offset:192
    v_mfma_f32_16x16x32_bf16 v[64:67], v[168:171], v[216:219], v[64:67]
    ds_read_b64_tr_b16 v[130:131], v249 offset:448
    v_mfma_f32_16x16x32_bf16 v[68:71], v[172:175], v[208:211], v[68:71]
    ds_read_b64_tr_b16 v[132:133], v249 offset:224
    v_mfma_f32_16x16x32_bf16 v[72:75], v[172:175], v[212:215], v[72:75]
    ds_read_b64_tr_b16 v[134:135], v249 offset:480
    v_mfma_f32_16x16x32_bf16 v[76:79], v[172:175], v[216:219], v[76:79]
    v_mfma_f32_16x16x32_bf16 v[80:83], v[176:179], v[208:211], v[80:83]
    v_mfma_f32_16x16x32_bf16 v[84:87], v[176:179], v[212:215], v[84:87]
    v_mfma_f32_16x16x32_bf16 v[88:91], v[176:179], v[216:219], v[88:91]
    v_mfma_f32_16x16x32_bf16 v[92:95], v[180:183], v[208:211], v[92:95]
    v_mfma_f32_16x16x32_bf16 v[96:99], v[180:183], v[212:215], v[96:99]
    v_mfma_f32_16x16x32_bf16 v[100:103], v[180:183], v[216:219], v[100:103]
    s_waitcnt lgkmcnt(0)
    s_barrier
    v_mfma_f32_16x16x32_bf16 v[8:11], v[104:107], v[136:139], v[8:11]
    v_mfma_f32_16x16x32_bf16 v[12:15], v[104:107], v[140:143], v[12:15]
    v_mfma_f32_16x16x32_bf16 v[16:19], v[104:107], v[144:147], v[16:19]
    v_mfma_f32_16x16x32_bf16 v[20:23], v[108:111], v[136:139], v[20:23]
    v_mfma_f32_16x16x32_bf16 v[24:27], v[108:111], v[140:143], v[24:27]
    v_mfma_f32_16x16x32_bf16 v[28:31], v[108:111], v[144:147], v[28:31]
    v_mfma_f32_16x16x32_bf16 v[32:35], v[112:115], v[136:139], v[32:35]
    v_mfma_f32_16x16x32_bf16 v[36:39], v[112:115], v[140:143], v[36:39]
    v_mfma_f32_16x16x32_bf16 v[40:43], v[112:115], v[144:147], v[40:43]
    v_mfma_f32_16x16x32_bf16 v[44:47], v[116:119], v[136:139], v[44:47]
    v_mfma_f32_16x16x32_bf16 v[48:51], v[116:119], v[140:143], v[48:51]
    v_mfma_f32_16x16x32_bf16 v[52:55], v[116:119], v[144:147], v[52:55]
    v_mfma_f32_16x16x32_bf16 v[56:59], v[120:123], v[136:139], v[56:59]
    v_mfma_f32_16x16x32_bf16 v[60:63], v[120:123], v[140:143], v[60:63]
    v_mfma_f32_16x16x32_bf16 v[64:67], v[120:123], v[144:147], v[64:67]
    v_mfma_f32_16x16x32_bf16 v[68:71], v[124:127], v[136:139], v[68:71]
    v_mfma_f32_16x16x32_bf16 v[72:75], v[124:127], v[140:143], v[72:75]
    v_mfma_f32_16x16x32_bf16 v[76:79], v[124:127], v[144:147], v[76:79]
    v_mfma_f32_16x16x32_bf16 v[80:83], v[128:131], v[136:139], v[80:83]
    v_mfma_f32_16x16x32_bf16 v[84:87], v[128:131], v[140:143], v[84:87]
    v_mfma_f32_16x16x32_bf16 v[88:91], v[128:131], v[144:147], v[88:91]
    v_mfma_f32_16x16x32_bf16 v[92:95], v[132:135], v[136:139], v[92:95]
    v_mfma_f32_16x16x32_bf16 v[96:99], v[132:135], v[140:143], v[96:99]
    v_mfma_f32_16x16x32_bf16 v[100:103], v[132:135], v[144:147], v[100:103]
    s_nop 7
    v_pk_mul_f32 v[8:9], v[8:9], s[88:89] op_sel_hi:[1,0]
    v_pk_mul_f32 v[10:11], v[10:11], s[88:89] op_sel_hi:[1,0]
    v_pk_mul_f32 v[12:13], v[12:13], s[88:89] op_sel_hi:[1,0]
    v_pk_mul_f32 v[14:15], v[14:15], s[88:89] op_sel_hi:[1,0]
    v_pk_mul_f32 v[16:17], v[16:17], s[88:89] op_sel_hi:[1,0]
    v_pk_mul_f32 v[18:19], v[18:19], s[88:89] op_sel_hi:[1,0]
    v_pk_mul_f32 v[20:21], v[20:21], s[88:89] op_sel_hi:[1,0]
    v_pk_mul_f32 v[22:23], v[22:23], s[88:89] op_sel_hi:[1,0]
    v_pk_mul_f32 v[24:25], v[24:25], s[88:89] op_sel_hi:[1,0]
    v_pk_mul_f32 v[26:27], v[26:27], s[88:89] op_sel_hi:[1,0]
    v_pk_mul_f32 v[28:29], v[28:29], s[88:89] op_sel_hi:[1,0]
    v_pk_mul_f32 v[30:31], v[30:31], s[88:89] op_sel_hi:[1,0]
    v_pk_mul_f32 v[32:33], v[32:33], s[88:89] op_sel_hi:[1,0]
    v_pk_mul_f32 v[34:35], v[34:35], s[88:89] op_sel_hi:[1,0]
    v_pk_mul_f32 v[36:37], v[36:37], s[88:89] op_sel_hi:[1,0]
    v_pk_mul_f32 v[38:39], v[38:39], s[88:89] op_sel_hi:[1,0]
    v_pk_mul_f32 v[40:41], v[40:41], s[88:89] op_sel_hi:[1,0]
    v_pk_mul_f32 v[42:43], v[42:43], s[88:89] op_sel_hi:[1,0]
    v_pk_mul_f32 v[44:45], v[44:45], s[88:89] op_sel_hi:[1,0]
    v_pk_mul_f32 v[46:47], v[46:47], s[88:89] op_sel_hi:[1,0]
    v_pk_mul_f32 v[48:49], v[48:49], s[88:89] op_sel_hi:[1,0]
    v_pk_mul_f32 v[50:51], v[50:51], s[88:89] op_sel_hi:[1,0]
    v_pk_mul_f32 v[52:53], v[52:53], s[88:89] op_sel_hi:[1,0]
    v_pk_mul_f32 v[54:55], v[54:55], s[88:89] op_sel_hi:[1,0]
    v_pk_mul_f32 v[56:57], v[56:57], s[88:89] op_sel_hi:[1,0]
    v_pk_mul_f32 v[58:59], v[58:59], s[88:89] op_sel_hi:[1,0]
    v_pk_mul_f32 v[60:61], v[60:61], s[88:89] op_sel_hi:[1,0]
    v_pk_mul_f32 v[62:63], v[62:63], s[88:89] op_sel_hi:[1,0]
    v_pk_mul_f32 v[64:65], v[64:65], s[88:89] op_sel_hi:[1,0]
    v_pk_mul_f32 v[66:67], v[66:67], s[88:89] op_sel_hi:[1,0]
    v_pk_mul_f32 v[68:69], v[68:69], s[88:89] op_sel_hi:[1,0]
    v_pk_mul_f32 v[70:71], v[70:71], s[88:89] op_sel_hi:[1,0]
    v_pk_mul_f32 v[72:73], v[72:73], s[88:89] op_sel_hi:[1,0]
    v_pk_mul_f32 v[74:75], v[74:75], s[88:89] op_sel_hi:[1,0]
    v_pk_mul_f32 v[76:77], v[76:77], s[88:89] op_sel_hi:[1,0]
    v_pk_mul_f32 v[78:79], v[78:79], s[88:89] op_sel_hi:[1,0]
    v_pk_mul_f32 v[80:81], v[80:81], s[88:89] op_sel_hi:[1,0]
    v_pk_mul_f32 v[82:83], v[82:83], s[88:89] op_sel_hi:[1,0]
    v_pk_mul_f32 v[84:85], v[84:85], s[88:89] op_sel_hi:[1,0]
    v_pk_mul_f32 v[86:87], v[86:87], s[88:89] op_sel_hi:[1,0]
    v_pk_mul_f32 v[88:89], v[88:89], s[88:89] op_sel_hi:[1,0]
    v_pk_mul_f32 v[90:91], v[90:91], s[88:89] op_sel_hi:[1,0]
    v_pk_mul_f32 v[92:93], v[92:93], s[88:89] op_sel_hi:[1,0]
    v_pk_mul_f32 v[94:95], v[94:95], s[88:89] op_sel_hi:[1,0]
    v_pk_mul_f32 v[96:97], v[96:97], s[88:89] op_sel_hi:[1,0]
    v_pk_mul_f32 v[98:99], v[98:99], s[88:89] op_sel_hi:[1,0]
    v_pk_mul_f32 v[100:101], v[100:101], s[88:89] op_sel_hi:[1,0]
    v_pk_mul_f32 v[102:103], v[102:103], s[88:89] op_sel_hi:[1,0]
    v_cvt_pk_bf16_f32 v104, v8, v9
    v_cvt_pk_bf16_f32 v105, v10, v11
    v_cvt_pk_bf16_f32 v106, v20, v21
    v_cvt_pk_bf16_f32 v107, v22, v23
    v_cvt_pk_bf16_f32 v108, v12, v13
    v_cvt_pk_bf16_f32 v109, v14, v15
    v_cvt_pk_bf16_f32 v110, v24, v25
    v_cvt_pk_bf16_f32 v111, v26, v27
    v_cvt_pk_bf16_f32 v112, v16, v17
    v_cvt_pk_bf16_f32 v113, v18, v19
    v_cvt_pk_bf16_f32 v114, v28, v29
    v_cvt_pk_bf16_f32 v115, v30, v31
    v_cvt_pk_bf16_f32 v116, v32, v33
    v_cvt_pk_bf16_f32 v117, v34, v35
    v_cvt_pk_bf16_f32 v118, v44, v45
    v_cvt_pk_bf16_f32 v119, v46, v47
    v_cvt_pk_bf16_f32 v120, v36, v37
    v_cvt_pk_bf16_f32 v121, v38, v39
    v_cvt_pk_bf16_f32 v122, v48, v49
    v_cvt_pk_bf16_f32 v123, v50, v51
    v_cvt_pk_bf16_f32 v124, v40, v41
    v_cvt_pk_bf16_f32 v125, v42, v43
    v_cvt_pk_bf16_f32 v126, v52, v53
    v_cvt_pk_bf16_f32 v127, v54, v55
    v_cvt_pk_bf16_f32 v128, v56, v57
    v_cvt_pk_bf16_f32 v129, v58, v59
    v_cvt_pk_bf16_f32 v130, v68, v69
    v_cvt_pk_bf16_f32 v131, v70, v71
    v_cvt_pk_bf16_f32 v132, v60, v61
    v_cvt_pk_bf16_f32 v133, v62, v63
    v_cvt_pk_bf16_f32 v134, v72, v73
    v_cvt_pk_bf16_f32 v135, v74, v75
    v_cvt_pk_bf16_f32 v136, v64, v65
    v_cvt_pk_bf16_f32 v137, v66, v67
    v_cvt_pk_bf16_f32 v138, v76, v77
    v_cvt_pk_bf16_f32 v139, v78, v79
    v_cvt_pk_bf16_f32 v140, v80, v81
    v_cvt_pk_bf16_f32 v141, v82, v83
    v_cvt_pk_bf16_f32 v142, v92, v93
    v_cvt_pk_bf16_f32 v143, v94, v95
    v_cvt_pk_bf16_f32 v144, v84, v85
    v_cvt_pk_bf16_f32 v145, v86, v87
    v_cvt_pk_bf16_f32 v146, v96, v97
    v_cvt_pk_bf16_f32 v147, v98, v99
    v_cvt_pk_bf16_f32 v148, v88, v89
    v_cvt_pk_bf16_f32 v149, v90, v91
    v_cvt_pk_bf16_f32 v150, v100, v101
    v_cvt_pk_bf16_f32 v151, v102, v103
    v_permlane32_swap_b32 v104, v106
    v_permlane32_swap_b32 v105, v107
    v_permlane32_swap_b32 v108, v110
    v_permlane32_swap_b32 v109, v111
    v_permlane32_swap_b32 v112, v114
    v_permlane32_swap_b32 v113, v115
    v_permlane32_swap_b32 v116, v118
    v_permlane32_swap_b32 v117, v119
    v_permlane32_swap_b32 v120, v122
    v_permlane32_swap_b32 v121, v123
    v_permlane32_swap_b32 v124, v126
    v_permlane32_swap_b32 v125, v127
    v_permlane32_swap_b32 v128, v130
    v_permlane32_swap_b32 v129, v131
    v_permlane32_swap_b32 v132, v134
    v_permlane32_swap_b32 v133, v135
    v_permlane32_swap_b32 v136, v138
    v_permlane32_swap_b32 v137, v139
    v_permlane32_swap_b32 v140, v142
    v_permlane32_swap_b32 v141, v143
    v_permlane32_swap_b32 v144, v146
    v_permlane32_swap_b32 v145, v147
    v_permlane32_swap_b32 v148, v150
    v_permlane32_swap_b32 v149, v151
    v_permlane16_swap_b32 v104, v106
    v_permlane16_swap_b32 v105, v107
    v_permlane16_swap_b32 v108, v110
    v_permlane16_swap_b32 v109, v111
    v_permlane16_swap_b32 v112, v114
    v_permlane16_swap_b32 v113, v115
    v_permlane16_swap_b32 v116, v118
    v_permlane16_swap_b32 v117, v119
    v_permlane16_swap_b32 v120, v122
    v_permlane16_swap_b32 v121, v123
    v_permlane16_swap_b32 v124, v126
    v_permlane16_swap_b32 v125, v127
    v_permlane16_swap_b32 v128, v130
    v_permlane16_swap_b32 v129, v131
    v_permlane16_swap_b32 v132, v134
    v_permlane16_swap_b32 v133, v135
    v_permlane16_swap_b32 v136, v138
    v_permlane16_swap_b32 v137, v139
    v_permlane16_swap_b32 v140, v142
    v_permlane16_swap_b32 v141, v143
    v_permlane16_swap_b32 v144, v146
    v_permlane16_swap_b32 v145, v147
    v_permlane16_swap_b32 v148, v150
    v_permlane16_swap_b32 v149, v151
    s_lshl_b32 s65, s2, 2
    s_add_u32 s65, s65, s6
    s_lshl_b32 s62, s65, 17
    s_and_b32 s63, s65, 15
    s_lshl_b32 s74, s2, 17
    s_lshl_b32 s65, s6, 13
    s_add_u32 s74, s74, s65
    s_mul_i32 s89, s2, 3
    s_add_u32 s89, s89, s4
    s_and_b32 s89, s89, 7
    s_mov_b32 s8, s38
    s_mov_b32 s9, s39
    s_mov_b32 s10, 0x2000000
    s_sub_u32 s65, s76, 16896
    v_add_u32 v2, s65, v2
    v_add_u32 v3, s65, v3
    s_lshl_b32 s70, s5, 19
    s_lshl_b32 s66, s6, 9
    s_add_u32 s70, s70, s66
    s_and_b32 s86, s4, 7
    v_mov_b32 v8, 0
    v_mov_b32 v9, 0
    v_mov_b32 v10, 0
    v_mov_b32 v11, 0
    v_mov_b32 v12, 0
    v_mov_b32 v13, 0
    v_mov_b32 v14, 0
    v_mov_b32 v15, 0
    v_mov_b32 v16, 0
    v_mov_b32 v17, 0
    v_mov_b32 v18, 0
    v_mov_b32 v19, 0
    v_mov_b32 v20, 0
    v_mov_b32 v21, 0
    v_mov_b32 v22, 0
    v_mov_b32 v23, 0
    v_mov_b32 v24, 0
    v_mov_b32 v25, 0
    v_mov_b32 v26, 0
    v_mov_b32 v27, 0
    v_mov_b32 v28, 0
    v_mov_b32 v29, 0
    v_mov_b32 v30, 0
    v_mov_b32 v31, 0
    v_mov_b32 v32, 0
    v_mov_b32 v33, 0
    v_mov_b32 v34, 0
    v_mov_b32 v35, 0
    v_mov_b32 v36, 0
    v_mov_b32 v37, 0
    v_mov_b32 v38, 0
    v_mov_b32 v39, 0
    v_mov_b32 v40, 0
    v_mov_b32 v41, 0
    v_mov_b32 v42, 0
    v_mov_b32 v43, 0
    v_mov_b32 v44, 0
    v_mov_b32 v45, 0
    v_mov_b32 v46, 0
    v_mov_b32 v47, 0
    v_mov_b32 v48, 0
    v_mov_b32 v49, 0
    v_mov_b32 v50, 0
    v_mov_b32 v51, 0
    v_mov_b32 v52, 0
    v_mov_b32 v53, 0
    v_mov_b32 v54, 0
    v_mov_b32 v55, 0
    v_mov_b32 v56, 0
    v_mov_b32 v57, 0
    v_mov_b32 v58, 0
    v_mov_b32 v59, 0
    v_mov_b32 v60, 0
    v_mov_b32 v61, 0
    v_mov_b32 v62, 0
    v_mov_b32 v63, 0
    v_mov_b32 v64, 0
    v_mov_b32 v65, 0
    v_mov_b32 v66, 0
    v_mov_b32 v67, 0
    v_mov_b32 v68, 0
    v_mov_b32 v69, 0
    v_mov_b32 v70, 0
    v_mov_b32 v71, 0
    v_mov_b32 v72, 0
    v_mov_b32 v73, 0
    v_mov_b32 v74, 0
    v_mov_b32 v75, 0
    v_mov_b32 v76, 0
    v_mov_b32 v77, 0
    v_mov_b32 v78, 0
    v_mov_b32 v79, 0
    v_mov_b32 v80, 0
    v_mov_b32 v81, 0
    v_mov_b32 v82, 0
    v_mov_b32 v83, 0
    v_mov_b32 v84, 0
    v_mov_b32 v85, 0
    v_mov_b32 v86, 0
    v_mov_b32 v87, 0
    v_mov_b32 v88, 0
    v_mov_b32 v89, 0
    v_mov_b32 v90, 0
    v_mov_b32 v91, 0
    v_mov_b32 v92, 0
    v_mov_b32 v93, 0
    v_mov_b32 v94, 0
    v_mov_b32 v95, 0
    v_mov_b32 v96, 0
    v_mov_b32 v97, 0
    v_mov_b32 v98, 0
    v_mov_b32 v99, 0
    v_mov_b32 v100, 0
    v_mov_b32 v101, 0
    v_mov_b32 v102, 0
    v_mov_b32 v103, 0
    v_mov_b32 v220, 0
    v_mov_b32 v221, 0
    v_mov_b32 v222, 0
    v_mov_b32 v223, 0
    v_mov_b32 v224, 0
    v_mov_b32 v225, 0
    v_mov_b32 v226, 0
    v_mov_b32 v227, 0
    v_mov_b32 v228, 0
    v_mov_b32 v229, 0
    v_mov_b32 v230, 0
    v_mov_b32 v231, 0
    v_mov_b32 v232, 0
    v_mov_b32 v233, 0
    v_mov_b32 v234, 0
    v_mov_b32 v235, 0
    v_mov_b32 v236, 0
    v_mov_b32 v237, 0
    v_mov_b32 v238, 0
    v_mov_b32 v239, 0
    v_mov_b32 v240, 0
    v_mov_b32 v241, 0
    v_mov_b32 v242, 0
    v_mov_b32 v243, 0
    v_mov_b32 v244, 0x3f803f80
    v_mov_b32 v245, 0x3f803f80
    v_mov_b32 v246, 0x3f803f80
    v_mov_b32 v247, 0x3f803f80
    s_mov_b32 s77, 0xff61b1e6
    s_mov_b32 s1, 0
    s_mov_b32 s7, 0x40004000
    s_barrier
    s_call_b64 s[80:81], L_tile
    v_add_u32 v2, 33792, v2
    v_add_u32 v3, 33792, v3
    s_barrier
    s_add_u32 s64, s63, 3
    s_and_b32 s64, s64, 15
    s_lshl_b32 s64, s64, 13
    s_add_u32 s64, s64, s62
    s_add_u32 m0, s76, 0
    s_nop 0
    buffer_load_dwordx4 v4, s[12:15], s64 offen offset:0 nt lds
    s_add_u32 m0, s76, 800
    s_nop 0
    buffer_load_dwordx4 v4, s[12:15], s64 offen offset:256 nt lds
    s_add_u32 m0, s76, 1600
    s_nop 0
    buffer_load_dwordx4 v4, s[12:15], s64 offen offset:512 nt lds
    s_add_u32 m0, s76, 2400
    s_nop 0
    buffer_load_dwordx4 v4, s[12:15], s64 offen offset:768 nt lds
    s_add_u32 m0, s76, 3200
    s_nop 0
    buffer_load_dwordx4 v5, s[12:15], s64 offen offset:1024 nt lds
    s_add_u32 m0, s76, 4000
    s_nop 0
    buffer_load_dwordx4 v5, s[12:15], s64 offen offset:1280 nt lds
    s_add_u32 m0, s76, 4800
    s_nop 0
    buffer_load_dwordx4 v5, s[12:15], s64 offen offset:1536 nt lds
    s_add_u32 m0, s76, 5600
    s_nop 0
    buffer_load_dwordx4 v5, s[12:15], s64 offen offset:1792 nt lds
    s_add_u32 m0, s76, 8448
    s_nop 0
    buffer_load_dwordx4 v6, s[16:19], s64 offen offset:0 nt lds
    s_add_u32 m0, s76, 9248
    s_nop 0
    buffer_load_dwordx4 v6, s[16:19], s64 offen offset:256 nt lds
    s_add_u32 m0, s76, 10048
    s_nop 0
    buffer_load_dwordx4 v6, s[16:19], s64 offen offset:512 nt lds
    s_add_u32 m0, s76, 10848
    s_nop 0
    buffer_load_dwordx4 v6, s[16:19], s64 offen offset:768 nt lds
    s_add_u32 m0, s76, 11648
    s_nop 0
    buffer_load_dwordx4 v6, s[16:19], s64 offen offset:1024 nt lds
    s_add_u32 m0, s76, 12448
    s_nop 0
    buffer_load_dwordx4 v6, s[16:19], s64 offen offset:1280 nt lds
    s_waitcnt vmcnt(14)
    s_barrier
    s_call_b64 s[80:81], L_tile
    v_add_u32 v2, 33792, v2
    v_add_u32 v3, 33792, v3
    s_barrier
    s_add_u32 s64, s63, 3
    s_and_b32 s64, s64, 15
    s_lshl_b32 s64, s64, 13
    s_add_u32 s64, s64, s62
    s_add_u32 m0, s76, 13248
    s_nop 0
    buffer_load_dwordx4 v6, s[16:19], s64 offen offset:1536 nt lds
    s_add_u32 m0, s76, 14048
    s_nop 0
    buffer_load_dwordx4 v6, s[16:19], s64 offen offset:1792 nt lds
    s_add_u32 s64, s63, 4
    s_and_b32 s64, s64, 15
    s_lshl_b32 s64, s64, 13
    s_add_u32 s64, s64, s62
    s_add_u32 m0, s76, 33792
    s_nop 0
    buffer_load_dwordx4 v4, s[12:15], s64 offen offset:0 nt lds
    s_add_u32 m0, s76, 34592
    s_nop 0
    buffer_load_dwordx4 v4, s[12:15], s64 offen offset:256 nt lds
    s_add_u32 m0, s76, 35392
    s_nop 0
    buffer_load_dwordx4 v4, s[12:15], s64 offen offset:512 nt lds
    s_add_u32 m0, s76, 36192
    s_nop 0
    buffer_load_dwordx4 v4, s[12:15], s64 offen offset:768 nt lds
    s_add_u32 m0, s76, 36992
    s_nop 0
    buffer_load_dwordx4 v5, s[12:15], s64 offen offset:1024 nt lds
    s_add_u32 m0, s76, 37792
    s_nop 0
    buffer_load_dwordx4 v5, s[12:15], s64 offen offset:1280 nt lds
    s_add_u32 m0, s76, 38592
    s_nop 0
    buffer_load_dwordx4 v5, s[12:15], s64 offen offset:1536 nt lds
    s_add_u32 m0, s76, 39392
    s_nop 0
    buffer_load_dwordx4 v5, s[12:15], s64 offen offset:1792 nt lds
    s_add_u32 m0, s76, 42240
    s_nop 0
    buffer_load_dwordx4 v6, s[16:19], s64 offen offset:0 nt lds
    s_add_u32 m0, s76, 43040
    s_nop 0
    buffer_load_dwordx4 v6, s[16:19], s64 offen offset:256 nt lds
    s_add_u32 m0, s76, 43840
    s_nop 0
    buffer_load_dwordx4 v6, s[16:19], s64 offen offset:512 nt lds
    s_add_u32 m0, s76, 44640
    s_nop 0
    buffer_load_dwordx4 v6, s[16:19], s64 offen offset:768 nt lds
    s_waitcnt vmcnt(14)
    s_barrier
    s_call_b64 s[80:81], L_tile
    v_add_u32 v2, -67584, v2
    v_add_u32 v3, -67584, v3
    s_barrier
    s_add_u32 s64, s63, 4
    s_and_b32 s64, s64, 15
    s_lshl_b32 s64, s64, 13
    s_add_u32 s64, s64, s62
    s_add_u32 m0, s76, 45440
    s_nop 0
    buffer_load_dwordx4 v6, s[16:19], s64 offen offset:1024 nt lds
    s_add_u32 m0, s76, 46240
    s_nop 0
    buffer_load_dwordx4 v6, s[16:19], s64 offen offset:1280 nt lds
    s_add_u32 m0, s76, 47040
    s_nop 0
    buffer_load_dwordx4 v6, s[16:19], s64 offen offset:1536 nt lds
    s_add_u32 m0, s76, 47840
    s_nop 0
    buffer_load_dwordx4 v6, s[16:19], s64 offen offset:1792 nt lds
    s_add_u32 s64, s63, 5
    s_and_b32 s64, s64, 15
    s_lshl_b32 s64, s64, 13
    s_add_u32 s64, s64, s62
    s_add_u32 m0, s76, 67584
    s_nop 0
    buffer_load_dwordx4 v4, s[12:15], s64 offen offset:0 nt lds
    s_add_u32 m0, s76, 68384
    s_nop 0
    buffer_load_dwordx4 v4, s[12:15], s64 offen offset:256 nt lds
    s_add_u32 m0, s76, 69184
    s_nop 0
    buffer_load_dwordx4 v4, s[12:15], s64 offen offset:512 nt lds
    s_add_u32 m0, s76, 69984
    s_nop 0
    buffer_load_dwordx4 v4, s[12:15], s64 offen offset:768 nt lds
    s_add_u32 m0, s76, 70784
    s_nop 0
    buffer_load_dwordx4 v5, s[12:15], s64 offen offset:1024 nt lds
    s_add_u32 m0, s76, 71584
    s_nop 0
    buffer_load_dwordx4 v5, s[12:15], s64 offen offset:1280 nt lds
    s_add_u32 m0, s76, 72384
    s_nop 0
    buffer_load_dwordx4 v5, s[12:15], s64 offen offset:1536 nt lds
    s_add_u32 m0, s76, 73184
    s_nop 0
    buffer_load_dwordx4 v5, s[12:15], s64 offen offset:1792 nt lds
    s_add_u32 m0, s76, 76032
    s_nop 0
    buffer_load_dwordx4 v6, s[16:19], s64 offen offset:0 nt lds
    s_add_u32 m0, s76, 76832
    s_nop 0
    buffer_load_dwordx4 v6, s[16:19], s64 offen offset:256 nt lds
    s_waitcnt vmcnt(14)
    s_barrier
    s_call_b64 s[80:81], L_tile
    v_add_u32 v2, 33792, v2
    v_add_u32 v3, 33792, v3
    s_barrier
    s_add_u32 s64, s63, 5
    s_and_b32 s64, s64, 15
    s_lshl_b32 s64, s64, 13
    s_add_u32 s64, s64, s62
    s_add_u32 m0, s76, 77632
    s_nop 0
    buffer_load_dwordx4 v6, s[16:19], s64 offen offset:512 nt lds
    s_add_u32 m0, s76, 78432
    s_nop 0
    buffer_load_dwordx4 v6, s[16:19], s64 offen offset:768 nt lds
    s_add_u32 m0, s76, 79232
    s_nop 0
    buffer_load_dwordx4 v6, s[16:19], s64 offen offset:1024 nt lds
    s_add_u32 m0, s76, 80032
    s_nop 0
    buffer_load_dwordx4 v6, s[16:19], s64 offen offset:1280 nt lds
    s_add_u32 m0, s76, 80832
    s_nop 0
    buffer_load_dwordx4 v6, s[16:19], s64 offen offset:1536 nt lds
    s_add_u32 m0, s76, 81632
    s_nop 0
    buffer_load_dwordx4 v6, s[16:19], s64 offen offset:1792 nt lds
    s_add_u32 s64, s63, 6
    s_and_b32 s64, s64, 15
    s_lshl_b32 s64, s64, 13
    s_add_u32 s64, s64, s62
    s_add_u32 m0, s76, 0
    s_nop 0
    buffer_load_dwordx4 v4, s[12:15], s64 offen offset:0 nt lds
    s_add_u32 m0, s76, 800
    s_nop 0
    buffer_load_dwordx4 v4, s[12:15], s64 offen offset:256 nt lds
    s_add_u32 m0, s76, 1600
    s_nop 0
    buffer_load_dwordx4 v4, s[12:15], s64 offen offset:512 nt lds
    s_add_u32 m0, s76, 2400
    s_nop 0
    buffer_load_dwordx4 v4, s[12:15], s64 offen offset:768 nt lds
    s_add_u32 m0, s76, 3200
    s_nop 0
    buffer_load_dwordx4 v5, s[12:15], s64 offen offset:1024 nt lds
    s_add_u32 m0, s76, 4000
    s_nop 0
    buffer_load_dwordx4 v5, s[12:15], s64 offen offset:1280 nt lds
    s_add_u32 m0, s76, 4800
    s_nop 0
    buffer_load_dwordx4 v5, s[12:15], s64 offen offset:1536 nt lds
    s_add_u32 m0, s76, 5600
    s_nop 0
    buffer_load_dwordx4 v5, s[12:15], s64 offen offset:1792 nt lds
    s_waitcnt vmcnt(14)
    s_barrier
    s_call_b64 s[80:81], L_tile
    v_add_u32 v2, 33792, v2
    v_add_u32 v3, 33792, v3
    s_barrier
    s_add_u32 s64, s63, 6
    s_and_b32 s64, s64, 15
    s_lshl_b32 s64, s64, 13
    s_add_u32 s64, s64, s62
    s_add_u32 m0, s76, 8448
    s_nop 0
    buffer_load_dwordx4 v6, s[16:19], s64 offen offset:0 nt lds
    s_add_u32 m0, s76, 9248
    s_nop 0
    buffer_load_dwordx4 v6, s[16:19], s64 offen offset:256 nt lds
    s_add_u32 m0, s76, 10048
    s_nop 0
    buffer_load_dwordx4 v6, s[16:19], s64 offen offset:512 nt lds
    s_add_u32 m0, s76, 10848
    s_nop 0
    buffer_load_dwordx4 v6, s[16:19], s64 offen offset:768 nt lds
    s_add_u32 m0, s76, 11648
    s_nop 0
    buffer_load_dwordx4 v6, s[16:19], s64 offen offset:1024 nt lds
    s_add_u32 m0, s76, 12448
    s_nop 0
    buffer_load_dwordx4 v6, s[16:19], s64 offen offset:1280 nt lds
    s_add_u32 m0, s76, 13248
    s_nop 0
    buffer_load_dwordx4 v6, s[16:19], s64 offen offset:1536 nt lds
    s_add_u32 m0, s76, 14048
    s_nop 0
    buffer_load_dwordx4 v6, s[16:19], s64 offen offset:1792 nt lds
    s_add_u32 s64, s63, 7
    s_and_b32 s64, s64, 15
    s_lshl_b32 s64, s64, 13
    s_add_u32 s64, s64, s62
    s_add_u32 m0, s76, 33792
    s_nop 0
    buffer_load_dwordx4 v4, s[12:15], s64 offen offset:0 nt lds
    s_add_u32 m0, s76, 34592
    s_nop 0
    buffer_load_dwordx4 v4, s[12:15], s64 offen offset:256 nt lds
    s_add_u32 m0, s76, 35392
    s_nop 0
    buffer_load_dwordx4 v4, s[12:15], s64 offen offset:512 nt lds
    s_add_u32 m0, s76, 36192
    s_nop 0
    buffer_load_dwordx4 v4, s[12:15], s64 offen offset:768 nt lds
    s_add_u32 m0, s76, 36992
    s_nop 0
    buffer_load_dwordx4 v5, s[12:15], s64 offen offset:1024 nt lds
    s_add_u32 m0, s76, 37792
    s_nop 0
    buffer_load_dwordx4 v5, s[12:15], s64 offen offset:1280 nt lds
    s_waitcnt vmcnt(14)
    s_barrier
    s_call_b64 s[80:81], L_tile
    v_add_u32 v2, -67584, v2
    v_add_u32 v3, -67584, v3
    s_barrier
    s_add_u32 s64, s63, 7
    s_and_b32 s64, s64, 15
    s_lshl_b32 s64, s64, 13
    s_add_u32 s64, s64, s62
    s_add_u32 m0, s76, 38592
    s_nop 0
    buffer_load_dwordx4 v5, s[12:15], s64 offen offset:1536 nt lds
    s_add_u32 m0, s76, 39392
    s_nop 0
    buffer_load_dwordx4 v5, s[12:15], s64 offen offset:1792 nt lds
    s_add_u32 m0, s76, 42240
    s_nop 0
    buffer_load_dwordx4 v6, s[16:19], s64 offen offset:0 nt lds
    s_add_u32 m0, s76, 43040
    s_nop 0
    buffer_load_dwordx4 v6, s[16:19], s64 offen offset:256 nt lds
    s_add_u32 m0, s76, 43840
    s_nop 0
    buffer_load_dwordx4 v6, s[16:19], s64 offen offset:512 nt lds
    s_add_u32 m0, s76, 44640
    s_nop 0
    buffer_load_dwordx4 v6, s[16:19], s64 offen offset:768 nt lds
    s_add_u32 m0, s76, 45440
    s_nop 0
    buffer_load_dwordx4 v6, s[16:19], s64 offen offset:1024 nt lds
    s_add_u32 m0, s76, 46240
    s_nop 0
    buffer_load_dwordx4 v6, s[16:19], s64 offen offset:1280 nt lds
    s_add_u32 m0, s76, 47040
    s_nop 0
    buffer_load_dwordx4 v6, s[16:19], s64 offen offset:1536 nt lds
    s_add_u32 m0, s76, 47840
    s_nop 0
    buffer_load_dwordx4 v6, s[16:19], s64 offen offset:1792 nt lds
    s_add_u32 s64, s63, 8
    s_and_b32 s64, s64, 15
    s_lshl_b32 s64, s64, 13
    s_add_u32 s64, s64, s62
    s_add_u32 m0, s76, 67584
    s_nop 0
    buffer_load_dwordx4 v4, s[12:15], s64 offen offset:0 nt lds
    s_add_u32 m0, s76, 68384
    s_nop 0
    buffer_load_dwordx4 v4, s[12:15], s64 offen offset:256 nt lds
    s_add_u32 m0, s76, 69184
    s_nop 0
    buffer_load_dwordx4 v4, s[12:15], s64 offen offset:512 nt lds
    s_add_u32 m0, s76, 69984
    s_nop 0
    buffer_load_dwordx4 v4, s[12:15], s64 offen offset:768 nt lds
    s_waitcnt vmcnt(14)
    s_barrier
    s_call_b64 s[80:81], L_tile
    v_add_u32 v2, 33792, v2
    v_add_u32 v3, 33792, v3
    s_barrier
    s_add_u32 s64, s63, 8
    s_and_b32 s64, s64, 15
    s_lshl_b32 s64, s64, 13
    s_add_u32 s64, s64, s62
    s_add_u32 m0, s76, 70784
    s_nop 0
    buffer_load_dwordx4 v5, s[12:15], s64 offen offset:1024 nt lds
    s_add_u32 m0, s76, 71584
    s_nop 0
    buffer_load_dwordx4 v5, s[12:15], s64 offen offset:1280 nt lds
    s_add_u32 m0, s76, 72384
    s_nop 0
    buffer_load_dwordx4 v5, s[12:15], s64 offen offset:1536 nt lds
    s_add_u32 m0, s76, 73184
    s_nop 0
    buffer_load_dwordx4 v5, s[12:15], s64 offen offset:1792 nt lds
    s_add_u32 m0, s76, 76032
    s_nop 0
    buffer_load_dwordx4 v6, s[16:19], s64 offen offset:0 nt lds
    s_add_u32 m0, s76, 76832
    s_nop 0
    buffer_load_dwordx4 v6, s[16:19], s64 offen offset:256 nt lds
    s_add_u32 m0, s76, 77632
    s_nop 0
    buffer_load_dwordx4 v6, s[16:19], s64 offen offset:512 nt lds
    s_add_u32 m0, s76, 78432
    s_nop 0
    buffer_load_dwordx4 v6, s[16:19], s64 offen offset:768 nt lds
    s_add_u32 m0, s76, 79232
    s_nop 0
    buffer_load_dwordx4 v6, s[16:19], s64 offen offset:1024 nt lds
    s_add_u32 m0, s76, 80032
    s_nop 0
    buffer_load_dwordx4 v6, s[16:19], s64 offen offset:1280 nt lds
    s_add_u32 m0, s76, 80832
    s_nop 0
    buffer_load_dwordx4 v6, s[16:19], s64 offen offset:1536 nt lds
    s_add_u32 m0, s76, 81632
    s_nop 0
    buffer_load_dwordx4 v6, s[16:19], s64 offen offset:1792 nt lds
    s_add_u32 s64, s63, 9
    s_and_b32 s64, s64, 15
    s_lshl_b32 s64, s64, 13
    s_add_u32 s64, s64, s62
    s_add_u32 m0, s76, 0
    s_nop 0
    buffer_load_dwordx4 v4, s[12:15], s64 offen offset:0 nt lds
    s_add_u32 m0, s76, 800
    s_nop 0
    buffer_load_dwordx4 v4, s[12:15], s64 offen offset:256 nt lds
    s_waitcnt vmcnt(14)
    s_barrier
    s_call_b64 s[80:81], L_tile
    v_add_u32 v2, 33792, v2
    v_add_u32 v3, 33792, v3
    s_barrier
    s_add_u32 s64, s63, 9
    s_and_b32 s64, s64, 15
    s_lshl_b32 s64, s64, 13
    s_add_u32 s64, s64, s62
    s_add_u32 m0, s76, 1600
    s_nop 0
    buffer_load_dwordx4 v4, s[12:15], s64 offen offset:512 nt lds
    s_add_u32 m0, s76, 2400
    s_nop 0
    buffer_load_dwordx4 v4, s[12:15], s64 offen offset:768 nt lds
    s_add_u32 m0, s76, 3200
    s_nop 0
    buffer_load_dwordx4 v5, s[12:15], s64 offen offset:1024 nt lds
    s_add_u32 m0, s76, 4000
    s_nop 0
    buffer_load_dwordx4 v5, s[12:15], s64 offen offset:1280 nt lds
    s_add_u32 m0, s76, 4800
    s_nop 0
    buffer_load_dwordx4 v5, s[12:15], s64 offen offset:1536 nt lds
    s_add_u32 m0, s76, 5600
    s_nop 0
    buffer_load_dwordx4 v5, s[12:15], s64 offen offset:1792 nt lds
    s_add_u32 m0, s76, 8448
    s_nop 0
    buffer_load_dwordx4 v6, s[16:19], s64 offen offset:0 nt lds
    s_add_u32 m0, s76, 9248
    s_nop 0
    buffer_load_dwordx4 v6, s[16:19], s64 offen offset:256 nt lds
    s_add_u32 m0, s76, 10048
    s_nop 0
    buffer_load_dwordx4 v6, s[16:19], s64 offen offset:512 nt lds
    s_add_u32 m0, s76, 10848
    s_nop 0
    buffer_load_dwordx4 v6, s[16:19], s64 offen offset:768 nt lds
    s_add_u32 m0, s76, 11648
    s_nop 0
    buffer_load_dwordx4 v6, s[16:19], s64 offen offset:1024 nt lds
    s_add_u32 m0, s76, 12448
    s_nop 0
    buffer_load_dwordx4 v6, s[16:19], s64 offen offset:1280 nt lds
    s_add_u32 m0, s76, 13248
    s_nop 0
    buffer_load_dwordx4 v6, s[16:19], s64 offen offset:1536 nt lds
    s_add_u32 m0, s76, 14048
    s_nop 0
    buffer_load_dwordx4 v6, s[16:19], s64 offen offset:1792 nt lds
    s_waitcnt vmcnt(14)
    s_barrier
    s_call_b64 s[80:81], L_tile
    v_add_u32 v2, -67584, v2
    v_add_u32 v3, -67584, v3
    s_barrier
    s_add_u32 s64, s63, 10
    s_and_b32 s64, s64, 15
    s_lshl_b32 s64, s64, 13
    s_add_u32 s64, s64, s62
    s_add_u32 m0, s76, 33792
    s_nop 0
    buffer_load_dwordx4 v4, s[12:15], s64 offen offset:0 nt lds
    s_add_u32 m0, s76, 34592
    s_nop 0
    buffer_load_dwordx4 v4, s[12:15], s64 offen offset:256 nt lds
    s_add_u32 m0, s76, 35392
    s_nop 0
    buffer_load_dwordx4 v4, s[12:15], s64 offen offset:512 nt lds
    s_add_u32 m0, s76, 36192
    s_nop 0
    buffer_load_dwordx4 v4, s[12:15], s64 offen offset:768 nt lds
    s_add_u32 m0, s76, 36992
    s_nop 0
    buffer_load_dwordx4 v5, s[12:15], s64 offen offset:1024 nt lds
    s_add_u32 m0, s76, 37792
    s_nop 0
    buffer_load_dwordx4 v5, s[12:15], s64 offen offset:1280 nt lds
    s_add_u32 m0, s76, 38592
    s_nop 0
    buffer_load_dwordx4 v5, s[12:15], s64 offen offset:1536 nt lds
    s_add_u32 m0, s76, 39392
    s_nop 0
    buffer_load_dwordx4 v5, s[12:15], s64 offen offset:1792 nt lds
    s_add_u32 m0, s76, 42240
    s_nop 0
    buffer_load_dwordx4 v6, s[16:19], s64 offen offset:0 nt lds
    s_add_u32 m0, s76, 43040
    s_nop 0
    buffer_load_dwordx4 v6, s[16:19], s64 offen offset:256 nt lds
    s_add_u32 m0, s76, 43840
    s_nop 0
    buffer_load_dwordx4 v6, s[16:19], s64 offen offset:512 nt lds
    s_add_u32 m0, s76, 44640
    s_nop 0
    buffer_load_dwordx4 v6, s[16:19], s64 offen offset:768 nt lds
    s_add_u32 m0, s76, 45440
    s_nop 0
    buffer_load_dwordx4 v6, s[16:19], s64 offen offset:1024 nt lds
    s_add_u32 m0, s76, 46240
    s_nop 0
    buffer_load_dwordx4 v6, s[16:19], s64 offen offset:1280 nt lds
    s_waitcnt vmcnt(14)
    s_barrier
    s_call_b64 s[80:81], L_tile
    v_add_u32 v2, 33792, v2
    v_add_u32 v3, 33792, v3
    s_barrier
    s_add_u32 s64, s63, 10
    s_and_b32 s64, s64, 15
    s_lshl_b32 s64, s64, 13
    s_add_u32 s64, s64, s62
    s_add_u32 m0, s76, 47040
    s_nop 0
    buffer_load_dwordx4 v6, s[16:19], s64 offen offset:1536 nt lds
    s_add_u32 m0, s76, 47840
    s_nop 0
    buffer_load_dwordx4 v6, s[16:19], s64 offen offset:1792 nt lds
    s_add_u32 s64, s63, 11
    s_and_b32 s64, s64, 15
    s_lshl_b32 s64, s64, 13
    s_add_u32 s64, s64, s62
    s_add_u32 m0, s76, 67584
    s_nop 0
    buffer_load_dwordx4 v4, s[12:15], s64 offen offset:0 nt lds
    s_add_u32 m0, s76, 68384
    s_nop 0
    buffer_load_dwordx4 v4, s[12:15], s64 offen offset:256 nt lds
    s_add_u32 m0, s76, 69184
    s_nop 0
    buffer_load_dwordx4 v4, s[12:15], s64 offen offset:512 nt lds
    s_add_u32 m0, s76, 69984
    s_nop 0
    buffer_load_dwordx4 v4, s[12:15], s64 offen offset:768 nt lds
    s_add_u32 m0, s76, 70784
    s_nop 0
    buffer_load_dwordx4 v5, s[12:15], s64 offen offset:1024 nt lds
    s_add_u32 m0, s76, 71584
    s_nop 0
    buffer_load_dwordx4 v5, s[12:15], s64 offen offset:1280 nt lds
    s_add_u32 m0, s76, 72384
    s_nop 0
    buffer_load_dwordx4 v5, s[12:15], s64 offen offset:1536 nt lds
    s_add_u32 m0, s76, 73184
    s_nop 0
    buffer_load_dwordx4 v5, s[12:15], s64 offen offset:1792 nt lds
    s_add_u32 m0, s76, 76032
    s_nop 0
    buffer_load_dwordx4 v6, s[16:19], s64 offen offset:0 nt lds
    s_add_u32 m0, s76, 76832
    s_nop 0
    buffer_load_dwordx4 v6, s[16:19], s64 offen offset:256 nt lds
    s_add_u32 m0, s76, 77632
    s_nop 0
    buffer_load_dwordx4 v6, s[16:19], s64 offen offset:512 nt lds
    s_add_u32 m0, s76, 78432
    s_nop 0
    buffer_load_dwordx4 v6, s[16:19], s64 offen offset:768 nt lds
    s_waitcnt vmcnt(14)
    s_barrier
    s_barrier
    s_add_u32 s64, s63, 11
    s_and_b32 s64, s64, 15
    s_lshl_b32 s64, s64, 13
    s_add_u32 s64, s64, s62
    s_add_u32 m0, s76, 79232
    s_nop 0
    buffer_load_dwordx4 v6, s[16:19], s64 offen offset:1024 nt lds
    s_add_u32 m0, s76, 80032
    s_nop 0
    buffer_load_dwordx4 v6, s[16:19], s64 offen offset:1280 nt lds
    s_add_u32 m0, s76, 80832
    s_nop 0
    buffer_load_dwordx4 v6, s[16:19], s64 offen offset:1536 nt lds
    s_add_u32 m0, s76, 81632
    s_nop 0
    buffer_load_dwordx4 v6, s[16:19], s64 offen offset:1792 nt lds
    s_add_u32 s64, s63, 12
    s_and_b32 s64, s64, 15
    s_lshl_b32 s64, s64, 13
    s_add_u32 s64, s64, s62
    s_add_u32 m0, s76, 0
    s_nop 0
    buffer_load_dwordx4 v4, s[12:15], s64 offen offset:0 nt lds
    s_add_u32 m0, s76, 800
    s_nop 0
    buffer_load_dwordx4 v4, s[12:15], s64 offen offset:256 nt lds
    s_add_u32 m0, s76, 1600
    s_nop 0
    buffer_load_dwordx4 v4, s[12:15], s64 offen offset:512 nt lds
    s_add_u32 m0, s76, 2400
    s_nop 0
    buffer_load_dwordx4 v4, s[12:15], s64 offen offset:768 nt lds
    s_add_u32 m0, s76, 3200
    s_nop 0
    buffer_load_dwordx4 v5, s[12:15], s64 offen offset:1024 nt lds
    s_add_u32 m0, s76, 4000
    s_nop 0
    buffer_load_dwordx4 v5, s[12:15], s64 offen offset:1280 nt lds
    s_add_u32 m0, s76, 4800
    s_nop 0
    buffer_load_dwordx4 v5, s[12:15], s64 offen offset:1536 nt lds
    s_add_u32 m0, s76, 5600
    s_nop 0
    buffer_load_dwordx4 v5, s[12:15], s64 offen offset:1792 nt lds
    s_add_u32 m0, s76, 8448
    s_nop 0
    buffer_load_dwordx4 v6, s[16:19], s64 offen offset:0 nt lds
    s_add_u32 m0, s76, 9248
    s_nop 0
    buffer_load_dwordx4 v6, s[16:19], s64 offen offset:256 nt lds
    s_waitcnt vmcnt(14)
    s_barrier
    s_call_b64 s[80:81], L_tile
    v_add_u32 v2, 33792, v2
    v_add_u32 v3, 33792, v3
    s_barrier
    s_add_u32 s64, s63, 12
    s_and_b32 s64, s64, 15
    s_lshl_b32 s64, s64, 13
    s_add_u32 s64, s64, s62
    s_add_u32 m0, s76, 10048
    s_nop 0
    buffer_load_dwordx4 v6, s[16:19], s64 offen offset:512 nt lds
    s_add_u32 m0, s76, 10848
    s_nop 0
    buffer_load_dwordx4 v6, s[16:19], s64 offen offset:768 nt lds
    s_add_u32 m0, s76, 11648
    s_nop 0
    buffer_load_dwordx4 v6, s[16:19], s64 offen offset:1024 nt lds
    s_add_u32 m0, s76, 12448
    s_nop 0
    buffer_load_dwordx4 v6, s[16:19], s64 offen offset:1280 nt lds
    s_add_u32 m0, s76, 13248
    s_nop 0
    buffer_load_dwordx4 v6, s[16:19], s64 offen offset:1536 nt lds
    s_add_u32 m0, s76, 14048
    s_nop 0
    buffer_load_dwordx4 v6, s[16:19], s64 offen offset:1792 nt lds
    s_add_u32 s64, s63, 13
    s_and_b32 s64, s64, 15
    s_lshl_b32 s64, s64, 13
    s_add_u32 s64, s64, s62
    s_add_u32 m0, s76, 33792
    s_nop 0
    buffer_load_dwordx4 v4, s[12:15], s64 offen offset:0 nt lds
    s_add_u32 m0, s76, 34592
    s_nop 0
    buffer_load_dwordx4 v4, s[12:15], s64 offen offset:256 nt lds
    s_add_u32 m0, s76, 35392
    s_nop 0
    buffer_load_dwordx4 v4, s[12:15], s64 offen offset:512 nt lds
    s_add_u32 m0, s76, 36192
    s_nop 0
    buffer_load_dwordx4 v4, s[12:15], s64 offen offset:768 nt lds
    s_add_u32 m0, s76, 36992
    s_nop 0
    buffer_load_dwordx4 v5, s[12:15], s64 offen offset:1024 nt lds
    s_add_u32 m0, s76, 37792
    s_nop 0
    buffer_load_dwordx4 v5, s[12:15], s64 offen offset:1280 nt lds
    s_add_u32 m0, s76, 38592
    s_nop 0
    buffer_load_dwordx4 v5, s[12:15], s64 offen offset:1536 nt lds
    s_add_u32 m0, s76, 39392
    s_nop 0
    buffer_load_dwordx4 v5, s[12:15], s64 offen offset:1792 nt lds
    s_waitcnt vmcnt(14)
    s_barrier
    s_call_b64 s[80:81], L_tile
    v_add_u32 v2, -67584, v2
    v_add_u32 v3, -67584, v3
    s_barrier
    s_add_u32 s64, s63, 13
    s_and_b32 s64, s64, 15
    s_lshl_b32 s64, s64, 13
    s_add_u32 s64, s64, s62
    s_add_u32 m0, s76, 42240
    s_nop 0
    buffer_load_dwordx4 v6, s[16:19], s64 offen offset:0 nt lds
    s_add_u32 m0, s76, 43040
    s_nop 0
    buffer_load_dwordx4 v6, s[16:19], s64 offen offset:256 nt lds
    s_add_u32 m0, s76, 43840
    s_nop 0
    buffer_load_dwordx4 v6, s[16:19], s64 offen offset:512 nt lds
    s_add_u32 m0, s76, 44640
    s_nop 0
    buffer_load_dwordx4 v6, s[16:19], s64 offen offset:768 nt lds
    s_add_u32 m0, s76, 45440
    s_nop 0
    buffer_load_dwordx4 v6, s[16:19], s64 offen offset:1024 nt lds
    s_add_u32 m0, s76, 46240
    s_nop 0
    buffer_load_dwordx4 v6, s[16:19], s64 offen offset:1280 nt lds
    s_add_u32 m0, s76, 47040
    s_nop 0
    buffer_load_dwordx4 v6, s[16:19], s64 offen offset:1536 nt lds
    s_add_u32 m0, s76, 47840
    s_nop 0
    buffer_load_dwordx4 v6, s[16:19], s64 offen offset:1792 nt lds
    s_add_u32 s64, s63, 14
    s_and_b32 s64, s64, 15
    s_lshl_b32 s64, s64, 13
    s_add_u32 s64, s64, s62
    s_add_u32 m0, s76, 67584
    s_nop 0
    buffer_load_dwordx4 v4, s[12:15], s64 offen offset:0 nt lds
    s_add_u32 m0, s76, 68384
    s_nop 0
    buffer_load_dwordx4 v4, s[12:15], s64 offen offset:256 nt lds
    s_add_u32 m0, s76, 69184
    s_nop 0
    buffer_load_dwordx4 v4, s[12:15], s64 offen offset:512 nt lds
    s_add_u32 m0, s76, 69984
    s_nop 0
    buffer_load_dwordx4 v4, s[12:15], s64 offen offset:768 nt lds
    s_add_u32 m0, s76, 70784
    s_nop 0
    buffer_load_dwordx4 v5, s[12:15], s64 offen offset:1024 nt lds
    s_add_u32 m0, s76, 71584
    s_nop 0
    buffer_load_dwordx4 v5, s[12:15], s64 offen offset:1280 nt lds
    s_waitcnt vmcnt(14)
    s_barrier
    s_call_b64 s[80:81], L_tile
    v_add_u32 v2, 33792, v2
    v_add_u32 v3, 33792, v3
    s_barrier
    s_add_u32 s64, s63, 14
    s_and_b32 s64, s64, 15
    s_lshl_b32 s64, s64, 13
    s_add_u32 s64, s64, s62
    s_add_u32 m0, s76, 72384
    s_nop 0
    buffer_load_dwordx4 v5, s[12:15], s64 offen offset:1536 nt lds
    s_add_u32 m0, s76, 73184
    s_nop 0
    buffer_load_dwordx4 v5, s[12:15], s64 offen offset:1792 nt lds
    s_add_u32 m0, s76, 76032
    s_nop 0
    buffer_load_dwordx4 v6, s[16:19], s64 offen offset:0 nt lds
    s_add_u32 m0, s76, 76832
    s_nop 0
    buffer_load_dwordx4 v6, s[16:19], s64 offen offset:256 nt lds
    s_add_u32 m0, s76, 77632
    s_nop 0
    buffer_load_dwordx4 v6, s[16:19], s64 offen offset:512 nt lds
    s_add_u32 m0, s76, 78432
    s_nop 0
    buffer_load_dwordx4 v6, s[16:19], s64 offen offset:768 nt lds
    s_add_u32 m0, s76, 79232
    s_nop 0
    buffer_load_dwordx4 v6, s[16:19], s64 offen offset:1024 nt lds
    s_add_u32 m0, s76, 80032
    s_nop 0
    buffer_load_dwordx4 v6, s[16:19], s64 offen offset:1280 nt lds
    s_add_u32 m0, s76, 80832
    s_nop 0
    buffer_load_dwordx4 v6, s[16:19], s64 offen offset:1536 nt lds
    s_add_u32 m0, s76, 81632
    s_nop 0
    buffer_load_dwordx4 v6, s[16:19], s64 offen offset:1792 nt lds
    s_add_u32 s64, s63, 15
    s_and_b32 s64, s64, 15
    s_lshl_b32 s64, s64, 13
    s_add_u32 s64, s64, s62
    s_add_u32 m0, s76, 0
    s_nop 0
    buffer_load_dwordx4 v4, s[12:15], s64 offen offset:0 nt lds
    s_add_u32 m0, s76, 800
    s_nop 0
    buffer_load_dwordx4 v4, s[12:15], s64 offen offset:256 nt lds
    s_add_u32 m0, s76, 1600
    s_nop 0
    buffer_load_dwordx4 v4, s[12:15], s64 offen offset:512 nt lds
    s_add_u32 m0, s76, 2400
    s_nop 0
    buffer_load_dwordx4 v4, s[12:15], s64 offen offset:768 nt lds
    s_add_u32 m0, s76, 3200
    s_nop 0
    buffer_load_dwordx4 v5, s[12:15], s64 offen offset:1024 nt lds
    s_add_u32 m0, s76, 4000
    s_nop 0
    buffer_load_dwordx4 v5, s[12:15], s64 offen offset:1280 nt lds
    s_waitcnt vmcnt(16)
    s_barrier
    s_call_b64 s[80:81], L_tile
    v_add_u32 v2, 33792, v2
    v_add_u32 v3, 33792, v3
    s_barrier
    s_add_u32 s64, s63, 15
    s_and_b32 s64, s64, 15
    s_lshl_b32 s64, s64, 13
    s_add_u32 s64, s64, s62
    s_add_u32 m0, s76, 4800
    s_nop 0
    buffer_load_dwordx4 v5, s[12:15], s64 offen offset:1536 nt lds
    s_add_u32 m0, s76, 5600
    s_nop 0
    buffer_load_dwordx4 v5, s[12:15], s64 offen offset:1792 nt lds
    s_add_u32 m0, s76, 8448
    s_nop 0
    buffer_load_dwordx4 v6, s[16:19], s64 offen offset:0 nt lds
    s_add_u32 m0, s76, 9248
    s_nop 0
    buffer_load_dwordx4 v6, s[16:19], s64 offen offset:256 nt lds
    s_add_u32 m0, s76, 10048
    s_nop 0
    buffer_load_dwordx4 v6, s[16:19], s64 offen offset:512 nt lds
    s_add_u32 m0, s76, 10848
    s_nop 0
    buffer_load_dwordx4 v6, s[16:19], s64 offen offset:768 nt lds
    s_add_u32 m0, s76, 11648
    s_nop 0
    buffer_load_dwordx4 v6, s[16:19], s64 offen offset:1024 nt lds
    s_add_u32 m0, s76, 12448
    s_nop 0
    buffer_load_dwordx4 v6, s[16:19], s64 offen offset:1280 nt lds
    s_add_u32 m0, s76, 13248
    s_nop 0
    buffer_load_dwordx4 v6, s[16:19], s64 offen offset:1536 nt lds
    s_add_u32 m0, s76, 14048
    s_nop 0
    buffer_load_dwordx4 v6, s[16:19], s64 offen offset:1792 nt lds
    s_add_u32 s64, s89, 0
    s_and_b32 s64, s64, 7
    s_lshl_b32 s64, s64, 14
    s_add_u32 s64, s64, s74
    s_add_u32 m0, s76, 33792
    s_nop 0
    buffer_load_dwordx4 v4, s[8:11], s64 offen offset:0 nt lds
    s_add_u32 m0, s76, 34592
    s_nop 0
    buffer_load_dwordx4 v4, s[8:11], s64 offen offset:256 nt lds
    s_add_u32 m0, s76, 35392
    s_nop 0
    buffer_load_dwordx4 v4, s[8:11], s64 offen offset:512 nt lds
    s_add_u32 m0, s76, 36192
    s_nop 0
    buffer_load_dwordx4 v4, s[8:11], s64 offen offset:768 nt lds
    s_add_u32 m0, s76, 36992
    s_nop 0
    buffer_load_dwordx4 v5, s[8:11], s64 offen offset:1024 nt lds
    s_add_u32 m0, s76, 37792
    s_nop 0
    buffer_load_dwordx4 v5, s[8:11], s64 offen offset:1280 nt lds
    s_waitcnt vmcnt(16)
    s_barrier
    s_call_b64 s[80:81], L_tile
    v_add_u32 v2, -67584, v2
    v_add_u32 v3, -67584, v3
    s_barrier
    s_add_u32 s64, s89, 0
    s_and_b32 s64, s64, 7
    s_lshl_b32 s64, s64, 14
    s_add_u32 s64, s64, s74
    s_add_u32 m0, s76, 38592
    s_nop 0
    buffer_load_dwordx4 v5, s[8:11], s64 offen offset:1536 nt lds
    s_add_u32 m0, s76, 39392
    s_nop 0
    buffer_load_dwordx4 v5, s[8:11], s64 offen offset:1792 nt lds
    s_add_u32 m0, s76, 42240
    s_nop 0
    buffer_load_dwordx4 v6, s[32:35], s64 offen offset:0 nt lds
    s_add_u32 m0, s76, 43040
    s_nop 0
    buffer_load_dwordx4 v6, s[32:35], s64 offen offset:256 nt lds
    s_add_u32 m0, s76, 43840
    s_nop 0
    buffer_load_dwordx4 v6, s[32:35], s64 offen offset:512 nt lds
    s_add_u32 m0, s76, 44640
    s_nop 0
    buffer_load_dwordx4 v6, s[32:35], s64 offen offset:768 nt lds
    s_add_u32 m0, s76, 45440
    s_nop 0
    buffer_load_dwordx4 v6, s[32:35], s64 offen offset:1024 nt lds
    s_add_u32 m0, s76, 46240
    s_nop 0
    buffer_load_dwordx4 v6, s[32:35], s64 offen offset:1280 nt lds
    s_add_u32 m0, s76, 47040
    s_nop 0
    buffer_load_dwordx4 v6, s[32:35], s64 offen offset:1536 nt lds
    s_add_u32 m0, s76, 47840
    s_nop 0
    buffer_load_dwordx4 v6, s[32:35], s64 offen offset:1792 nt lds
    s_add_u32 s64, s89, 1
    s_and_b32 s64, s64, 7
    s_lshl_b32 s64, s64, 14
    s_add_u32 s64, s64, s74
    s_add_u32 m0, s76, 67584
    s_nop 0
    buffer_load_dwordx4 v4, s[8:11], s64 offen offset:0 nt lds
    s_add_u32 m0, s76, 68384
    s_nop 0
    buffer_load_dwordx4 v4, s[8:11], s64 offen offset:256 nt lds
    s_add_u32 m0, s76, 69184
    s_nop 0
    buffer_load_dwordx4 v4, s[8:11], s64 offen offset:512 nt lds
    s_add_u32 m0, s76, 69984
    s_nop 0
    buffer_load_dwordx4 v4, s[8:11], s64 offen offset:768 nt lds
    s_add_u32 m0, s76, 70784
    s_nop 0
    buffer_load_dwordx4 v5, s[8:11], s64 offen offset:1024 nt lds
    s_add_u32 m0, s76, 71584
    s_nop 0
    buffer_load_dwordx4 v5, s[8:11], s64 offen offset:1280 nt lds
    s_waitcnt vmcnt(16)
    s_barrier
    s_call_b64 s[80:81], L_tile
    v_add_u32 v2, 33792, v2
    v_add_u32 v3, 33792, v3
    s_add_u32 s64, s89, 1
    s_and_b32 s64, s64, 7
    s_lshl_b32 s64, s64, 14
    s_add_u32 s64, s64, s74
    s_add_u32 m0, s76, 72384
    s_nop 0
    buffer_load_dwordx4 v5, s[8:11], s64 offen offset:1536 nt lds
    s_add_u32 m0, s76, 73184
    s_nop 0
    buffer_load_dwordx4 v5, s[8:11], s64 offen offset:1792 nt lds
    s_add_u32 m0, s76, 76032
    s_nop 0
    buffer_load_dwordx4 v6, s[32:35], s64 offen offset:0 nt lds
    s_add_u32 m0, s76, 76832
    s_nop 0
    buffer_load_dwordx4 v6, s[32:35], s64 offen offset:256 nt lds
    s_add_u32 m0, s76, 77632
    s_nop 0
    buffer_load_dwordx4 v6, s[32:35], s64 offen offset:512 nt lds
    s_add_u32 m0, s76, 78432
    s_nop 0
    buffer_load_dwordx4 v6, s[32:35], s64 offen offset:768 nt lds
    s_add_u32 m0, s76, 79232
    s_nop 0
    buffer_load_dwordx4 v6, s[32:35], s64 offen offset:1024 nt lds
    s_add_u32 m0, s76, 80032
    s_nop 0
    buffer_load_dwordx4 v6, s[32:35], s64 offen offset:1280 nt lds
    s_add_u32 m0, s76, 80832
    s_nop 0
    buffer_load_dwordx4 v6, s[32:35], s64 offen offset:1536 nt lds
    s_add_u32 m0, s76, 81632
    s_nop 0
    buffer_load_dwordx4 v6, s[32:35], s64 offen offset:1792 nt lds
    s_add_u32 s64, s89, 2
    s_and_b32 s64, s64, 7
    s_lshl_b32 s64, s64, 14
    s_add_u32 s64, s64, s74
    s_add_u32 m0, s76, 0
    s_nop 0
    buffer_load_dwordx4 v4, s[8:11], s64 offen offset:0 nt lds
    s_add_u32 m0, s76, 800
    s_nop 0
    buffer_load_dwordx4 v4, s[8:11], s64 offen offset:256 nt lds
    s_add_u32 m0, s76, 1600
    s_nop 0
    buffer_load_dwordx4 v4, s[8:11], s64 offen offset:512 nt lds
    s_add_u32 m0, s76, 2400
    s_nop 0
    buffer_load_dwordx4 v4, s[8:11], s64 offen offset:768 nt lds
    s_add_u32 m0, s76, 3200
    s_nop 0
    buffer_load_dwordx4 v5, s[8:11], s64 offen offset:1024 nt lds
    s_add_u32 m0, s76, 4000
    s_nop 0
    buffer_load_dwordx4 v5, s[8:11], s64 offen offset:1280 nt lds
    s_waitcnt vmcnt(16)
    s_barrier
    s_add_u32 s64, s89, 2
    s_and_b32 s64, s64, 7
    s_lshl_b32 s64, s64, 14
    s_add_u32 s64, s64, s74
    s_add_u32 m0, s76, 4800
    s_nop 0
    buffer_load_dwordx4 v5, s[8:11], s64 offen offset:1536 nt lds
    s_add_u32 m0, s76, 5600
    s_nop 0
    buffer_load_dwordx4 v5, s[8:11], s64 offen offset:1792 nt lds
    s_add_u32 m0, s76, 8448
    s_nop 0
    buffer_load_dwordx4 v6, s[32:35], s64 offen offset:0 nt lds
    s_add_u32 m0, s76, 9248
    s_nop 0
    buffer_load_dwordx4 v6, s[32:35], s64 offen offset:256 nt lds
    s_add_u32 m0, s76, 10048
    s_nop 0
    buffer_load_dwordx4 v6, s[32:35], s64 offen offset:512 nt lds
    s_add_u32 m0, s76, 10848
    s_nop 0
    buffer_load_dwordx4 v6, s[32:35], s64 offen offset:768 nt lds
    s_add_u32 m0, s76, 11648
    s_nop 0
    buffer_load_dwordx4 v6, s[32:35], s64 offen offset:1024 nt lds
    s_add_u32 m0, s76, 12448
    s_nop 0
    buffer_load_dwordx4 v6, s[32:35], s64 offen offset:1280 nt lds
    s_add_u32 m0, s76, 13248
    s_nop 0
    buffer_load_dwordx4 v6, s[32:35], s64 offen offset:1536 nt lds
    s_add_u32 m0, s76, 14048
    s_nop 0
    buffer_load_dwordx4 v6, s[32:35], s64 offen offset:1792 nt lds
    s_nop 7
    v_rcp_f32 v232, v232
    v_rcp_f32 v233, v233
    v_rcp_f32 v236, v236
    v_rcp_f32 v237, v237
    v_rcp_f32 v240, v240
    v_rcp_f32 v241, v241
    v_pk_mul_f32 v[8:9], v[8:9], v[232:233]
    v_pk_mul_f32 v[10:11], v[10:11], v[232:233]
    v_pk_mul_f32 v[12:13], v[12:13], v[236:237]
    v_pk_mul_f32 v[14:15], v[14:15], v[236:237]
    v_pk_mul_f32 v[16:17], v[16:17], v[240:241]
    v_pk_mul_f32 v[18:19], v[18:19], v[240:241]
    v_pk_mul_f32 v[20:21], v[20:21], v[232:233]
    v_pk_mul_f32 v[22:23], v[22:23], v[232:233]
    v_pk_mul_f32 v[24:25], v[24:25], v[236:237]
    v_pk_mul_f32 v[26:27], v[26:27], v[236:237]
    v_pk_mul_f32 v[28:29], v[28:29], v[240:241]
    v_pk_mul_f32 v[30:31], v[30:31], v[240:241]
    v_pk_mul_f32 v[32:33], v[32:33], v[232:233]
    v_pk_mul_f32 v[34:35], v[34:35], v[232:233]
    v_pk_mul_f32 v[36:37], v[36:37], v[236:237]
    v_pk_mul_f32 v[38:39], v[38:39], v[236:237]
    v_pk_mul_f32 v[40:41], v[40:41], v[240:241]
    v_pk_mul_f32 v[42:43], v[42:43], v[240:241]
    v_pk_mul_f32 v[44:45], v[44:45], v[232:233]
    v_pk_mul_f32 v[46:47], v[46:47], v[232:233]
    v_pk_mul_f32 v[48:49], v[48:49], v[236:237]
    v_pk_mul_f32 v[50:51], v[50:51], v[236:237]
    v_pk_mul_f32 v[52:53], v[52:53], v[240:241]
    v_pk_mul_f32 v[54:55], v[54:55], v[240:241]
    v_pk_mul_f32 v[56:57], v[56:57], v[232:233]
    v_pk_mul_f32 v[58:59], v[58:59], v[232:233]
    v_pk_mul_f32 v[60:61], v[60:61], v[236:237]
    v_pk_mul_f32 v[62:63], v[62:63], v[236:237]
    v_pk_mul_f32 v[64:65], v[64:65], v[240:241]
    v_pk_mul_f32 v[66:67], v[66:67], v[240:241]
    v_pk_mul_f32 v[68:69], v[68:69], v[232:233]
    v_pk_mul_f32 v[70:71], v[70:71], v[232:233]
    v_pk_mul_f32 v[72:73], v[72:73], v[236:237]
    v_pk_mul_f32 v[74:75], v[74:75], v[236:237]
    v_pk_mul_f32 v[76:77], v[76:77], v[240:241]
    v_pk_mul_f32 v[78:79], v[78:79], v[240:241]
    v_pk_mul_f32 v[80:81], v[80:81], v[232:233]
    v_pk_mul_f32 v[82:83], v[82:83], v[232:233]
    v_pk_mul_f32 v[84:85], v[84:85], v[236:237]
    v_pk_mul_f32 v[86:87], v[86:87], v[236:237]
    v_pk_mul_f32 v[88:89], v[88:89], v[240:241]
    v_pk_mul_f32 v[90:91], v[90:91], v[240:241]
    v_pk_mul_f32 v[92:93], v[92:93], v[232:233]
    v_pk_mul_f32 v[94:95], v[94:95], v[232:233]
    v_pk_mul_f32 v[96:97], v[96:97], v[236:237]
    v_pk_mul_f32 v[98:99], v[98:99], v[236:237]
    v_pk_mul_f32 v[100:101], v[100:101], v[240:241]
    v_pk_mul_f32 v[102:103], v[102:103], v[240:241]
    v_cvt_pk_bf16_f32 v104, v8, v9
    v_cvt_pk_bf16_f32 v105, v10, v11
    v_cvt_pk_bf16_f32 v106, v20, v21
    v_cvt_pk_bf16_f32 v107, v22, v23
    v_cvt_pk_bf16_f32 v108, v12, v13
    v_cvt_pk_bf16_f32 v109, v14, v15
    v_cvt_pk_bf16_f32 v110, v24, v25
    v_cvt_pk_bf16_f32 v111, v26, v27
    v_cvt_pk_bf16_f32 v112, v16, v17
    v_cvt_pk_bf16_f32 v113, v18, v19
    v_cvt_pk_bf16_f32 v114, v28, v29
    v_cvt_pk_bf16_f32 v115, v30, v31
    v_cvt_pk_bf16_f32 v116, v32, v33
    v_cvt_pk_bf16_f32 v117, v34, v35
    v_cvt_pk_bf16_f32 v118, v44, v45
    v_cvt_pk_bf16_f32 v119, v46, v47
    v_cvt_pk_bf16_f32 v120, v36, v37
    v_cvt_pk_bf16_f32 v121, v38, v39
    v_cvt_pk_bf16_f32 v122, v48, v49
    v_cvt_pk_bf16_f32 v123, v50, v51
    v_cvt_pk_bf16_f32 v124, v40, v41
    v_cvt_pk_bf16_f32 v125, v42, v43
    v_cvt_pk_bf16_f32 v126, v52, v53
    v_cvt_pk_bf16_f32 v127, v54, v55
    v_cvt_pk_bf16_f32 v128, v56, v57
    v_cvt_pk_bf16_f32 v129, v58, v59
    v_cvt_pk_bf16_f32 v130, v68, v69
    v_cvt_pk_bf16_f32 v131, v70, v71
    v_cvt_pk_bf16_f32 v132, v60, v61
    v_cvt_pk_bf16_f32 v133, v62, v63
    v_cvt_pk_bf16_f32 v134, v72, v73
    v_cvt_pk_bf16_f32 v135, v74, v75
    v_cvt_pk_bf16_f32 v136, v64, v65
    v_cvt_pk_bf16_f32 v137, v66, v67
    v_cvt_pk_bf16_f32 v138, v76, v77
    v_cvt_pk_bf16_f32 v139, v78, v79
    v_cvt_pk_bf16_f32 v140, v80, v81
    v_cvt_pk_bf16_f32 v141, v82, v83
    v_cvt_pk_bf16_f32 v142, v92, v93
    v_cvt_pk_bf16_f32 v143, v94, v95
    v_cvt_pk_bf16_f32 v144, v84, v85
    v_cvt_pk_bf16_f32 v145, v86, v87
    v_cvt_pk_bf16_f32 v146, v96, v97
    v_cvt_pk_bf16_f32 v147, v98, v99
    v_cvt_pk_bf16_f32 v148, v88, v89
    v_cvt_pk_bf16_f32 v149, v90, v91
    v_cvt_pk_bf16_f32 v150, v100, v101
    v_cvt_pk_bf16_f32 v151, v102, v103
    s_waitcnt vmcnt(10)
    s_barrier
    s_mul_i32 s65, s6, 12288
    v_add_u32 v250, s65, v1
    ds_write_b128 v250, v[104:107] offset:0
    ds_write_b128 v250, v[108:111] offset:1024
    ds_write_b128 v250, v[112:115] offset:2048
    ds_write_b128 v250, v[116:119] offset:3072
    ds_write_b128 v250, v[120:123] offset:4096
    ds_write_b128 v250, v[124:127] offset:5120
    ds_write_b128 v250, v[128:131] offset:6144
    ds_write_b128 v250, v[132:135] offset:7168
    ds_write_b128 v250, v[136:139] offset:8192
    ds_write_b128 v250, v[140:143] offset:9216
    ds_write_b128 v250, v[144:147] offset:10240
    ds_write_b128 v250, v[148:151] offset:11264
    s_waitcnt lgkmcnt(0)
    v_mov_b32 v8, 0
    v_mov_b32 v9, 0
    v_mov_b32 v10, 0
    v_mov_b32 v11, 0
    v_mov_b32 v12, 0
    v_mov_b32 v13, 0
    v_mov_b32 v14, 0
    v_mov_b32 v15, 0
    v_mov_b32 v16, 0
    v_mov_b32 v17, 0
    v_mov_b32 v18, 0
    v_mov_b32 v19, 0
    v_mov_b32 v20, 0
    v_mov_b32 v21, 0
    v_mov_b32 v22, 0
    v_mov_b32 v23, 0
    v_mov_b32 v24, 0
    v_mov_b32 v25, 0
    v_mov_b32 v26, 0
    v_mov_b32 v27, 0
    v_mov_b32 v28, 0
    v_mov_b32 v29, 0
    v_mov_b32 v30, 0
    v_mov_b32 v31, 0
    v_mov_b32 v32, 0
    v_mov_b32 v33, 0
    v_mov_b32 v34, 0
    v_mov_b32 v35, 0
    v_mov_b32 v36, 0
    v_mov_b32 v37, 0
    v_mov_b32 v38, 0
    v_mov_b32 v39, 0
    v_mov_b32 v40, 0
    v_mov_b32 v41, 0
    v_mov_b32 v42, 0
    v_mov_b32 v43, 0
    v_mov_b32 v44, 0
    v_mov_b32 v45, 0
    v_mov_b32 v46, 0
    v_mov_b32 v47, 0
    v_mov_b32 v48, 0
    v_mov_b32 v49, 0
    v_mov_b32 v50, 0
    v_mov_b32 v51, 0
    v_mov_b32 v52, 0
    v_mov_b32 v53, 0
    v_mov_b32 v54, 0
    v_mov_b32 v55, 0
    v_mov_b32 v56, 0
    v_mov_b32 v57, 0
    v_mov_b32 v58, 0
    v_mov_b32 v59, 0
    v_mov_b32 v60, 0
    v_mov_b32 v61, 0
    v_mov_b32 v62, 0
    v_mov_b32 v63, 0
    v_mov_b32 v64, 0
    v_mov_b32 v65, 0
    v_mov_b32 v66, 0
    v_mov_b32 v67, 0
    v_mov_b32 v68, 0
    v_mov_b32 v69, 0
    v_mov_b32 v70, 0
    v_mov_b32 v71, 0
    v_mov_b32 v72, 0
    v_mov_b32 v73, 0
    v_mov_b32 v74, 0
    v_mov_b32 v75, 0
    v_mov_b32 v76, 0
    v_mov_b32 v77, 0
    v_mov_b32 v78, 0
    v_mov_b32 v79, 0
    v_mov_b32 v80, 0
    v_mov_b32 v81, 0
    v_mov_b32 v82, 0
    v_mov_b32 v83, 0
    v_mov_b32 v84, 0
    v_mov_b32 v85, 0
    v_mov_b32 v86, 0
    v_mov_b32 v87, 0
    v_mov_b32 v88, 0
    v_mov_b32 v89, 0
    v_mov_b32 v90, 0
    v_mov_b32 v91, 0
    v_mov_b32 v92, 0
    v_mov_b32 v93, 0
    v_mov_b32 v94, 0
    v_mov_b32 v95, 0
    v_mov_b32 v96, 0
    v_mov_b32 v97, 0
    v_mov_b32 v98, 0
    v_mov_b32 v99, 0
    v_mov_b32 v100, 0
    v_mov_b32 v101, 0
    v_mov_b32 v102, 0
    v_mov_b32 v103, 0
    s_waitcnt vmcnt(0)
    s_barrier
    v_mov_b32 v104, 0
    v_mov_b32 v105, 0
    v_mov_b32 v106, 0
    v_mov_b32 v107, 0
    v_mov_b32 v108, 0
    v_mov_b32 v109, 0
    v_mov_b32 v110, 0
    v_mov_b32 v111, 0
    v_mov_b32 v112, 0
    v_mov_b32 v113, 0
    v_mov_b32 v114, 0
    v_mov_b32 v115, 0
    v_mov_b32 v116, 0
    v_mov_b32 v117, 0
    v_mov_b32 v118, 0
    v_mov_b32 v119, 0
    v_mov_b32 v120, 0
    v_mov_b32 v121, 0
    v_mov_b32 v122, 0
    v_mov_b32 v123, 0
    v_mov_b32 v124, 0
    v_mov_b32 v125, 0
    v_mov_b32 v126, 0
    v_mov_b32 v127, 0
    v_mov_b32 v128, 0
    v_mov_b32 v129, 0
    v_mov_b32 v130, 0
    v_mov_b32 v131, 0
    v_mov_b32 v132, 0
    v_mov_b32 v133, 0
    v_mov_b32 v134, 0
    v_mov_b32 v135, 0
    v_mov_b32 v136, 0
    v_mov_b32 v137, 0
    v_mov_b32 v138, 0
    v_mov_b32 v139, 0
    v_mov_b32 v140, 0
    v_mov_b32 v141, 0
    v_mov_b32 v142, 0
    v_mov_b32 v143, 0
    v_mov_b32 v144, 0
    v_mov_b32 v145, 0
    v_mov_b32 v146, 0
    v_mov_b32 v147, 0
    v_mov_b32 v148, 0
    v_mov_b32 v149, 0
    v_mov_b32 v150, 0
    v_mov_b32 v151, 0
    v_mov_b32 v152, 0
    v_mov_b32 v153, 0
    v_mov_b32 v154, 0
    v_mov_b32 v155, 0
    v_mov_b32 v156, 0
    v_mov_b32 v157, 0
    v_mov_b32 v158, 0
    v_mov_b32 v159, 0
    v_mov_b32 v160, 0
    v_mov_b32 v161, 0
    v_mov_b32 v162, 0
    v_mov_b32 v163, 0
    v_mov_b32 v164, 0
    v_mov_b32 v165, 0
    v_mov_b32 v166, 0
    v_mov_b32 v167, 0
    v_mov_b32 v168, 0
    v_mov_b32 v169, 0
    v_mov_b32 v170, 0
    v_mov_b32 v171, 0
    v_mov_b32 v172, 0
    v_mov_b32 v173, 0
    v_mov_b32 v174, 0
    v_mov_b32 v175, 0
    v_mov_b32 v176, 0
    v_mov_b32 v177, 0
    v_mov_b32 v178, 0
    v_mov_b32 v179, 0
    v_mov_b32 v180, 0
    v_mov_b32 v181, 0
    v_mov_b32 v182, 0
    v_mov_b32 v183, 0
    v_mov_b32 v184, 0
    v_mov_b32 v185, 0
    v_mov_b32 v186, 0
    v_mov_b32 v187, 0
    v_mov_b32 v188, 0
    v_mov_b32 v189, 0
    v_mov_b32 v190, 0
    v_mov_b32 v191, 0
    v_mov_b32 v192, 0
    v_mov_b32 v193, 0
    v_mov_b32 v194, 0
    v_mov_b32 v195, 0
    v_mov_b32 v196, 0
    v_mov_b32 v197, 0
    v_mov_b32 v198, 0
    v_mov_b32 v199, 0
    v_subrev_u32 v249, s76, v2
    s_sub_u32 s65, s75, 16896
    v_add_u32 v249, s65, v249
    s_waitcnt vmcnt(0)
    s_barrier
    s_waitcnt vmcnt(0)
    s_barrier
    s_waitcnt vmcnt(0)
    s_barrier
    s_waitcnt vmcnt(0)
    s_barrier
    s_add_u32 s64, s86, 0
    s_and_b32 s64, s64, 7
    s_lshl_b32 s64, s64, 15
    s_add_u32 s64, s64, s70
    s_add_u32 m0, s75, 0
    s_nop 0
    buffer_load_dwordx4 v7, s[24:27], s64 offen offset:0 lds
    s_add_u32 m0, s75, 32
    s_nop 0
    buffer_load_dwordx4 v7, s[24:27], s64 offen offset:1024 lds
    s_add_u32 m0, s75, 64
    s_nop 0
    buffer_load_dwordx4 v7, s[24:27], s64 offen offset:2048 lds
    s_add_u32 m0, s75, 96
    s_nop 0
    buffer_load_dwordx4 v7, s[24:27], s64 offen offset:3072 lds
    s_add_u32 m0, s75, 4224
    s_add_u32 s64, s64, 4096
    buffer_load_dwordx4 v7, s[24:27], s64 offen offset:0 lds
    s_add_u32 m0, s75, 4256
    s_nop 0
    buffer_load_dwordx4 v7, s[24:27], s64 offen offset:1024 lds
    s_add_u32 m0, s75, 4288
    s_nop 0
    buffer_load_dwordx4 v7, s[24:27], s64 offen offset:2048 lds
    s_add_u32 m0, s75, 4320
    s_nop 0
    buffer_load_dwordx4 v7, s[24:27], s64 offen offset:3072 lds
    s_add_u32 s64, s86, 0
    s_and_b32 s64, s64, 7
    s_lshl_b32 s64, s64, 15
    s_add_u32 s64, s64, s70
    s_add_u32 s64, s64, 256
    s_add_u32 m0, s75, 8448
    s_nop 0
    buffer_load_dwordx4 v7, s[24:27], s64 offen offset:0 lds
    s_add_u32 m0, s75, 8480
    s_nop 0
    buffer_load_dwordx4 v7, s[24:27], s64 offen offset:1024 lds
    s_add_u32 m0, s75, 8512
    s_nop 0
    buffer_load_dwordx4 v7, s[24:27], s64 offen offset:2048 lds
    s_add_u32 m0, s75, 8544
    s_nop 0
    buffer_load_dwordx4 v7, s[24:27], s64 offen offset:3072 lds
    s_add_u32 m0, s75, 12672
    s_add_u32 s64, s64, 4096
    buffer_load_dwordx4 v7, s[24:27], s64 offen offset:0 lds
    s_add_u32 m0, s75, 12704
    s_nop 0
    buffer_load_dwordx4 v7, s[24:27], s64 offen offset:1024 lds
    s_add_u32 m0, s75, 12736
    s_nop 0
    buffer_load_dwordx4 v7, s[24:27], s64 offen offset:2048 lds
    s_add_u32 m0, s75, 12768
    s_nop 0
    buffer_load_dwordx4 v7, s[24:27], s64 offen offset:3072 lds
    s_waitcnt vmcnt(16)
    s_barrier
    s_waitcnt vmcnt(0)
    s_mov_b32 s68, 0
L_G0_o:
    s_barrier
    s_add_u32 s65, s86, s68
    s_and_b32 s65, s65, 7
    s_mul_i32 s65, s65, 3072
    v_add_u32 v248, s65, v1
    ds_read_b128 v[232:235], v248 offset:0
    ds_read_b128 v[236:239], v248 offset:1024
    ds_read_b128 v[240:243], v248 offset:2048
    ds_read_b64_tr_b16 v[200:201], v249 offset:0
    ds_read_b64_tr_b16 v[202:203], v249 offset:256
    ds_read_b64_tr_b16 v[204:205], v249 offset:32
    ds_read_b64_tr_b16 v[206:207], v249 offset:288
    ds_read_b64_tr_b16 v[208:209], v249 offset:64
    ds_read_b64_tr_b16 v[210:211], v249 offset:320
    ds_read_b64_tr_b16 v[212:213], v249 offset:96
    ds_read_b64_tr_b16 v[214:215], v249 offset:352
    ds_read_b64_tr_b16 v[216:217], v249 offset:128
    ds_read_b64_tr_b16 v[218:219], v249 offset:384
    ds_read_b64_tr_b16 v[220:221], v249 offset:160
    ds_read_b64_tr_b16 v[222:223], v249 offset:416
    s_waitcnt lgkmcnt(10)
    ds_read_b64_tr_b16 v[224:225], v249 offset:192
    ds_read_b64_tr_b16 v[226:227], v249 offset:448
    ds_read_b64_tr_b16 v[228:229], v249 offset:224
    ds_read_b64_tr_b16 v[230:231], v249 offset:480
    s_waitcnt lgkmcnt(0)
    s_cmp_eq_u32 s68, 7
    s_cbranch_scc1 L_c_1
    s_add_u32 s64, s86, s68
    s_add_u32 s64, s64, 1
    s_and_b32 s64, s64, 7
    s_lshl_b32 s64, s64, 15
    s_add_u32 s64, s64, s70
    s_add_u32 m0, s75, 0
    s_nop 0
    buffer_load_dwordx4 v7, s[24:27], s64 offen offset:0 lds
    s_add_u32 m0, s75, 32
    s_nop 0
    buffer_load_dwordx4 v7, s[24:27], s64 offen offset:1024 lds
    s_add_u32 m0, s75, 64
    s_nop 0
    buffer_load_dwordx4 v7, s[24:27], s64 offen offset:2048 lds
    s_add_u32 m0, s75, 96
    s_nop 0
    buffer_load_dwordx4 v7, s[24:27], s64 offen offset:3072 lds
    s_add_u32 m0, s75, 4224
    s_add_u32 s64, s64, 4096
    buffer_load_dwordx4 v7, s[24:27], s64 offen offset:0 lds
    s_add_u32 m0, s75, 4256
    s_nop 0
    buffer_load_dwordx4 v7, s[24:27], s64 offen offset:1024 lds
    s_add_u32 m0, s75, 4288
    s_nop 0
    buffer_load_dwordx4 v7, s[24:27], s64 offen offset:2048 lds
    s_add_u32 m0, s75, 4320
    s_nop 0
    buffer_load_dwordx4 v7, s[24:27], s64 offen offset:3072 lds
L_c_1:
    s_barrier
    v_mfma_f32_16x16x32_bf16 v[8:11], v[200:203], v[232:235], v[8:11]
    v_mfma_f32_16x16x32_bf16 v[12:15], v[200:203], v[236:239], v[12:15]
    v_mfma_f32_16x16x32_bf16 v[16:19], v[200:203], v[240:243], v[16:19]
    v_mfma_f32_16x16x32_bf16 v[20:23], v[204:207], v[232:235], v[20:23]
    v_mfma_f32_16x16x32_bf16 v[24:27], v[204:207], v[236:239], v[24:27]
    v_mfma_f32_16x16x32_bf16 v[28:31], v[204:207], v[240:243], v[28:31]
    v_mfma_f32_16x16x32_bf16 v[32:35], v[208:211], v[232:235], v[32:35]
    v_mfma_f32_16x16x32_bf16 v[36:39], v[208:211], v[236:239], v[36:39]
    v_mfma_f32_16x16x32_bf16 v[40:43], v[208:211], v[240:243], v[40:43]
    v_mfma_f32_16x16x32_bf16 v[44:47], v[212:215], v[232:235], v[44:47]
    v_mfma_f32_16x16x32_bf16 v[48:51], v[212:215], v[236:239], v[48:51]
    v_mfma_f32_16x16x32_bf16 v[52:55], v[212:215], v[240:243], v[52:55]
    v_mfma_f32_16x16x32_bf16 v[56:59], v[216:219], v[232:235], v[56:59]
    v_mfma_f32_16x16x32_bf16 v[60:63], v[216:219], v[236:239], v[60:63]
    v_mfma_f32_16x16x32_bf16 v[64:67], v[216:219], v[240:243], v[64:67]
    v_mfma_f32_16x16x32_bf16 v[68:71], v[220:223], v[232:235], v[68:71]
    v_mfma_f32_16x16x32_bf16 v[72:75], v[220:223], v[236:239], v[72:75]
    v_mfma_f32_16x16x32_bf16 v[76:79], v[220:223], v[240:243], v[76:79]
    v_mfma_f32_16x16x32_bf16 v[80:83], v[224:227], v[232:235], v[80:83]
    v_mfma_f32_16x16x32_bf16 v[84:87], v[224:227], v[236:239], v[84:87]
    v_mfma_f32_16x16x32_bf16 v[88:91], v[224:227], v[240:243], v[88:91]
    v_mfma_f32_16x16x32_bf16 v[92:95], v[228:231], v[232:235], v[92:95]
    v_mfma_f32_16x16x32_bf16 v[96:99], v[228:231], v[236:239], v[96:99]
    v_mfma_f32_16x16x32_bf16 v[100:103], v[228:231], v[240:243], v[100:103]
    s_cmp_eq_u32 s68, 7
    s_cbranch_scc0 L_c_2
    s_waitcnt vmcnt(0)
L_c_2:
    s_waitcnt vmcnt(8)
    s_barrier
    ds_read_b128 v[232:235], v248 offset:0
    ds_read_b128 v[236:239], v248 offset:1024
    ds_read_b128 v[240:243], v248 offset:2048
    ds_read_b64_tr_b16 v[200:201], v249 offset:8448
    ds_read_b64_tr_b16 v[202:203], v249 offset:8704
    ds_read_b64_tr_b16 v[204:205], v249 offset:8480
    ds_read_b64_tr_b16 v[206:207], v249 offset:8736
    ds_read_b64_tr_b16 v[208:209], v249 offset:8512
    ds_read_b64_tr_b16 v[210:211], v249 offset:8768
    ds_read_b64_tr_b16 v[212:213], v249 offset:8544
    ds_read_b64_tr_b16 v[214:215], v249 offset:8800
    ds_read_b64_tr_b16 v[216:217], v249 offset:8576
    ds_read_b64_tr_b16 v[218:219], v249 offset:8832
    ds_read_b64_tr_b16 v[220:221], v249 offset:8608
    ds_read_b64_tr_b16 v[222:223], v249 offset:8864
    s_waitcnt lgkmcnt(10)
    ds_read_b64_tr_b16 v[224:225], v249 offset:8640
    ds_read_b64_tr_b16 v[226:227], v249 offset:8896
    ds_read_b64_tr_b16 v[228:229], v249 offset:8672
    ds_read_b64_tr_b16 v[230:231], v249 offset:8928
    s_waitcnt lgkmcnt(0)
    s_cmp_eq_u32 s68, 7
    s_cbranch_scc1 L_c_3
    s_add_u32 s64, s86, s68
    s_add_u32 s64, s64, 1
    s_and_b32 s64, s64, 7
    s_lshl_b32 s64, s64, 15
    s_add_u32 s64, s64, s70
    s_add_u32 s64, s64, 256
    s_add_u32 m0, s75, 8448
    s_nop 0
    buffer_load_dwordx4 v7, s[24:27], s64 offen offset:0 lds
    s_add_u32 m0, s75, 8480
    s_nop 0
    buffer_load_dwordx4 v7, s[24:27], s64 offen offset:1024 lds
    s_add_u32 m0, s75, 8512
    s_nop 0
    buffer_load_dwordx4 v7, s[24:27], s64 offen offset:2048 lds
    s_add_u32 m0, s75, 8544
    s_nop 0
    buffer_load_dwordx4 v7, s[24:27], s64 offen offset:3072 lds
    s_add_u32 m0, s75, 12672
    s_add_u32 s64, s64, 4096
    buffer_load_dwordx4 v7, s[24:27], s64 offen offset:0 lds
    s_add_u32 m0, s75, 12704
    s_nop 0
    buffer_load_dwordx4 v7, s[24:27], s64 offen offset:1024 lds
    s_add_u32 m0, s75, 12736
    s_nop 0
    buffer_load_dwordx4 v7, s[24:27], s64 offen offset:2048 lds
    s_add_u32 m0, s75, 12768
    s_nop 0
    buffer_load_dwordx4 v7, s[24:27], s64 offen offset:3072 lds
L_c_3:
    s_barrier
    v_mfma_f32_16x16x32_bf16 v[104:107], v[200:203], v[232:235], v[104:107]
    v_mfma_f32_16x16x32_bf16 v[108:111], v[200:203], v[236:239], v[108:111]
    v_mfma_f32_16x16x32_bf16 v[112:115], v[200:203], v[240:243], v[112:115]
    v_mfma_f32_16x16x32_bf16 v[116:119], v[204:207], v[232:235], v[116:119]
    v_mfma_f32_16x16x32_bf16 v[120:123], v[204:207], v[236:239], v[120:123]
    v_mfma_f32_16x16x32_bf16 v[124:127], v[204:207], v[240:243], v[124:127]
    v_mfma_f32_16x16x32_bf16 v[128:131], v[208:211], v[232:235], v[128:131]
    v_mfma_f32_16x16x32_bf16 v[132:135], v[208:211], v[236:239], v[132:135]
    v_mfma_f32_16x16x32_bf16 v[136:139], v[208:211], v[240:243], v[136:139]
    v_mfma_f32_16x16x32_bf16 v[140:143], v[212:215], v[232:235], v[140:143]
    v_mfma_f32_16x16x32_bf16 v[144:147], v[212:215], v[236:239], v[144:147]
    v_mfma_f32_16x16x32_bf16 v[148:151], v[212:215], v[240:243], v[148:151]
    v_mfma_f32_16x16x32_bf16 v[152:155], v[216:219], v[232:235], v[152:155]
    v_mfma_f32_16x16x32_bf16 v[156:159], v[216:219], v[236:239], v[156:159]
    v_mfma_f32_16x16x32_bf16 v[160:163], v[216:219], v[240:243], v[160:163]
    v_mfma_f32_16x16x32_bf16 v[164:167], v[220:223], v[232:235], v[164:167]
    v_mfma_f32_16x16x32_bf16 v[168:171], v[220:223], v[236:239], v[168:171]
    v_mfma_f32_16x16x32_bf16 v[172:175], v[220:223], v[240:243], v[172:175]
    v_mfma_f32_16x16x32_bf16 v[176:179], v[224:227], v[232:235], v[176:179]
    v_mfma_f32_16x16x32_bf16 v[180:183], v[224:227], v[236:239], v[180:183]
    v_mfma_f32_16x16x32_bf16 v[184:187], v[224:227], v[240:243], v[184:187]
    v_mfma_f32_16x16x32_bf16 v[188:191], v[228:231], v[232:235], v[188:191]
    v_mfma_f32_16x16x32_bf16 v[192:195], v[228:231], v[236:239], v[192:195]
    v_mfma_f32_16x16x32_bf16 v[196:199], v[228:231], v[240:243], v[196:199]
    s_waitcnt vmcnt(8)
    s_add_u32 s68, s68, 1
    s_cmp_lt_u32 s68, 8
    s_cbranch_scc1 L_G0_o
    s_nop 7
    v_cvt_pk_bf16_f32 v200, v104, v105
    v_cvt_pk_bf16_f32 v201, v106, v107
    v_cvt_pk_bf16_f32 v202, v116, v117
    v_cvt_pk_bf16_f32 v203, v118, v119
    v_cvt_pk_bf16_f32 v204, v108, v109
    v_cvt_pk_bf16_f32 v205, v110, v111
    v_cvt_pk_bf16_f32 v206, v120, v121
    v_cvt_pk_bf16_f32 v207, v122, v123
    v_cvt_pk_bf16_f32 v208, v112, v113
    v_cvt_pk_bf16_f32 v209, v114, v115
    v_cvt_pk_bf16_f32 v210, v124, v125
    v_cvt_pk_bf16_f32 v211, v126, v127
    v_cvt_pk_bf16_f32 v212, v128, v129
    v_cvt_pk_bf16_f32 v213, v130, v131
    v_cvt_pk_bf16_f32 v214, v140, v141
    v_cvt_pk_bf16_f32 v215, v142, v143
    v_cvt_pk_bf16_f32 v216, v132, v133
    v_cvt_pk_bf16_f32 v217, v134, v135
    v_cvt_pk_bf16_f32 v218, v144, v145
    v_cvt_pk_bf16_f32 v219, v146, v147
    v_cvt_pk_bf16_f32 v220, v136, v137
    v_cvt_pk_bf16_f32 v221, v138, v139
    v_cvt_pk_bf16_f32 v222, v148, v149
    v_cvt_pk_bf16_f32 v223, v150, v151
    v_cvt_pk_bf16_f32 v224, v152, v153
    v_cvt_pk_bf16_f32 v225, v154, v155
    v_cvt_pk_bf16_f32 v226, v164, v165
    v_cvt_pk_bf16_f32 v227, v166, v167
    v_cvt_pk_bf16_f32 v228, v156, v157
    v_cvt_pk_bf16_f32 v229, v158, v159
    v_cvt_pk_bf16_f32 v230, v168, v169
    v_cvt_pk_bf16_f32 v231, v170, v171
    v_cvt_pk_bf16_f32 v232, v160, v161
    v_cvt_pk_bf16_f32 v233, v162, v163
    v_cvt_pk_bf16_f32 v234, v172, v173
    v_cvt_pk_bf16_f32 v235, v174, v175
    v_cvt_pk_bf16_f32 v236, v176, v177
    v_cvt_pk_bf16_f32 v237, v178, v179
    v_cvt_pk_bf16_f32 v238, v188, v189
    v_cvt_pk_bf16_f32 v239, v190, v191
    v_cvt_pk_bf16_f32 v240, v180, v181
    v_cvt_pk_bf16_f32 v241, v182, v183
    v_cvt_pk_bf16_f32 v242, v192, v193
    v_cvt_pk_bf16_f32 v243, v194, v195
    v_cvt_pk_bf16_f32 v244, v184, v185
    v_cvt_pk_bf16_f32 v245, v186, v187
    v_cvt_pk_bf16_f32 v246, v196, v197
    v_cvt_pk_bf16_f32 v247, v198, v199
    s_lshl_b32 s73, s6, 1
    s_lshl_b32 s70, s5, 19
    s_lshl_b32 s66, s73, 8
    s_add_u32 s70, s70, s66
    s_add_u32 s70, s70, 262144
    s_mul_i32 s75, s6, 8448
    s_add_u32 s75, s75, 28672
    s_barrier
    s_mul_i32 s65, s6, 12288
    s_add_u32 s65, s65, 130048
    v_add_u32 v250, s65, v1
    ds_write_b128 v250, v[200:203] offset:0
    ds_write_b128 v250, v[204:207] offset:1024
    ds_write_b128 v250, v[208:211] offset:2048
    ds_write_b128 v250, v[212:215] offset:3072
    ds_write_b128 v250, v[216:219] offset:4096
    ds_write_b128 v250, v[220:223] offset:5120
    ds_write_b128 v250, v[224:227] offset:6144
    ds_write_b128 v250, v[228:231] offset:7168
    ds_write_b128 v250, v[232:235] offset:8192
    ds_write_b128 v250, v[236:239] offset:9216
    ds_write_b128 v250, v[240:243] offset:10240
    ds_write_b128 v250, v[244:247] offset:11264
    s_waitcnt lgkmcnt(0)
    s_add_u32 s64, s86, 0
    s_and_b32 s64, s64, 7
    s_lshl_b32 s64, s64, 15
    s_add_u32 s64, s64, s70
    s_add_u32 m0, s75, 33792
    s_nop 0
    buffer_load_dwordx4 v7, s[24:27], s64 offen offset:0 lds
    s_add_u32 m0, s75, 33824
    s_nop 0
    buffer_load_dwordx4 v7, s[24:27], s64 offen offset:1024 lds
    s_add_u32 m0, s75, 33856
    s_nop 0
    buffer_load_dwordx4 v7, s[24:27], s64 offen offset:2048 lds
    s_add_u32 m0, s75, 33888
    s_nop 0
    buffer_load_dwordx4 v7, s[24:27], s64 offen offset:3072 lds
    s_add_u32 m0, s75, 38016
    s_add_u32 s64, s64, 4096
    buffer_load_dwordx4 v7, s[24:27], s64 offen offset:0 lds
    s_add_u32 m0, s75, 38048
    s_nop 0
    buffer_load_dwordx4 v7, s[24:27], s64 offen offset:1024 lds
    s_add_u32 m0, s75, 38080
    s_nop 0
    buffer_load_dwordx4 v7, s[24:27], s64 offen offset:2048 lds
    s_add_u32 m0, s75, 38112
    s_nop 0
    buffer_load_dwordx4 v7, s[24:27], s64 offen offset:3072 lds
    s_barrier
    s_barrier
    s_add_u32 s64, s86, 1
    s_and_b32 s64, s64, 7
    s_lshl_b32 s64, s64, 15
    s_add_u32 s64, s64, s70
    s_add_u32 m0, s75, 67584
    s_nop 0
    buffer_load_dwordx4 v7, s[24:27], s64 offen offset:0 lds
    s_add_u32 m0, s75, 67616
    s_nop 0
    buffer_load_dwordx4 v7, s[24:27], s64 offen offset:1024 lds
    s_add_u32 m0, s75, 67648
    s_nop 0
    buffer_load_dwordx4 v7, s[24:27], s64 offen offset:2048 lds
    s_add_u32 m0, s75, 67680
    s_nop 0
    buffer_load_dwordx4 v7, s[24:27], s64 offen offset:3072 lds
    s_add_u32 m0, s75, 71808
    s_add_u32 s64, s64, 4096
    buffer_load_dwordx4 v7, s[24:27], s64 offen offset:0 lds
    s_add_u32 m0, s75, 71840
    s_nop 0
    buffer_load_dwordx4 v7, s[24:27], s64 offen offset:1024 lds
    s_add_u32 m0, s75, 71872
    s_nop 0
    buffer_load_dwordx4 v7, s[24:27], s64 offen offset:2048 lds
    s_add_u32 m0, s75, 71904
    s_nop 0
    buffer_load_dwordx4 v7, s[24:27], s64 offen offset:3072 lds
    s_barrier
    v_bfe_u32 v248, v0, 2, 3
    v_mul_u32_u24 v4, 1056, v248
    v_lshrrev_b32 v248, 5, v0
    v_lshl_add_u32 v4, v248, 9, v4
    v_and_b32 v248, 3, v0
    v_lshl_add_u32 v4, v248, 3, v4
    v_add_u32 v4, s75, v4
    v_add_u32 v5, 67584, v4
L_P3:
    s_add_u32 s65, s86, 0
    s_and_b32 s65, s65, 7
    s_mul_i32 s65, s65, 3072
    v_add_u32 v248, s65, v1
    s_waitcnt vmcnt(8) lgkmcnt(0)
    s_barrier
    ds_read_b128 v[208:211], v248 offset:0
    ds_read_b128 v[212:215], v248 offset:1024
    ds_read_b128 v[216:219], v248 offset:2048
    ds_read_b64_tr_b16 v[152:153], v4 offset:33792
    ds_read_b64_tr_b16 v[154:155], v4 offset:34048
    ds_read_b64_tr_b16 v[156:157], v4 offset:33824
    ds_read_b64_tr_b16 v[158:159], v4 offset:34080
    ds_read_b64_tr_b16 v[160:161], v4 offset:33856
    ds_read_b64_tr_b16 v[162:163], v4 offset:34112
    ds_read_b64_tr_b16 v[164:165], v4 offset:33888
    ds_read_b64_tr_b16 v[166:167], v4 offset:34144
    ds_read_b64_tr_b16 v[168:169], v4 offset:33920
    ds_read_b64_tr_b16 v[170:171], v4 offset:34176
    ds_read_b64_tr_b16 v[172:173], v4 offset:33952
    ds_read_b64_tr_b16 v[174:175], v4 offset:34208
    ds_read_b64_tr_b16 v[176:177], v4 offset:33984
    ds_read_b64_tr_b16 v[178:179], v4 offset:34240
    ds_read_b64_tr_b16 v[180:181], v4 offset:34016
    ds_read_b64_tr_b16 v[182:183], v4 offset:34272
    s_add_u32 s65, s86, 1
    s_and_b32 s65, s65, 7
    s_mul_i32 s65, s65, 3072
    v_add_u32 v248, s65, v1
    s_add_u32 s64, s86, 2
    s_and_b32 s64, s64, 7
    s_lshl_b32 s64, s64, 15
    s_add_u32 s64, s64, s70
    s_add_u32 m0, s75, 0
    s_nop 0
    buffer_load_dwordx4 v7, s[24:27], s64 offen offset:0 lds
    s_add_u32 m0, s75, 32
    s_nop 0
    buffer_load_dwordx4 v7, s[24:27], s64 offen offset:1024 lds
    s_add_u32 m0, s75, 64
    s_nop 0
    buffer_load_dwordx4 v7, s[24:27], s64 offen offset:2048 lds
    s_add_u32 m0, s75, 96
    s_nop 0
    buffer_load_dwordx4 v7, s[24:27], s64 offen offset:3072 lds
    s_add_u32 m0, s75, 4224
    s_add_u32 s64, s64, 4096
    buffer_load_dwordx4 v7, s[24:27], s64 offen offset:0 lds
    s_add_u32 m0, s75, 4256
    s_nop 0
    buffer_load_dwordx4 v7, s[24:27], s64 offen offset:1024 lds
    s_add_u32 m0, s75, 4288
    s_nop 0
    buffer_load_dwordx4 v7, s[24:27], s64 offen offset:2048 lds
    s_add_u32 m0, s75, 4320
    s_nop 0
    buffer_load_dwordx4 v7, s[24:27], s64 offen offset:3072 lds
    s_waitcnt vmcnt(8)
    s_waitcnt lgkmcnt(0)
    v_mfma_f32_16x16x32_bf16 v[8:11], v[152:155], v[208:211], v[8:11]
    ds_read_b128 v[136:139], v248 offset:0
    ds_read_b128 v[140:143], v248 offset:1024
    s_add_u32 s64, s86, 3
    s_and_b32 s64, s64, 7
    v_mfma_f32_16x16x32_bf16 v[12:15], v[152:155], v[212:215], v[12:15]
    ds_read_b128 v[144:147], v248 offset:2048
    s_lshl_b32 s64, s64, 15
    s_add_u32 s64, s64, s70
    v_mfma_f32_16x16x32_bf16 v[16:19], v[152:155], v[216:219], v[16:19]
    ds_read_b64_tr_b16 v[104:105], v5 offset:0
    s_add_u32 m0, s75, 33792
    v_mfma_f32_16x16x32_bf16 v[20:23], v[156:159], v[208:211], v[20:23]
    ds_read_b64_tr_b16 v[106:107], v5 offset:256
    v_mfma_f32_16x16x32_bf16 v[24:27], v[156:159], v[212:215], v[24:27]
    ds_read_b64_tr_b16 v[108:109], v5 offset:32
    buffer_load_dwordx4 v7, s[24:27], s64 offen offset:0 lds
    v_mfma_f32_16x16x32_bf16 v[28:31], v[156:159], v[216:219], v[28:31]
    ds_read_b64_tr_b16 v[110:111], v5 offset:288
    s_add_u32 m0, s75, 33824
    v_mfma_f32_16x16x32_bf16 v[32:35], v[160:163], v[208:211], v[32:35]
    ds_read_b64_tr_b16 v[112:113], v5 offset:64
    buffer_load_dwordx4 v7, s[24:27], s64 offen offset:1024 lds
    v_mfma_f32_16x16x32_bf16 v[36:39], v[160:163], v[212:215], v[36:39]
    ds_read_b64_tr_b16 v[114:115], v5 offset:320
    v_mfma_f32_16x16x32_bf16 v[40:43], v[160:163], v[216:219], v[40:43]
    ds_read_b64_tr_b16 v[116:117], v5 offset:96
    ds_read_b64_tr_b16 v[118:119], v5 offset:352
    s_add_u32 m0, s75, 33856
    v_mfma_f32_16x16x32_bf16 v[44:47], v[164:167], v[208:211], v[44:47]
    ds_read_b64_tr_b16 v[120:121], v5 offset:128
    buffer_load_dwordx4 v7, s[24:27], s64 offen offset:2048 lds
    v_mfma_f32_16x16x32_bf16 v[48:51], v[164:167], v[212:215], v[48:51]
    ds_read_b64_tr_b16 v[122:123], v5 offset:384
    s_add_u32 m0, s75, 33888
    v_mfma_f32_16x16x32_bf16 v[52:55], v[164:167], v[216:219], v[52:55]
    ds_read_b64_tr_b16 v[124:125], v5 offset:160
    v_mfma_f32_16x16x32_bf16 v[56:59], v[168:171], v[208:211], v[56:59]
    ds_read_b64_tr_b16 v[126:127], v5 offset:416
    buffer_load_dwordx4 v7, s[24:27], s64 offen offset:3072 lds
    v_mfma_f32_16x16x32_bf16 v[60:63], v[168:171], v[212:215], v[60:63]
    ds_read_b64_tr_b16 v[128:129], v5 offset:192
    s_add_u32 m0, s75, 38016
    s_add_u32 s64, s64, 4096
    v_mfma_f32_16x16x32_bf16 v[64:67], v[168:171], v[216:219], v[64:67]
    ds_read_b64_tr_b16 v[130:131], v5 offset:448
    buffer_load_dwordx4 v7, s[24:27], s64 offen offset:0 lds
    v_mfma_f32_16x16x32_bf16 v[68:71], v[172:175], v[208:211], v[68:71]
    ds_read_b64_tr_b16 v[132:133], v5 offset:224
    v_mfma_f32_16x16x32_bf16 v[72:75], v[172:175], v[212:215], v[72:75]
    ds_read_b64_tr_b16 v[134:135], v5 offset:480
    s_add_u32 m0, s75, 38048
    v_mfma_f32_16x16x32_bf16 v[76:79], v[172:175], v[216:219], v[76:79]
    buffer_load_dwordx4 v7, s[24:27], s64 offen offset:1024 lds
    v_mfma_f32_16x16x32_bf16 v[80:83], v[176:179], v[208:211], v[80:83]
    s_add_u32 m0, s75, 38080
    s_add_u32 s65, s86, 2
    s_and_b32 s65, s65, 7
    v_mfma_f32_16x16x32_bf16 v[84:87], v[176:179], v[212:215], v[84:87]
    v_mfma_f32_16x16x32_bf16 v[88:91], v[176:179], v[216:219], v[88:91]
    buffer_load_dwordx4 v7, s[24:27], s64 offen offset:2048 lds
    s_mul_i32 s65, s65, 3072
    v_mfma_f32_16x16x32_bf16 v[92:95], v[180:183], v[208:211], v[92:95]
    s_add_u32 m0, s75, 38112
    v_mfma_f32_16x16x32_bf16 v[96:99], v[180:183], v[212:215], v[96:99]
    buffer_load_dwordx4 v7, s[24:27], s64 offen offset:3072 lds
    v_add_u32 v248, s65, v1
    v_mfma_f32_16x16x32_bf16 v[100:103], v[180:183], v[216:219], v[100:103]
    s_waitcnt vmcnt(8)
    s_waitcnt lgkmcnt(0)
    v_mfma_f32_16x16x32_bf16 v[8:11], v[104:107], v[136:139], v[8:11]
    ds_read_b128 v[208:211], v248 offset:0
    ds_read_b128 v[212:215], v248 offset:1024
    s_add_u32 s64, s86, 4
    s_and_b32 s64, s64, 7
    v_mfma_f32_16x16x32_bf16 v[12:15], v[104:107], v[140:143], v[12:15]
    ds_read_b128 v[216:219], v248 offset:2048
    s_lshl_b32 s64, s64, 15
    s_add_u32 s64, s64, s70
    v_mfma_f32_16x16x32_bf16 v[16:19], v[104:107], v[144:147], v[16:19]
    ds_read_b64_tr_b16 v[152:153], v4 offset:0
    s_add_u32 m0, s75, 67584
    v_mfma_f32_16x16x32_bf16 v[20:23], v[108:111], v[136:139], v[20:23]
    ds_read_b64_tr_b16 v[154:155], v4 offset:256
    v_mfma_f32_16x16x32_bf16 v[24:27], v[108:111], v[140:143], v[24:27]
    ds_read_b64_tr_b16 v[156:157], v4 offset:32
    buffer_load_dwordx4 v7, s[24:27], s64 offen offset:0 lds
    v_mfma_f32_16x16x32_bf16 v[28:31], v[108:111], v[144:147], v[28:31]
    ds_read_b64_tr_b16 v[158:159], v4 offset:288
    s_add_u32 m0, s75, 67616
    v_mfma_f32_16x16x32_bf16 v[32:35], v[112:115], v[136:139], v[32:35]
    ds_read_b64_tr_b16 v[160:161], v4 offset:64
    buffer_load_dwordx4 v7, s[24:27], s64 offen offset:1024 lds
    v_mfma_f32_16x16x32_bf16 v[36:39], v[112:115], v[140:143], v[36:39]
    ds_read_b64_tr_b16 v[162:163], v4 offset:320
    v_mfma_f32_16x16x32_bf16 v[40:43], v[112:115], v[144:147], v[40:43]
    ds_read_b64_tr_b16 v[164:165], v4 offset:96
    ds_read_b64_tr_b16 v[166:167], v4 offset:352
    s_add_u32 m0, s75, 67648
    v_mfma_f32_16x16x32_bf16 v[44:47], v[116:119], v[136:139], v[44:47]
    ds_read_b64_tr_b16 v[168:169], v4 offset:128
    buffer_load_dwordx4 v7, s[24:27], s64 offen offset:2048 lds
    v_mfma_f32_16x16x32_bf16 v[48:51], v[116:119], v[140:143], v[48:51]
    ds_read_b64_tr_b16 v[170:171], v4 offset:384
    s_add_u32 m0, s75, 67680
    v_mfma_f32_16x16x32_bf16 v[52:55], v[116:119], v[144:147], v[52:55]
    ds_read_b64_tr_b16 v[172:173], v4 offset:160
    v_mfma_f32_16x16x32_bf16 v[56:59], v[120:123], v[136:139], v[56:59]
    ds_read_b64_tr_b16 v[174:175], v4 offset:416
    buffer_load_dwordx4 v7, s[24:27], s64 offen offset:3072 lds
    v_mfma_f32_16x16x32_bf16 v[60:63], v[120:123], v[140:143], v[60:63]
    ds_read_b64_tr_b16 v[176:177], v4 offset:192
    s_add_u32 m0, s75, 71808
    s_add_u32 s64, s64, 4096
    v_mfma_f32_16x16x32_bf16 v[64:67], v[120:123], v[144:147], v[64:67]
    ds_read_b64_tr_b16 v[178:179], v4 offset:448
    buffer_load_dwordx4 v7, s[24:27], s64 offen offset:0 lds
    v_mfma_f32_16x16x32_bf16 v[68:71], v[124:127], v[136:139], v[68:71]
    ds_read_b64_tr_b16 v[180:181], v4 offset:224
    v_mfma_f32_16x16x32_bf16 v[72:75], v[124:127], v[140:143], v[72:75]
    ds_read_b64_tr_b16 v[182:183], v4 offset:480
    s_add_u32 m0, s75, 71840
    v_mfma_f32_16x16x32_bf16 v[76:79], v[124:127], v[144:147], v[76:79]
    buffer_load_dwordx4 v7, s[24:27], s64 offen offset:1024 lds
    v_mfma_f32_16x16x32_bf16 v[80:83], v[128:131], v[136:139], v[80:83]
    s_add_u32 m0, s75, 71872
    s_add_u32 s65, s86, 3
    s_and_b32 s65, s65, 7
    v_mfma_f32_16x16x32_bf16 v[84:87], v[128:131], v[140:143], v[84:87]
    v_mfma_f32_16x16x32_bf16 v[88:91], v[128:131], v[144:147], v[88:91]
    buffer_load_dwordx4 v7, s[24:27], s64 offen offset:2048 lds
    s_mul_i32 s65, s65, 3072
    v_mfma_f32_16x16x32_bf16 v[92:95], v[132:135], v[136:139], v[92:95]
    s_add_u32 m0, s75, 71904
    v_mfma_f32_16x16x32_bf16 v[96:99], v[132:135], v[140:143], v[96:99]
    buffer_load_dwordx4 v7, s[24:27], s64 offen offset:3072 lds
    v_add_u32 v248, s65, v1
    v_mfma_f32_16x16x32_bf16 v[100:103], v[132:135], v[144:147], v[100:103]
    s_waitcnt vmcnt(8)
    s_waitcnt lgkmcnt(0)
    v_mfma_f32_16x16x32_bf16 v[8:11], v[152:155], v[208:211], v[8:11]
    ds_read_b128 v[136:139], v248 offset:0
    ds_read_b128 v[140:143], v248 offset:1024
    s_add_u32 s64, s86, 5
    s_and_b32 s64, s64, 7
    v_mfma_f32_16x16x32_bf16 v[12:15], v[152:155], v[212:215], v[12:15]
    ds_read_b128 v[144:147], v248 offset:2048
    s_lshl_b32 s64, s64, 15
    s_add_u32 s64, s64, s70
    v_mfma_f32_16x16x32_bf16 v[16:19], v[152:155], v[216:219], v[16:19]
    ds_read_b64_tr_b16 v[104:105], v4 offset:33792
    s_add_u32 m0, s75, 0
    v_mfma_f32_16x16x32_bf16 v[20:23], v[156:159], v[208:211], v[20:23]
    ds_read_b64_tr_b16 v[106:107], v4 offset:34048
    v_mfma_f32_16x16x32_bf16 v[24:27], v[156:159], v[212:215], v[24:27]
    ds_read_b64_tr_b16 v[108:109], v4 offset:33824
    buffer_load_dwordx4 v7, s[24:27], s64 offen offset:0 lds
    v_mfma_f32_16x16x32_bf16 v[28:31], v[156:159], v[216:219], v[28:31]
    ds_read_b64_tr_b16 v[110:111], v4 offset:34080
    s_add_u32 m0, s75, 32
    v_mfma_f32_16x16x32_bf16 v[32:35], v[160:163], v[208:211], v[32:35]
    ds_read_b64_tr_b16 v[112:113], v4 offset:33856
    buffer_load_dwordx4 v7, s[24:27], s64 offen offset:1024 lds
    v_mfma_f32_16x16x32_bf16 v[36:39], v[160:163], v[212:215], v[36:39]
    ds_read_b64_tr_b16 v[114:115], v4 offset:34112
    v_mfma_f32_16x16x32_bf16 v[40:43], v[160:163], v[216:219], v[40:43]
    ds_read_b64_tr_b16 v[116:117], v4 offset:33888
    ds_read_b64_tr_b16 v[118:119], v4 offset:34144
    s_add_u32 m0, s75, 64
    v_mfma_f32_16x16x32_bf16 v[44:47], v[164:167], v[208:211], v[44:47]
    ds_read_b64_tr_b16 v[120:121], v4 offset:33920
    buffer_load_dwordx4 v7, s[24:27], s64 offen offset:2048 lds
    v_mfma_f32_16x16x32_bf16 v[48:51], v[164:167], v[212:215], v[48:51]
    ds_read_b64_tr_b16 v[122:123], v4 offset:34176
    s_add_u32 m0, s75, 96
    v_mfma_f32_16x16x32_bf16 v[52:55], v[164:167], v[216:219], v[52:55]
    ds_read_b64_tr_b16 v[124:125], v4 offset:33952
    v_mfma_f32_16x16x32_bf16 v[56:59], v[168:171], v[208:211], v[56:59]
    ds_read_b64_tr_b16 v[126:127], v4 offset:34208
    buffer_load_dwordx4 v7, s[24:27], s64 offen offset:3072 lds
    v_mfma_f32_16x16x32_bf16 v[60:63], v[168:171], v[212:215], v[60:63]
    ds_read_b64_tr_b16 v[128:129], v4 offset:33984
    s_add_u32 m0, s75, 4224
    s_add_u32 s64, s64, 4096
    v_mfma_f32_16x16x32_bf16 v[64:67], v[168:171], v[216:219], v[64:67]
    ds_read_b64_tr_b16 v[130:131], v4 offset:34240
    buffer_load_dwordx4 v7, s[24:27], s64 offen offset:0 lds
    v_mfma_f32_16x16x32_bf16 v[68:71], v[172:175], v[208:211], v[68:71]
    ds_read_b64_tr_b16 v[132:133], v4 offset:34016
    v_mfma_f32_16x16x32_bf16 v[72:75], v[172:175], v[212:215], v[72:75]
    ds_read_b64_tr_b16 v[134:135], v4 offset:34272
    s_add_u32 m0, s75, 4256
    v_mfma_f32_16x16x32_bf16 v[76:79], v[172:175], v[216:219], v[76:79]
    buffer_load_dwordx4 v7, s[24:27], s64 offen offset:1024 lds
    v_mfma_f32_16x16x32_bf16 v[80:83], v[176:179], v[208:211], v[80:83]
    s_add_u32 m0, s75, 4288
    s_add_u32 s65, s86, 4
    s_and_b32 s65, s65, 7
    v_mfma_f32_16x16x32_bf16 v[84:87], v[176:179], v[212:215], v[84:87]
    v_mfma_f32_16x16x32_bf16 v[88:91], v[176:179], v[216:219], v[88:91]
    buffer_load_dwordx4 v7, s[24:27], s64 offen offset:2048 lds
    s_mul_i32 s65, s65, 3072
    v_mfma_f32_16x16x32_bf16 v[92:95], v[180:183], v[208:211], v[92:95]
    s_add_u32 m0, s75, 4320
    v_mfma_f32_16x16x32_bf16 v[96:99], v[180:183], v[212:215], v[96:99]
    buffer_load_dwordx4 v7, s[24:27], s64 offen offset:3072 lds
    v_add_u32 v248, s65, v1
    v_mfma_f32_16x16x32_bf16 v[100:103], v[180:183], v[216:219], v[100:103]
    s_waitcnt vmcnt(8)
    s_waitcnt lgkmcnt(0)
    v_mfma_f32_16x16x32_bf16 v[8:11], v[104:107], v[136:139], v[8:11]
    ds_read_b128 v[208:211], v248 offset:0
    ds_read_b128 v[212:215], v248 offset:1024
    s_add_u32 s64, s86, 6
    s_and_b32 s64, s64, 7
    v_mfma_f32_16x16x32_bf16 v[12:15], v[104:107], v[140:143], v[12:15]
    ds_read_b128 v[216:219], v248 offset:2048
    s_lshl_b32 s64, s64, 15
    s_add_u32 s64, s64, s70
    v_mfma_f32_16x16x32_bf16 v[16:19], v[104:107], v[144:147], v[16:19]
    ds_read_b64_tr_b16 v[152:153], v5 offset:0
    s_add_u32 m0, s75, 33792
    v_mfma_f32_16x16x32_bf16 v[20:23], v[108:111], v[136:139], v[20:23]
    ds_read_b64_tr_b16 v[154:155], v5 offset:256
    v_mfma_f32_16x16x32_bf16 v[24:27], v[108:111], v[140:143], v[24:27]
    ds_read_b64_tr_b16 v[156:157], v5 offset:32
    buffer_load_dwordx4 v7, s[24:27], s64 offen offset:0 lds
    v_mfma_f32_16x16x32_bf16 v[28:31], v[108:111], v[144:147], v[28:31]
    ds_read_b64_tr_b16 v[158:159], v5 offset:288
    s_add_u32 m0, s75, 33824
    v_mfma_f32_16x16x32_bf16 v[32:35], v[112:115], v[136:139], v[32:35]
    ds_read_b64_tr_b16 v[160:161], v5 offset:64
    buffer_load_dwordx4 v7, s[24:27], s64 offen offset:1024 lds
    v_mfma_f32_16x16x32_bf16 v[36:39], v[112:115], v[140:143], v[36:39]
    ds_read_b64_tr_b16 v[162:163], v5 offset:320
    v_mfma_f32_16x16x32_bf16 v[40:43], v[112:115], v[144:147], v[40:43]
    ds_read_b64_tr_b16 v[164:165], v5 offset:96
    ds_read_b64_tr_b16 v[166:167], v5 offset:352
    s_add_u32 m0, s75, 33856
    v_mfma_f32_16x16x32_bf16 v[44:47], v[116:119], v[136:139], v[44:47]
    ds_read_b64_tr_b16 v[168:169], v5 offset:128
    buffer_load_dwordx4 v7, s[24:27], s64 offen offset:2048 lds
    v_mfma_f32_16x16x32_bf16 v[48:51], v[116:119], v[140:143], v[48:51]
    ds_read_b64_tr_b16 v[170:171], v5 offset:384
    s_add_u32 m0, s75, 33888
    v_mfma_f32_16x16x32_bf16 v[52:55], v[116:119], v[144:147], v[52:55]
    ds_read_b64_tr_b16 v[172:173], v5 offset:160
    v_mfma_f32_16x16x32_bf16 v[56:59], v[120:123], v[136:139], v[56:59]
    ds_read_b64_tr_b16 v[174:175], v5 offset:416
    buffer_load_dwordx4 v7, s[24:27], s64 offen offset:3072 lds
    v_mfma_f32_16x16x32_bf16 v[60:63], v[120:123], v[140:143], v[60:63]
    ds_read_b64_tr_b16 v[176:177], v5 offset:192
    s_add_u32 m0, s75, 38016
    s_add_u32 s64, s64, 4096
    v_mfma_f32_16x16x32_bf16 v[64:67], v[120:123], v[144:147], v[64:67]
    ds_read_b64_tr_b16 v[178:179], v5 offset:448
    buffer_load_dwordx4 v7, s[24:27], s64 offen offset:0 lds
    v_mfma_f32_16x16x32_bf16 v[68:71], v[124:127], v[136:139], v[68:71]
    ds_read_b64_tr_b16 v[180:181], v5 offset:224
    v_mfma_f32_16x16x32_bf16 v[72:75], v[124:127], v[140:143], v[72:75]
    ds_read_b64_tr_b16 v[182:183], v5 offset:480
    s_add_u32 m0, s75, 38048
    v_mfma_f32_16x16x32_bf16 v[76:79], v[124:127], v[144:147], v[76:79]
    buffer_load_dwordx4 v7, s[24:27], s64 offen offset:1024 lds
    v_mfma_f32_16x16x32_bf16 v[80:83], v[128:131], v[136:139], v[80:83]
    s_add_u32 m0, s75, 38080
    s_add_u32 s65, s86, 5
    s_and_b32 s65, s65, 7
    v_mfma_f32_16x16x32_bf16 v[84:87], v[128:131], v[140:143], v[84:87]
    v_mfma_f32_16x16x32_bf16 v[88:91], v[128:131], v[144:147], v[88:91]
    buffer_load_dwordx4 v7, s[24:27], s64 offen offset:2048 lds
    s_mul_i32 s65, s65, 3072
    v_mfma_f32_16x16x32_bf16 v[92:95], v[132:135], v[136:139], v[92:95]
    s_add_u32 m0, s75, 38112
    v_mfma_f32_16x16x32_bf16 v[96:99], v[132:135], v[140:143], v[96:99]
    buffer_load_dwordx4 v7, s[24:27], s64 offen offset:3072 lds
    v_add_u32 v248, s65, v1
    v_mfma_f32_16x16x32_bf16 v[100:103], v[132:135], v[144:147], v[100:103]
    s_waitcnt vmcnt(8)
    s_waitcnt lgkmcnt(0)
    v_mfma_f32_16x16x32_bf16 v[8:11], v[152:155], v[208:211], v[8:11]
    ds_read_b128 v[136:139], v248 offset:0
    ds_read_b128 v[140:143], v248 offset:1024
    s_add_u32 s64, s86, 7
    s_and_b32 s64, s64, 7
    v_mfma_f32_16x16x32_bf16 v[12:15], v[152:155], v[212:215], v[12:15]
    ds_read_b128 v[144:147], v248 offset:2048
    s_lshl_b32 s64, s64, 15
    s_add_u32 s64, s64, s70
    v_mfma_f32_16x16x32_bf16 v[16:19], v[152:155], v[216:219], v[16:19]
    ds_read_b64_tr_b16 v[104:105], v4 offset:0
    s_add_u32 m0, s75, 67584
    v_mfma_f32_16x16x32_bf16 v[20:23], v[156:159], v[208:211], v[20:23]
    ds_read_b64_tr_b16 v[106:107], v4 offset:256
    v_mfma_f32_16x16x32_bf16 v[24:27], v[156:159], v[212:215], v[24:27]
    ds_read_b64_tr_b16 v[108:109], v4 offset:32
    buffer_load_dwordx4 v7, s[24:27], s64 offen offset:0 lds
    v_mfma_f32_16x16x32_bf16 v[28:31], v[156:159], v[216:219], v[28:31]
    ds_read_b64_tr_b16 v[110:111], v4 offset:288
    s_add_u32 m0, s75, 67616
    v_mfma_f32_16x16x32_bf16 v[32:35], v[160:163], v[208:211], v[32:35]
    ds_read_b64_tr_b16 v[112:113], v4 offset:64
    buffer_load_dwordx4 v7, s[24:27], s64 offen offset:1024 lds
    v_mfma_f32_16x16x32_bf16 v[36:39], v[160:163], v[212:215], v[36:39]
    ds_read_b64_tr_b16 v[114:115], v4 offset:320
    v_mfma_f32_16x16x32_bf16 v[40:43], v[160:163], v[216:219], v[40:43]
    ds_read_b64_tr_b16 v[116:117], v4 offset:96
    ds_read_b64_tr_b16 v[118:119], v4 offset:352
    s_add_u32 m0, s75, 67648
    v_mfma_f32_16x16x32_bf16 v[44:47], v[164:167], v[208:211], v[44:47]
    ds_read_b64_tr_b16 v[120:121], v4 offset:128
    buffer_load_dwordx4 v7, s[24:27], s64 offen offset:2048 lds
    v_mfma_f32_16x16x32_bf16 v[48:51], v[164:167], v[212:215], v[48:51]
    ds_read_b64_tr_b16 v[122:123], v4 offset:384
    s_add_u32 m0, s75, 67680
    v_mfma_f32_16x16x32_bf16 v[52:55], v[164:167], v[216:219], v[52:55]
    ds_read_b64_tr_b16 v[124:125], v4 offset:160
    v_mfma_f32_16x16x32_bf16 v[56:59], v[168:171], v[208:211], v[56:59]
    ds_read_b64_tr_b16 v[126:127], v4 offset:416
    buffer_load_dwordx4 v7, s[24:27], s64 offen offset:3072 lds
    v_mfma_f32_16x16x32_bf16 v[60:63], v[168:171], v[212:215], v[60:63]
    ds_read_b64_tr_b16 v[128:129], v4 offset:192
    s_add_u32 m0, s75, 71808
    s_add_u32 s64, s64, 4096
    v_mfma_f32_16x16x32_bf16 v[64:67], v[168:171], v[216:219], v[64:67]
    ds_read_b64_tr_b16 v[130:131], v4 offset:448
    buffer_load_dwordx4 v7, s[24:27], s64 offen offset:0 lds
    v_mfma_f32_16x16x32_bf16 v[68:71], v[172:175], v[208:211], v[68:71]
    ds_read_b64_tr_b16 v[132:133], v4 offset:224
    v_mfma_f32_16x16x32_bf16 v[72:75], v[172:175], v[212:215], v[72:75]
    ds_read_b64_tr_b16 v[134:135], v4 offset:480
    s_add_u32 m0, s75, 71840
    v_mfma_f32_16x16x32_bf16 v[76:79], v[172:175], v[216:219], v[76:79]
    buffer_load_dwordx4 v7, s[24:27], s64 offen offset:1024 lds
    v_mfma_f32_16x16x32_bf16 v[80:83], v[176:179], v[208:211], v[80:83]
    s_add_u32 m0, s75, 71872
    s_add_u32 s65, s86, 6
    s_and_b32 s65, s65, 7
    v_mfma_f32_16x16x32_bf16 v[84:87], v[176:179], v[212:215], v[84:87]
    v_mfma_f32_16x16x32_bf16 v[88:91], v[176:179], v[216:219], v[88:91]
    buffer_load_dwordx4 v7, s[24:27], s64 offen offset:2048 lds
    s_mul_i32 s65, s65, 3072
    v_mfma_f32_16x16x32_bf16 v[92:95], v[180:183], v[208:211], v[92:95]
    s_add_u32 m0, s75, 71904
    v_mfma_f32_16x16x32_bf16 v[96:99], v[180:183], v[212:215], v[96:99]
    buffer_load_dwordx4 v7, s[24:27], s64 offen offset:3072 lds
    v_add_u32 v248, s65, v1
    v_mfma_f32_16x16x32_bf16 v[100:103], v[180:183], v[216:219], v[100:103]
    s_waitcnt vmcnt(8)
    s_waitcnt lgkmcnt(0)
    v_mfma_f32_16x16x32_bf16 v[8:11], v[104:107], v[136:139], v[8:11]
    ds_read_b128 v[208:211], v248 offset:0
    ds_read_b128 v[212:215], v248 offset:1024
    v_mfma_f32_16x16x32_bf16 v[12:15], v[104:107], v[140:143], v[12:15]
    ds_read_b128 v[216:219], v248 offset:2048
    v_mfma_f32_16x16x32_bf16 v[16:19], v[104:107], v[144:147], v[16:19]
    ds_read_b64_tr_b16 v[152:153], v4 offset:33792
    v_mfma_f32_16x16x32_bf16 v[20:23], v[108:111], v[136:139], v[20:23]
    ds_read_b64_tr_b16 v[154:155], v4 offset:34048
    v_mfma_f32_16x16x32_bf16 v[24:27], v[108:111], v[140:143], v[24:27]
    ds_read_b64_tr_b16 v[156:157], v4 offset:33824
    v_mfma_f32_16x16x32_bf16 v[28:31], v[108:111], v[144:147], v[28:31]
    ds_read_b64_tr_b16 v[158:159], v4 offset:34080
    v_mfma_f32_16x16x32_bf16 v[32:35], v[112:115], v[136:139], v[32:35]
    ds_read_b64_tr_b16 v[160:161], v4 offset:33856
    v_mfma_f32_16x16x32_bf16 v[36:39], v[112:115], v[140:143], v[36:39]
    ds_read_b64_tr_b16 v[162:163], v4 offset:34112
    v_mfma_f32_16x16x32_bf16 v[40:43], v[112:115], v[144:147], v[40:43]
    ds_read_b64_tr_b16 v[164:165], v4 offset:33888
    ds_read_b64_tr_b16 v[166:167], v4 offset:34144
    v_mfma_f32_16x16x32_bf16 v[44:47], v[116:119], v[136:139], v[44:47]
    ds_read_b64_tr_b16 v[168:169], v4 offset:33920
    v_mfma_f32_16x16x32_bf16 v[48:51], v[116:119], v[140:143], v[48:51]
    ds_read_b64_tr_b16 v[170:171], v4 offset:34176
    v_mfma_f32_16x16x32_bf16 v[52:55], v[116:119], v[144:147], v[52:55]
    ds_read_b64_tr_b16 v[172:173], v4 offset:33952
    v_mfma_f32_16x16x32_bf16 v[56:59], v[120:123], v[136:139], v[56:59]
    ds_read_b64_tr_b16 v[174:175], v4 offset:34208
    v_mfma_f32_16x16x32_bf16 v[60:63], v[120:123], v[140:143], v[60:63]
    ds_read_b64_tr_b16 v[176:177], v4 offset:33984
    v_mfma_f32_16x16x32_bf16 v[64:67], v[120:123], v[144:147], v[64:67]
    ds_read_b64_tr_b16 v[178:179], v4 offset:34240
    v_mfma_f32_16x16x32_bf16 v[68:71], v[124:127], v[136:139], v[68:71]
    ds_read_b64_tr_b16 v[180:181], v4 offset:34016
    v_mfma_f32_16x16x32_bf16 v[72:75], v[124:127], v[140:143], v[72:75]
    ds_read_b64_tr_b16 v[182:183], v4 offset:34272
    v_mfma_f32_16x16x32_bf16 v[76:79], v[124:127], v[144:147], v[76:79]
    v_mfma_f32_16x16x32_bf16 v[80:83], v[128:131], v[136:139], v[80:83]
    s_add_u32 s65, s86, 7
    s_and_b32 s65, s65, 7
    v_mfma_f32_16x16x32_bf16 v[84:87], v[128:131], v[140:143], v[84:87]
    v_mfma_f32_16x16x32_bf16 v[88:91], v[128:131], v[144:147], v[88:91]
    s_mul_i32 s65, s65, 3072
    v_mfma_f32_16x16x32_bf16 v[92:95], v[132:135], v[136:139], v[92:95]
    v_mfma_f32_16x16x32_bf16 v[96:99], v[132:135], v[140:143], v[96:99]
    v_add_u32 v248, s65, v1
    v_mfma_f32_16x16x32_bf16 v[100:103], v[132:135], v[144:147], v[100:103]
    s_waitcnt vmcnt(0)
    s_waitcnt lgkmcnt(0)
    v_mfma_f32_16x16x32_bf16 v[8:11], v[152:155], v[208:211], v[8:11]
    ds_read_b128 v[136:139], v248 offset:0
    ds_read_b128 v[140:143], v248 offset:1024
    s_add_u32 s74, s4, 32
    s_lshl_b32 s74, s74, 2
    s_add_u32 s74, s74, s73
    v_mfma_f32_16x16x32_bf16 v[12:15], v[152:155], v[212:215], v[12:15]
    ds_read_b128 v[144:147], v248 offset:2048
    v_mfma_f32_16x16x32_bf16 v[16:19], v[152:155], v[216:219], v[16:19]
    ds_read_b64_tr_b16 v[104:105], v5 offset:0
    v_mfma_f32_16x16x32_bf16 v[20:23], v[156:159], v[208:211], v[20:23]
    ds_read_b64_tr_b16 v[106:107], v5 offset:256
    v_mfma_f32_16x16x32_bf16 v[24:27], v[156:159], v[212:215], v[24:27]
    ds_read_b64_tr_b16 v[108:109], v5 offset:32
    s_mul_i32 s74, s74, 98304
    s_lshl_b32 s66, s5, 10
    s_add_u32 s74, s74, s66
    v_mfma_f32_16x16x32_bf16 v[28:31], v[156:159], v[216:219], v[28:31]
    ds_read_b64_tr_b16 v[110:111], v5 offset:288
    v_mfma_f32_16x16x32_bf16 v[32:35], v[160:163], v[208:211], v[32:35]
    ds_read_b64_tr_b16 v[112:113], v5 offset:64
    v_mfma_f32_16x16x32_bf16 v[36:39], v[160:163], v[212:215], v[36:39]
    ds_read_b64_tr_b16 v[114:115], v5 offset:320
    v_mfma_f32_16x16x32_bf16 v[40:43], v[160:163], v[216:219], v[40:43]
    ds_read_b64_tr_b16 v[116:117], v5 offset:96
    ds_read_b64_tr_b16 v[118:119], v5 offset:352
    v_mfma_f32_16x16x32_bf16 v[44:47], v[164:167], v[208:211], v[44:47]
    ds_read_b64_tr_b16 v[120:121], v5 offset:128
    s_lshr_b32 s66, s5, 1
    s_and_b32 s63, s5, 1
    s_cmp_eq_u32 s66, s73
    s_cselect_b32 s63, s63, 2
    v_mfma_f32_16x16x32_bf16 v[48:51], v[164:167], v[212:215], v[48:51]
    ds_read_b64_tr_b16 v[122:123], v5 offset:384
    v_mfma_f32_16x16x32_bf16 v[52:55], v[164:167], v[216:219], v[52:55]
    ds_read_b64_tr_b16 v[124:125], v5 offset:160
    v_mfma_f32_16x16x32_bf16 v[56:59], v[168:171], v[208:211], v[56:59]
    ds_read_b64_tr_b16 v[126:127], v5 offset:416
    v_mfma_f32_16x16x32_bf16 v[60:63], v[168:171], v[212:215], v[60:63]
    ds_read_b64_tr_b16 v[128:129], v5 offset:192
    v_mfma_f32_16x16x32_bf16 v[64:67], v[168:171], v[216:219], v[64:67]
    ds_read_b64_tr_b16 v[130:131], v5 offset:448
    s_cmp_eq_u32 s63, 1
    s_cselect_b32 s89, 0x40000000, s74
    v_mfma_f32_16x16x32_bf16 v[68:71], v[172:175], v[208:211], v[68:71]
    ds_read_b64_tr_b16 v[132:133], v5 offset:224
    v_mfma_f32_16x16x32_bf16 v[72:75], v[172:175], v[212:215], v[72:75]
    ds_read_b64_tr_b16 v[134:135], v5 offset:480
    v_mfma_f32_16x16x32_bf16 v[76:79], v[172:175], v[216:219], v[76:79]
    v_mfma_f32_16x16x32_bf16 v[80:83], v[176:179], v[208:211], v[80:83]
    v_mfma_f32_16x16x32_bf16 v[84:87], v[176:179], v[212:215], v[84:87]
    s_cmp_eq_u32 s63, 0
    s_cselect_b32 s74, 0x40000000, s74
    v_mfma_f32_16x16x32_bf16 v[88:91], v[176:179], v[216:219], v[88:91]
    v_mfma_f32_16x16x32_bf16 v[92:95], v[180:183], v[208:211], v[92:95]
    v_mfma_f32_16x16x32_bf16 v[96:99], v[180:183], v[212:215], v[96:99]
    v_mfma_f32_16x16x32_bf16 v[100:103], v[180:183], v[216:219], v[100:103]
    s_waitcnt lgkmcnt(0)
    v_mfma_f32_16x16x32_bf16 v[8:11], v[104:107], v[136:139], v[8:11]
    v_mfma_f32_16x16x32_bf16 v[12:15], v[104:107], v[140:143], v[12:15]
    v_mfma_f32_16x16x32_bf16 v[16:19], v[104:107], v[144:147], v[16:19]
    v_mfma_f32_16x16x32_bf16 v[20:23], v[108:111], v[136:139], v[20:23]
    v_mfma_f32_16x16x32_bf16 v[24:27], v[108:111], v[140:143], v[24:27]
    v_mfma_f32_16x16x32_bf16 v[28:31], v[108:111], v[144:147], v[28:31]
    v_mfma_f32_16x16x32_bf16 v[32:35], v[112:115], v[136:139], v[32:35]
    v_mfma_f32_16x16x32_bf16 v[36:39], v[112:115], v[140:143], v[36:39]
    v_mfma_f32_16x16x32_bf16 v[40:43], v[112:115], v[144:147], v[40:43]
    v_mfma_f32_16x16x32_bf16 v[44:47], v[116:119], v[136:139], v[44:47]
    v_mfma_f32_16x16x32_bf16 v[48:51], v[116:119], v[140:143], v[48:51]
    v_cvt_pk_bf16_f32 v152, v8, v9
    v_cvt_pk_bf16_f32 v153, v10, v11
    v_cvt_pk_bf16_f32 v154, v20, v21
    v_mfma_f32_16x16x32_bf16 v[52:55], v[116:119], v[144:147], v[52:55]
    v_cvt_pk_bf16_f32 v155, v22, v23
    s_add_u32 s66, s74, 0
    buffer_store_dwordx4 v[152:155], v1, s[28:31], s66 offen sc1
    v_mfma_f32_16x16x32_bf16 v[56:59], v[120:123], v[136:139], v[56:59]
    v_cvt_pk_bf16_f32 v156, v12, v13
    v_cvt_pk_bf16_f32 v157, v14, v15
    v_cvt_pk_bf16_f32 v158, v24, v25
    v_mfma_f32_16x16x32_bf16 v[60:63], v[120:123], v[140:143], v[60:63]
    v_cvt_pk_bf16_f32 v159, v26, v27
    s_add_u32 s66, s74, 8192
    buffer_store_dwordx4 v[156:159], v1, s[28:31], s66 offen sc1
    v_mfma_f32_16x16x32_bf16 v[64:67], v[120:123], v[144:147], v[64:67]
    v_cvt_pk_bf16_f32 v160, v16, v17
    v_cvt_pk_bf16_f32 v161, v18, v19
    v_cvt_pk_bf16_f32 v162, v28, v29
    v_mfma_f32_16x16x32_bf16 v[68:71], v[124:127], v[136:139], v[68:71]
    v_cvt_pk_bf16_f32 v163, v30, v31
    s_add_u32 s66, s74, 16384
    buffer_store_dwordx4 v[160:163], v1, s[28:31], s66 offen sc1
    v_mfma_f32_16x16x32_bf16 v[72:75], v[124:127], v[140:143], v[72:75]
    v_cvt_pk_bf16_f32 v164, v32, v33
    v_cvt_pk_bf16_f32 v165, v34, v35
    v_cvt_pk_bf16_f32 v166, v44, v45
    v_mfma_f32_16x16x32_bf16 v[76:79], v[124:127], v[144:147], v[76:79]
    v_cvt_pk_bf16_f32 v167, v46, v47
    s_add_u32 s66, s74, 24576
    buffer_store_dwordx4 v[164:167], v1, s[28:31], s66 offen sc1
    v_mfma_f32_16x16x32_bf16 v[80:83], v[128:131], v[136:139], v[80:83]
    v_cvt_pk_bf16_f32 v168, v36, v37
    v_cvt_pk_bf16_f32 v169, v38, v39
    v_cvt_pk_bf16_f32 v170, v48, v49
    v_mfma_f32_16x16x32_bf16 v[84:87], v[128:131], v[140:143], v[84:87]
    v_cvt_pk_bf16_f32 v171, v50, v51
    s_add_u32 s66, s74, 32768
    buffer_store_dwordx4 v[168:171], v1, s[28:31], s66 offen sc1
    v_mfma_f32_16x16x32_bf16 v[88:91], v[128:131], v[144:147], v[88:91]
    v_cvt_pk_bf16_f32 v172, v40, v41
    v_cvt_pk_bf16_f32 v173, v42, v43
    v_cvt_pk_bf16_f32 v174, v52, v53
    v_mfma_f32_16x16x32_bf16 v[92:95], v[132:135], v[136:139], v[92:95]
    v_cvt_pk_bf16_f32 v175, v54, v55
    s_add_u32 s66, s74, 40960
    buffer_store_dwordx4 v[172:175], v1, s[28:31], s66 offen sc1
    v_mfma_f32_16x16x32_bf16 v[96:99], v[132:135], v[140:143], v[96:99]
    v_mfma_f32_16x16x32_bf16 v[100:103], v[132:135], v[144:147], v[100:103]
    v_cvt_pk_bf16_f32 v176, v56, v57
    v_cvt_pk_bf16_f32 v177, v58, v59
    v_cvt_pk_bf16_f32 v178, v68, v69
    v_cvt_pk_bf16_f32 v179, v70, v71
    s_add_u32 s66, s89, 49152
    buffer_store_dwordx4 v[176:179], v1, s[28:31], s66 offen sc1
    v_cvt_pk_bf16_f32 v180, v60, v61
    v_cvt_pk_bf16_f32 v181, v62, v63
    v_cvt_pk_bf16_f32 v182, v72, v73
    v_cvt_pk_bf16_f32 v183, v74, v75
    s_add_u32 s66, s89, 57344
    buffer_store_dwordx4 v[180:183], v1, s[28:31], s66 offen sc1
    v_cvt_pk_bf16_f32 v184, v64, v65
    v_cvt_pk_bf16_f32 v185, v66, v67
    v_cvt_pk_bf16_f32 v186, v76, v77
    v_cvt_pk_bf16_f32 v187, v78, v79
    s_add_u32 s66, s89, 65536
    buffer_store_dwordx4 v[184:187], v1, s[28:31], s66 offen sc1
    v_cvt_pk_bf16_f32 v188, v80, v81
    v_cvt_pk_bf16_f32 v189, v82, v83
    v_cvt_pk_bf16_f32 v190, v92, v93
    v_cvt_pk_bf16_f32 v191, v94, v95
    s_add_u32 s66, s89, 73728
    buffer_store_dwordx4 v[188:191], v1, s[28:31], s66 offen sc1
    v_cvt_pk_bf16_f32 v192, v84, v85
    v_cvt_pk_bf16_f32 v193, v86, v87
    v_cvt_pk_bf16_f32 v194, v96, v97
    v_cvt_pk_bf16_f32 v195, v98, v99
    s_add_u32 s66, s89, 81920
    buffer_store_dwordx4 v[192:195], v1, s[28:31], s66 offen sc1
    v_cvt_pk_bf16_f32 v196, v88, v89
    v_cvt_pk_bf16_f32 v197, v90, v91
    v_cvt_pk_bf16_f32 v198, v100, v101
    v_cvt_pk_bf16_f32 v199, v102, v103
    s_add_u32 s66, s89, 90112
    buffer_store_dwordx4 v[196:199], v1, s[28:31], s66 offen sc1
    s_cmp_eq_u32 s63, 0
    s_cbranch_scc0 L_c_4
    v_add_u32 v250, 136192, v1
    ds_write_b128 v250, v[152:155] offset:0
    ds_write_b128 v250, v[156:159] offset:1024
    ds_write_b128 v250, v[160:163] offset:2048
    ds_write_b128 v250, v[164:167] offset:3072
    ds_write_b128 v250, v[168:171] offset:4096
    ds_write_b128 v250, v[172:175] offset:5120
L_c_4:
    s_cmp_eq_u32 s63, 1
    s_cbranch_scc0 L_c_5
    v_add_u32 v250, 136192, v1
    ds_write_b128 v250, v[176:179] offset:0
    ds_write_b128 v250, v[180:183] offset:1024
    ds_write_b128 v250, v[184:187] offset:2048
    ds_write_b128 v250, v[188:191] offset:3072
    ds_write_b128 v250, v[192:195] offset:4096
    ds_write_b128 v250, v[196:199] offset:5120
L_c_5:
    v_mov_b32 v248, 163808
    v_mov_b32 v249, 1
    v_lshlrev_b32 v252, 7, v0
    s_lshl_b32 s64, s4, 10
    s_add_u32 s64, s64, 0x3000000
    s_lshl_b32 s66, s2, 7
    s_add_u32 s66, s66, 0x3000000
    s_mov_b64 exec, 1
    ds_read_b32 v253, v248 offset:8
    v_mov_b32 v251, 0
    s_waitcnt vmcnt(0)
    ds_add_rtn_u32 v250, v248, v249
    s_waitcnt lgkmcnt(0)
    v_readfirstlane_b32 s65, v250
    s_cmp_eq_u32 s65, 7
    s_cbranch_scc0 L_d_6
    s_mov_b64 exec, 0xff
    buffer_atomic_add v249, v252, s[28:31], s64 offen offset:0 sc1
    s_mov_b64 exec, 1
    v_readfirstlane_b32 s87, v253
    s_add_u32 s87, s87, 8
    s_mov_b32 s67, 200000
L_poll_8:
    s_sub_u32 s67, s67, 1
    s_cbranch_scc1 L_w_7
    buffer_load_dword v250, v251, s[28:31], s66 offen offset:0 sc1
    s_waitcnt vmcnt(0)
    v_readfirstlane_b32 s65, v250
    s_cmp_eq_u32 s65, s87
    s_cbranch_scc1 L_w_7
    s_sleep 1
    s_branch L_poll_8
L_w_7:
    ds_write_b32 v248, v249 offset:4
    s_waitcnt lgkmcnt(0)
L_d_6:
    s_mov_b64 exec, -1
    v_and_b32 v212, 15, v0
    v_lshrrev_b32 v208, 4, v0
    v_lshlrev_b32 v212, 11, v212
    v_lshl_add_u32 v212, v208, 4, v212
    s_mov_b32 s12, s56
    s_mov_b32 s13, s57
    s_mov_b32 s14, 0x300000
    s_mov_b32 s15, 0x20000
    s_mul_i32 s65, s5, 6
    s_add_u32 s65, s65, s6
    s_add_u32 s66, s4, 32
    s_mul_i32 s66, s66, 48
    s_add_u32 s66, s66, s65
    s_lshl_b32 s74, s66, 13
    s_mul_i32 s66, s65, 43
    s_lshr_b32 s66, s66, 7
    s_mul_i32 s67, s66, 3
    s_sub_u32 s67, s65, s67
    s_mul_i32 s72, s4, 3
    s_add_u32 s72, s72, s67
    s_lshl_b32 s72, s72, 15
    s_lshl_b32 s66, s66, 6
    s_add_u32 s72, s72, s66
    s_add_u32 s72, s72, 1024
    s_mul_i32 s65, s5, 6
    s_add_u32 s65, s65, s6
    s_add_u32 s66, s4, 0
    s_mul_i32 s66, s66, 48
    s_add_u32 s66, s66, s65
    s_lshl_b32 s89, s66, 13
    s_mul_i32 s66, s65, 43
    s_lshr_b32 s66, s66, 7
    s_mul_i32 s67, s66, 3
    s_sub_u32 s67, s65, s67
    s_mul_i32 s73, s4, 3
    s_add_u32 s73, s73, s67
    s_lshl_b32 s73, s73, 15
    s_lshl_b32 s66, s66, 6
    s_add_u32 s73, s73, s66
    v_mov_b32 v248, 163808
    s_mov_b32 s67, 4000000
L_f_9:
    s_sub_u32 s67, s67, 1
    s_cbranch_scc1 L_g_10
    ds_read_b32 v249, v248 offset:4
    s_waitcnt lgkmcnt(0)
    v_readfirstlane_b32 s65, v249
    s_cmp_lg_u32 s65, 0
    s_cbranch_scc1 L_g_10
    s_sleep 1
    s_branch L_f_9
L_g_10:
    s_lshl_b32 s65, s6, 10
    s_add_u32 s65, s65, 136192
    v_add_u32 v208, s65, v1
    ds_read_b128 v[224:227], v208
    s_add_u32 s65, s5, 1
    s_and_b32 s65, s65, 7
    s_lshl_b32 s65, s65, 10
    s_add_u32 s65, s65, s74
    buffer_load_dwordx4 v[8:11], v1, s[28:31], s65 offen sc1
    s_add_u32 s65, s5, 2
    s_and_b32 s65, s65, 7
    s_lshl_b32 s65, s65, 10
    s_add_u32 s65, s65, s74
    buffer_load_dwordx4 v[12:15], v1, s[28:31], s65 offen sc1
    s_add_u32 s65, s5, 3
    s_and_b32 s65, s65, 7
    s_lshl_b32 s65, s65, 10
    s_add_u32 s65, s65, s74
    buffer_load_dwordx4 v[16:19], v1, s[28:31], s65 offen sc1
    s_add_u32 s65, s5, 4
    s_and_b32 s65, s65, 7
    s_lshl_b32 s65, s65, 10
    s_add_u32 s65, s65, s74
    buffer_load_dwordx4 v[20:23], v1, s[28:31], s65 offen sc1
    s_add_u32 s65, s5, 5
    s_and_b32 s65, s65, 7
    s_lshl_b32 s65, s65, 10
    s_add_u32 s65, s65, s74
    buffer_load_dwordx4 v[24:27], v1, s[28:31], s65 offen sc1
    s_add_u32 s65, s5, 6
    s_and_b32 s65, s65, 7
    s_lshl_b32 s65, s65, 10
    s_add_u32 s65, s65, s74
    buffer_load_dwordx4 v[28:31], v1, s[28:31], s65 offen sc1
    s_add_u32 s65, s5, 7
    s_and_b32 s65, s65, 7
    s_lshl_b32 s65, s65, 10
    s_add_u32 s65, s65, s74
    buffer_load_dwordx4 v[32:35], v1, s[28:31], s65 offen sc1
    s_lshl_b32 s65, s6, 10
    s_add_u32 s65, s65, 130048
    v_add_u32 v208, s65, v1
    ds_read_b128 v[228:231], v208
    s_add_u32 s65, s5, 1
    s_and_b32 s65, s65, 7
    s_lshl_b32 s65, s65, 10
    s_add_u32 s65, s65, s89
    buffer_load_dwordx4 v[40:43], v1, s[28:31], s65 offen sc1
    s_add_u32 s65, s5, 2
    s_and_b32 s65, s65, 7
    s_lshl_b32 s65, s65, 10
    s_add_u32 s65, s65, s89
    buffer_load_dwordx4 v[44:47], v1, s[28:31], s65 offen sc1
    s_add_u32 s65, s5, 3
    s_and_b32 s65, s65, 7
    s_lshl_b32 s65, s65, 10
    s_add_u32 s65, s65, s89
    buffer_load_dwordx4 v[48:51], v1, s[28:31], s65 offen sc1
    s_add_u32 s65, s5, 4
    s_and_b32 s65, s65, 7
    s_lshl_b32 s65, s65, 10
    s_add_u32 s65, s65, s89
    buffer_load_dwordx4 v[52:55], v1, s[28:31], s65 offen sc1
    s_add_u32 s65, s5, 5
    s_and_b32 s65, s65, 7
    s_lshl_b32 s65, s65, 10
    s_add_u32 s65, s65, s89
    buffer_load_dwordx4 v[56:59], v1, s[28:31], s65 offen sc1
    s_add_u32 s65, s5, 6
    s_and_b32 s65, s65, 7
    s_lshl_b32 s65, s65, 10
    s_add_u32 s65, s65, s89
    buffer_load_dwordx4 v[60:63], v1, s[28:31], s65 offen sc1
    s_add_u32 s65, s5, 7
    s_and_b32 s65, s65, 7
    s_lshl_b32 s65, s65, 10
    s_add_u32 s65, s65, s89
    buffer_load_dwordx4 v[64:67], v1, s[28:31], s65 offen sc1
    s_waitcnt lgkmcnt(0)
    v_lshlrev_b32 v200, 16, v224
    v_and_b32 v201, 0xffff0000, v224
    v_lshlrev_b32 v202, 16, v225
    v_and_b32 v203, 0xffff0000, v225
    v_lshlrev_b32 v204, 16, v226
    v_and_b32 v205, 0xffff0000, v226
    v_lshlrev_b32 v206, 16, v227
    v_and_b32 v207, 0xffff0000, v227
    s_waitcnt vmcnt(13)
    v_lshlrev_b32 v208, 16, v8
    v_and_b32 v209, 0xffff0000, v8
    v_pk_add_f32 v[200:201], v[200:201], v[208:209]
    v_lshlrev_b32 v210, 16, v9
    v_and_b32 v211, 0xffff0000, v9
    v_pk_add_f32 v[202:203], v[202:203], v[210:211]
    v_lshlrev_b32 v208, 16, v10
    v_and_b32 v209, 0xffff0000, v10
    v_pk_add_f32 v[204:205], v[204:205], v[208:209]
    v_lshlrev_b32 v210, 16, v11
    v_and_b32 v211, 0xffff0000, v11
    v_pk_add_f32 v[206:207], v[206:207], v[210:211]
    s_waitcnt vmcnt(12)
    v_lshlrev_b32 v208, 16, v12
    v_and_b32 v209, 0xffff0000, v12
    v_pk_add_f32 v[200:201], v[200:201], v[208:209]
    v_lshlrev_b32 v210, 16, v13
    v_and_b32 v211, 0xffff0000, v13
    v_pk_add_f32 v[202:203], v[202:203], v[210:211]
    v_lshlrev_b32 v208, 16, v14
    v_and_b32 v209, 0xffff0000, v14
    v_pk_add_f32 v[204:205], v[204:205], v[208:209]
    v_lshlrev_b32 v210, 16, v15
    v_and_b32 v211, 0xffff0000, v15
    v_pk_add_f32 v[206:207], v[206:207], v[210:211]
    s_waitcnt vmcnt(11)
    v_lshlrev_b32 v208, 16, v16
    v_and_b32 v209, 0xffff0000, v16
    v_pk_add_f32 v[200:201], v[200:201], v[208:209]
    v_lshlrev_b32 v210, 16, v17
    v_and_b32 v211, 0xffff0000, v17
    v_pk_add_f32 v[202:203], v[202:203], v[210:211]
    v_lshlrev_b32 v208, 16, v18
    v_and_b32 v209, 0xffff0000, v18
    v_pk_add_f32 v[204:205], v[204:205], v[208:209]
    v_lshlrev_b32 v210, 16, v19
    v_and_b32 v211, 0xffff0000, v19
    v_pk_add_f32 v[206:207], v[206:207], v[210:211]
    s_waitcnt vmcnt(10)
    v_lshlrev_b32 v208, 16, v20
    v_and_b32 v209, 0xffff0000, v20
    v_pk_add_f32 v[200:201], v[200:201], v[208:209]
    v_lshlrev_b32 v210, 16, v21
    v_and_b32 v211, 0xffff0000, v21
    v_pk_add_f32 v[202:203], v[202:203], v[210:211]
    v_lshlrev_b32 v208, 16, v22
    v_and_b32 v209, 0xffff0000, v22
    v_pk_add_f32 v[204:205], v[204:205], v[208:209]
    v_lshlrev_b32 v210, 16, v23
    v_and_b32 v211, 0xffff0000, v23
    v_pk_add_f32 v[206:207], v[206:207], v[210:211]
    s_waitcnt vmcnt(9)
    v_lshlrev_b32 v208, 16, v24
    v_and_b32 v209, 0xffff0000, v24
    v_pk_add_f32 v[200:201], v[200:201], v[208:209]
    v_lshlrev_b32 v210, 16, v25
    v_and_b32 v211, 0xffff0000, v25
    v_pk_add_f32 v[202:203], v[202:203], v[210:211]
    v_lshlrev_b32 v208, 16, v26
    v_and_b32 v209, 0xffff0000, v26
    v_pk_add_f32 v[204:205], v[204:205], v[208:209]
    v_lshlrev_b32 v210, 16, v27
    v_and_b32 v211, 0xffff0000, v27
    v_pk_add_f32 v[206:207], v[206:207], v[210:211]
    s_waitcnt vmcnt(8)
    v_lshlrev_b32 v208, 16, v28
    v_and_b32 v209, 0xffff0000, v28
    v_pk_add_f32 v[200:201], v[200:201], v[208:209]
    v_lshlrev_b32 v210, 16, v29
    v_and_b32 v211, 0xffff0000, v29
    v_pk_add_f32 v[202:203], v[202:203], v[210:211]
    v_lshlrev_b32 v208, 16, v30
    v_and_b32 v209, 0xffff0000, v30
    v_pk_add_f32 v[204:205], v[204:205], v[208:209]
    v_lshlrev_b32 v210, 16, v31
    v_and_b32 v211, 0xffff0000, v31
    v_pk_add_f32 v[206:207], v[206:207], v[210:211]
    s_waitcnt vmcnt(7)
    v_lshlrev_b32 v208, 16, v32
    v_and_b32 v209, 0xffff0000, v32
    v_pk_add_f32 v[200:201], v[200:201], v[208:209]
    v_lshlrev_b32 v210, 16, v33
    v_and_b32 v211, 0xffff0000, v33
    v_pk_add_f32 v[202:203], v[202:203], v[210:211]
    v_lshlrev_b32 v208, 16, v34
    v_and_b32 v209, 0xffff0000, v34
    v_pk_add_f32 v[204:205], v[204:205], v[208:209]
    v_lshlrev_b32 v210, 16, v35
    v_and_b32 v211, 0xffff0000, v35
    v_pk_add_f32 v[206:207], v[206:207], v[210:211]
    v_cvt_pk_bf16_f32 v216, v200, v201
    v_cvt_pk_bf16_f32 v217, v202, v203
    v_cvt_pk_bf16_f32 v218, v204, v205
    v_cvt_pk_bf16_f32 v219, v206, v207
    s_nop 0
    v_permlane32_swap_b32 v216, v218
    v_permlane32_swap_b32 v217, v219
    s_nop 0
    v_permlane16_swap_b32 v216, v218
    v_permlane16_swap_b32 v217, v219
    s_waitcnt lgkmcnt(0)
    v_lshlrev_b32 v200, 16, v228
    v_and_b32 v201, 0xffff0000, v228
    v_lshlrev_b32 v202, 16, v229
    v_and_b32 v203, 0xffff0000, v229
    v_lshlrev_b32 v204, 16, v230
    v_and_b32 v205, 0xffff0000, v230
    v_lshlrev_b32 v206, 16, v231
    v_and_b32 v207, 0xffff0000, v231
    s_waitcnt vmcnt(6)
    v_lshlrev_b32 v208, 16, v40
    v_and_b32 v209, 0xffff0000, v40
    v_pk_add_f32 v[200:201], v[200:201], v[208:209]
    v_lshlrev_b32 v210, 16, v41
    v_and_b32 v211, 0xffff0000, v41
    v_pk_add_f32 v[202:203], v[202:203], v[210:211]
    v_lshlrev_b32 v208, 16, v42
    v_and_b32 v209, 0xffff0000, v42
    v_pk_add_f32 v[204:205], v[204:205], v[208:209]
    v_lshlrev_b32 v210, 16, v43
    v_and_b32 v211, 0xffff0000, v43
    v_pk_add_f32 v[206:207], v[206:207], v[210:211]
    s_waitcnt vmcnt(5)
    v_lshlrev_b32 v208, 16, v44
    v_and_b32 v209, 0xffff0000, v44
    v_pk_add_f32 v[200:201], v[200:201], v[208:209]
    v_lshlrev_b32 v210, 16, v45
    v_and_b32 v211, 0xffff0000, v45
    v_pk_add_f32 v[202:203], v[202:203], v[210:211]
    v_lshlrev_b32 v208, 16, v46
    v_and_b32 v209, 0xffff0000, v46
    v_pk_add_f32 v[204:205], v[204:205], v[208:209]
    v_lshlrev_b32 v210, 16, v47
    v_and_b32 v211, 0xffff0000, v47
    v_pk_add_f32 v[206:207], v[206:207], v[210:211]
    s_waitcnt vmcnt(4)
    v_lshlrev_b32 v208, 16, v48
    v_and_b32 v209, 0xffff0000, v48
    v_pk_add_f32 v[200:201], v[200:201], v[208:209]
    v_lshlrev_b32 v210, 16, v49
    v_and_b32 v211, 0xffff0000, v49
    v_pk_add_f32 v[202:203], v[202:203], v[210:211]
    v_lshlrev_b32 v208, 16, v50
    v_and_b32 v209, 0xffff0000, v50
    v_pk_add_f32 v[204:205], v[204:205], v[208:209]
    v_lshlrev_b32 v210, 16, v51
    v_and_b32 v211, 0xffff0000, v51
    v_pk_add_f32 v[206:207], v[206:207], v[210:211]
    s_waitcnt vmcnt(3)
    v_lshlrev_b32 v208, 16, v52
    v_and_b32 v209, 0xffff0000, v52
    v_pk_add_f32 v[200:201], v[200:201], v[208:209]
    v_lshlrev_b32 v210, 16, v53
    v_and_b32 v211, 0xffff0000, v53
    v_pk_add_f32 v[202:203], v[202:203], v[210:211]
    v_lshlrev_b32 v208, 16, v54
    v_and_b32 v209, 0xffff0000, v54
    v_pk_add_f32 v[204:205], v[204:205], v[208:209]
    v_lshlrev_b32 v210, 16, v55
    v_and_b32 v211, 0xffff0000, v55
    v_pk_add_f32 v[206:207], v[206:207], v[210:211]
    s_waitcnt vmcnt(2)
    v_lshlrev_b32 v208, 16, v56
    v_and_b32 v209, 0xffff0000, v56
    v_pk_add_f32 v[200:201], v[200:201], v[208:209]
    v_lshlrev_b32 v210, 16, v57
    v_and_b32 v211, 0xffff0000, v57
    v_pk_add_f32 v[202:203], v[202:203], v[210:211]
    v_lshlrev_b32 v208, 16, v58
    v_and_b32 v209, 0xffff0000, v58
    v_pk_add_f32 v[204:205], v[204:205], v[208:209]
    v_lshlrev_b32 v210, 16, v59
    v_and_b32 v211, 0xffff0000, v59
    v_pk_add_f32 v[206:207], v[206:207], v[210:211]
    s_waitcnt vmcnt(1)
    v_lshlrev_b32 v208, 16, v60
    v_and_b32 v209, 0xffff0000, v60
    v_pk_add_f32 v[200:201], v[200:201], v[208:209]
    v_lshlrev_b32 v210, 16, v61
    v_and_b32 v211, 0xffff0000, v61
    v_pk_add_f32 v[202:203], v[202:203], v[210:211]
    v_lshlrev_b32 v208, 16, v62
    v_and_b32 v209, 0xffff0000, v62
    v_pk_add_f32 v[204:205], v[204:205], v[208:209]
    v_lshlrev_b32 v210, 16, v63
    v_and_b32 v211, 0xffff0000, v63
    v_pk_add_f32 v[206:207], v[206:207], v[210:211]
    s_waitcnt vmcnt(0)
    v_lshlrev_b32 v208, 16, v64
    v_and_b32 v209, 0xffff0000, v64
    v_pk_add_f32 v[200:201], v[200:201], v[208:209]
    v_lshlrev_b32 v210, 16, v65
    v_and_b32 v211, 0xffff0000, v65
    v_pk_add_f32 v[202:203], v[202:203], v[210:211]
    v_lshlrev_b32 v208, 16, v66
    v_and_b32 v209, 0xffff0000, v66
    v_pk_add_f32 v[204:205], v[204:205], v[208:209]
    v_lshlrev_b32 v210, 16, v67
    v_and_b32 v211, 0xffff0000, v67
    v_pk_add_f32 v[206:207], v[206:207], v[210:211]
    v_cvt_pk_bf16_f32 v220, v200, v201
    v_cvt_pk_bf16_f32 v221, v202, v203
    v_cvt_pk_bf16_f32 v222, v204, v205
    v_cvt_pk_bf16_f32 v223, v206, v207
    buffer_store_dwordx4 v[216:219], v212, s[12:15], s72 offen sc1
    buffer_store_dwordx4 v[220:223], v212, s[12:15], s73 offen sc1
    s_branch L_fin
L_G1:
    s_lshl_b32 s65, s2, 2
    s_add_u32 s65, s65, s6
    s_sub_u32 s65, s65, 2
    s_lshl_b32 s62, s65, 17
    s_and_b32 s63, s65, 15
    v_mov_b32 v26, 0
    s_mov_b64 exec, 1
    buffer_load_dword v27, v26, s[12:15], s62 offen nt
    buffer_load_dword v27, v26, s[16:19], s62 offen nt
    s_lshl_b32 s65, s2, 17
    buffer_load_dword v27, v26, s[32:35], s65 offen nt
    s_mov_b32 s32, s38
    s_mov_b32 s33, s39
    buffer_load_dword v27, v26, s[32:35], s65 offen nt
    s_lshl_b32 s65, s5, 19
    buffer_load_dword v27, v26, s[24:27], s65 offen
    s_mov_b64 exec, -1
    s_barrier
    s_waitcnt vmcnt(0)
    v_mov_b32 v8, 0
    v_mov_b32 v9, 0
    v_mov_b32 v10, 0
    v_mov_b32 v11, 0
    v_mov_b32 v12, 0
    v_mov_b32 v13, 0
    v_mov_b32 v14, 0
    v_mov_b32 v15, 0
    v_mov_b32 v16, 0
    v_mov_b32 v17, 0
    v_mov_b32 v18, 0
    v_mov_b32 v19, 0
    v_mov_b32 v20, 0
    v_mov_b32 v21, 0
    v_mov_b32 v22, 0
    v_mov_b32 v23, 0
    v_mov_b32 v24, 0
    v_mov_b32 v25, 0
    v_mov_b32 v26, 0
    v_mov_b32 v27, 0
    v_mov_b32 v28, 0
    v_mov_b32 v29, 0
    v_mov_b32 v30, 0
    v_mov_b32 v31, 0
    v_mov_b32 v32, 0
    v_mov_b32 v33, 0
    v_mov_b32 v34, 0
    v_mov_b32 v35, 0
    v_mov_b32 v36, 0
    v_mov_b32 v37, 0
    v_mov_b32 v38, 0
    v_mov_b32 v39, 0
    v_mov_b32 v40, 0
    v_mov_b32 v41, 0
    v_mov_b32 v42, 0
    v_mov_b32 v43, 0
    v_mov_b32 v44, 0
    v_mov_b32 v45, 0
    v_mov_b32 v46, 0
    v_mov_b32 v47, 0
    v_mov_b32 v48, 0
    v_mov_b32 v49, 0
    v_mov_b32 v50, 0
    v_mov_b32 v51, 0
    v_mov_b32 v52, 0
    v_mov_b32 v53, 0
    v_mov_b32 v54, 0
    v_mov_b32 v55, 0
    v_mov_b32 v56, 0
    v_mov_b32 v57, 0
    v_mov_b32 v58, 0
    v_mov_b32 v59, 0
    v_mov_b32 v60, 0
    v_mov_b32 v61, 0
    v_mov_b32 v62, 0
    v_mov_b32 v63, 0
    v_mov_b32 v64, 0
    v_mov_b32 v65, 0
    v_mov_b32 v66, 0
    v_mov_b32 v67, 0
    v_mov_b32 v68, 0
    v_mov_b32 v69, 0
    v_mov_b32 v70, 0
    v_mov_b32 v71, 0
    v_mov_b32 v72, 0
    v_mov_b32 v73, 0
    v_mov_b32 v74, 0
    v_mov_b32 v75, 0
    v_mov_b32 v76, 0
    v_mov_b32 v77, 0
    v_mov_b32 v78, 0
    v_mov_b32 v79, 0
    v_mov_b32 v80, 0
    v_mov_b32 v81, 0
    v_mov_b32 v82, 0
    v_mov_b32 v83, 0
    v_mov_b32 v84, 0
    v_mov_b32 v85, 0
    v_mov_b32 v86, 0
    v_mov_b32 v87, 0
    v_mov_b32 v88, 0
    v_mov_b32 v89, 0
    v_mov_b32 v90, 0
    v_mov_b32 v91, 0
    v_mov_b32 v92, 0
    v_mov_b32 v93, 0
    v_mov_b32 v94, 0
    v_mov_b32 v95, 0
    v_mov_b32 v96, 0
    v_mov_b32 v97, 0
    v_mov_b32 v98, 0
    v_mov_b32 v99, 0
    v_mov_b32 v100, 0
    v_mov_b32 v101, 0
    v_mov_b32 v102, 0
    v_mov_b32 v103, 0
    s_barrier
    s_barrier
    s_barrier
    s_barrier
    s_barrier
    s_add_u32 s64, s63, 0
    s_and_b32 s64, s64, 15
    s_lshl_b32 s64, s64, 13
    s_add_u32 s64, s64, s62
    s_add_u32 m0, s76, 0
    s_nop 0
    buffer_load_dwordx4 v4, s[12:15], s64 offen offset:0 nt lds
    s_add_u32 m0, s76, 800
    s_nop 0
    buffer_load_dwordx4 v4, s[12:15], s64 offen offset:256 nt lds
    s_add_u32 m0, s76, 1600
    s_nop 0
    buffer_load_dwordx4 v4, s[12:15], s64 offen offset:512 nt lds
    s_add_u32 m0, s76, 2400
    s_nop 0
    buffer_load_dwordx4 v4, s[12:15], s64 offen offset:768 nt lds
    s_add_u32 m0, s76, 3200
    s_nop 0
    buffer_load_dwordx4 v5, s[12:15], s64 offen offset:1024 nt lds
    s_add_u32 m0, s76, 4000
    s_nop 0
    buffer_load_dwordx4 v5, s[12:15], s64 offen offset:1280 nt lds
    s_add_u32 m0, s76, 4800
    s_nop 0
    buffer_load_dwordx4 v5, s[12:15], s64 offen offset:1536 nt lds
    s_add_u32 m0, s76, 5600
    s_nop 0
    buffer_load_dwordx4 v5, s[12:15], s64 offen offset:1792 nt lds
    s_add_u32 m0, s76, 8448
    s_nop 0
    buffer_load_dwordx4 v6, s[16:19], s64 offen offset:0 nt lds
    s_add_u32 m0, s76, 9248
    s_nop 0
    buffer_load_dwordx4 v6, s[16:19], s64 offen offset:256 nt lds
    s_add_u32 m0, s76, 10048
    s_nop 0
    buffer_load_dwordx4 v6, s[16:19], s64 offen offset:512 nt lds
    s_add_u32 m0, s76, 10848
    s_nop 0
    buffer_load_dwordx4 v6, s[16:19], s64 offen offset:768 nt lds
    s_add_u32 m0, s76, 11648
    s_nop 0
    buffer_load_dwordx4 v6, s[16:19], s64 offen offset:1024 nt lds
    s_add_u32 m0, s76, 12448
    s_nop 0
    buffer_load_dwordx4 v6, s[16:19], s64 offen offset:1280 nt lds
    s_add_u32 m0, s76, 13248
    s_nop 0
    buffer_load_dwordx4 v6, s[16:19], s64 offen offset:1536 nt lds
    s_add_u32 m0, s76, 14048
    s_nop 0
    buffer_load_dwordx4 v6, s[16:19], s64 offen offset:1792 nt lds
    s_barrier
    s_barrier
    s_add_u32 s64, s63, 1
    s_and_b32 s64, s64, 15
    s_lshl_b32 s64, s64, 13
    s_add_u32 s64, s64, s62
    s_add_u32 m0, s76, 33792
    s_nop 0
    buffer_load_dwordx4 v4, s[12:15], s64 offen offset:0 nt lds
    s_add_u32 m0, s76, 34592
    s_nop 0
    buffer_load_dwordx4 v4, s[12:15], s64 offen offset:256 nt lds
    s_add_u32 m0, s76, 35392
    s_nop 0
    buffer_load_dwordx4 v4, s[12:15], s64 offen offset:512 nt lds
    s_add_u32 m0, s76, 36192
    s_nop 0
    buffer_load_dwordx4 v4, s[12:15], s64 offen offset:768 nt lds
    s_add_u32 m0, s76, 36992
    s_nop 0
    buffer_load_dwordx4 v5, s[12:15], s64 offen offset:1024 nt lds
    s_add_u32 m0, s76, 37792
    s_nop 0
    buffer_load_dwordx4 v5, s[12:15], s64 offen offset:1280 nt lds
    s_add_u32 m0, s76, 38592
    s_nop 0
    buffer_load_dwordx4 v5, s[12:15], s64 offen offset:1536 nt lds
    s_add_u32 m0, s76, 39392
    s_nop 0
    buffer_load_dwordx4 v5, s[12:15], s64 offen offset:1792 nt lds
    s_add_u32 m0, s76, 42240
    s_nop 0
    buffer_load_dwordx4 v6, s[16:19], s64 offen offset:0 nt lds
    s_add_u32 m0, s76, 43040
    s_nop 0
    buffer_load_dwordx4 v6, s[16:19], s64 offen offset:256 nt lds
    s_add_u32 m0, s76, 43840
    s_nop 0
    buffer_load_dwordx4 v6, s[16:19], s64 offen offset:512 nt lds
    s_add_u32 m0, s76, 44640
    s_nop 0
    buffer_load_dwordx4 v6, s[16:19], s64 offen offset:768 nt lds
    s_add_u32 m0, s76, 45440
    s_nop 0
    buffer_load_dwordx4 v6, s[16:19], s64 offen offset:1024 nt lds
    s_add_u32 m0, s76, 46240
    s_nop 0
    buffer_load_dwordx4 v6, s[16:19], s64 offen offset:1280 nt lds
    s_add_u32 m0, s76, 47040
    s_nop 0
    buffer_load_dwordx4 v6, s[16:19], s64 offen offset:1536 nt lds
    s_add_u32 m0, s76, 47840
    s_nop 0
    buffer_load_dwordx4 v6, s[16:19], s64 offen offset:1792 nt lds
    s_barrier
    s_add_u32 s72, s86, 7
    s_and_b32 s72, s72, 7
    s_add_u32 s64, s72, 0
    s_and_b32 s64, s64, 7
    s_lshl_b32 s64, s64, 1
    s_add_u32 s64, s64, s82
    s_lshl_b32 s64, s64, 18
    s_add_u32 s64, s64, s69
    s_add_u32 m0, s75, 0
    s_nop 0
    buffer_load_dwordx4 v184, s[20:23], s64 offen offset:0 lds
    buffer_load_dwordx4 v185, s[20:23], s64 offen offset:1056 lds
    buffer_load_dwordx4 v186, s[20:23], s64 offen offset:2112 lds
    buffer_load_dwordx4 v187, s[20:23], s64 offen offset:3168 lds
    s_add_u32 m0, s75, 4224
    s_nop 0
    buffer_load_dwordx4 v188, s[20:23], s64 offen offset:0 lds
    buffer_load_dwordx4 v189, s[20:23], s64 offen offset:1056 lds
    buffer_load_dwordx4 v190, s[20:23], s64 offen offset:2112 lds
    buffer_load_dwordx4 v191, s[20:23], s64 offen offset:3168 lds
    s_add_u32 s64, s72, 0
    s_and_b32 s64, s64, 7
    s_lshl_b32 s64, s64, 1
    s_add_u32 s64, s64, s83
    s_lshl_b32 s64, s64, 18
    s_add_u32 s64, s64, s69
    s_add_u32 m0, s75, 8448
    s_nop 0
    buffer_load_dwordx4 v184, s[20:23], s64 offen offset:0 lds
    buffer_load_dwordx4 v185, s[20:23], s64 offen offset:1056 lds
    buffer_load_dwordx4 v186, s[20:23], s64 offen offset:2112 lds
    buffer_load_dwordx4 v187, s[20:23], s64 offen offset:3168 lds
    s_add_u32 m0, s75, 12672
    s_nop 0
    buffer_load_dwordx4 v188, s[20:23], s64 offen offset:0 lds
    buffer_load_dwordx4 v189, s[20:23], s64 offen offset:1056 lds
    buffer_load_dwordx4 v190, s[20:23], s64 offen offset:2112 lds
    buffer_load_dwordx4 v191, s[20:23], s64 offen offset:3168 lds
    s_waitcnt vmcnt(32)
    s_add_u32 s64, s63, 2
    s_and_b32 s64, s64, 15
    s_lshl_b32 s64, s64, 13
    s_add_u32 s64, s64, s62
    s_add_u32 m0, s76, 67584
    s_nop 0
    buffer_load_dwordx4 v4, s[12:15], s64 offen offset:0 nt lds
    s_add_u32 m0, s76, 68384
    s_nop 0
    buffer_load_dwordx4 v4, s[12:15], s64 offen offset:256 nt lds
    s_add_u32 m0, s76, 69184
    s_nop 0
    buffer_load_dwordx4 v4, s[12:15], s64 offen offset:512 nt lds
    s_add_u32 m0, s76, 69984
    s_nop 0
    buffer_load_dwordx4 v4, s[12:15], s64 offen offset:768 nt lds
    s_add_u32 m0, s76, 70784
    s_nop 0
    buffer_load_dwordx4 v5, s[12:15], s64 offen offset:1024 nt lds
    s_add_u32 m0, s76, 71584
    s_nop 0
    buffer_load_dwordx4 v5, s[12:15], s64 offen offset:1280 nt lds
    s_add_u32 m0, s76, 72384
    s_nop 0
    buffer_load_dwordx4 v5, s[12:15], s64 offen offset:1536 nt lds
    s_add_u32 m0, s76, 73184
    s_nop 0
    buffer_load_dwordx4 v5, s[12:15], s64 offen offset:1792 nt lds
    s_add_u32 m0, s76, 76032
    s_nop 0
    buffer_load_dwordx4 v6, s[16:19], s64 offen offset:0 nt lds
    s_add_u32 m0, s76, 76832
    s_nop 0
    buffer_load_dwordx4 v6, s[16:19], s64 offen offset:256 nt lds
    s_add_u32 m0, s76, 77632
    s_nop 0
    buffer_load_dwordx4 v6, s[16:19], s64 offen offset:512 nt lds
    s_add_u32 m0, s76, 78432
    s_nop 0
    buffer_load_dwordx4 v6, s[16:19], s64 offen offset:768 nt lds
    s_add_u32 m0, s76, 79232
    s_nop 0
    buffer_load_dwordx4 v6, s[16:19], s64 offen offset:1024 nt lds
    s_add_u32 m0, s76, 80032
    s_nop 0
    buffer_load_dwordx4 v6, s[16:19], s64 offen offset:1280 nt lds
    s_add_u32 m0, s76, 80832
    s_nop 0
    buffer_load_dwordx4 v6, s[16:19], s64 offen offset:1536 nt lds
    s_add_u32 m0, s76, 81632
    s_nop 0
    buffer_load_dwordx4 v6, s[16:19], s64 offen offset:1792 nt lds
    s_and_b32 s66, s6, 1
    s_mul_i32 s65, s66, 24576
    s_add_u32 s71, s71, s65
    s_mul_i32 s70, s66, 3072
    v_add_u32 v249, s75, v2
    s_mov_b32 s74, 18432
    s_mov_b32 s68, 0
    s_waitcnt vmcnt(24)
L_G1_q:
    s_barrier
    s_lshl_b32 s65, s82, 6
    v_xor_b32 v248, s65, v245
    v_add_u32 v248, s74, v248
    ds_read_b128 v[208:211], v248 offset:0
    ds_read_b128 v[212:215], v248 offset:2048
    ds_read_b128 v[216:219], v248 offset:4096
    ds_read_b64_tr_b16 v[152:153], v249 offset:0
    ds_read_b64_tr_b16 v[154:155], v249 offset:256
    ds_read_b64_tr_b16 v[156:157], v249 offset:32
    ds_read_b64_tr_b16 v[158:159], v249 offset:288
    ds_read_b64_tr_b16 v[160:161], v249 offset:64
    ds_read_b64_tr_b16 v[162:163], v249 offset:320
    ds_read_b64_tr_b16 v[164:165], v249 offset:96
    ds_read_b64_tr_b16 v[166:167], v249 offset:352
    ds_read_b64_tr_b16 v[168:169], v249 offset:128
    ds_read_b64_tr_b16 v[170:171], v249 offset:384
    ds_read_b64_tr_b16 v[172:173], v249 offset:160
    ds_read_b64_tr_b16 v[174:175], v249 offset:416
    s_waitcnt lgkmcnt(10)
    ds_read_b64_tr_b16 v[176:177], v249 offset:192
    ds_read_b64_tr_b16 v[178:179], v249 offset:448
    ds_read_b64_tr_b16 v[180:181], v249 offset:224
    ds_read_b64_tr_b16 v[182:183], v249 offset:480
    s_waitcnt lgkmcnt(0)
    s_sub_u32 s65, s68, 1
    s_cmp_lt_u32 s65, 6
    s_cbranch_scc0 L_nx_11
    s_xor_b32 s87, s74, 30720
    s_add_u32 s87, s87, s70
    s_add_u32 s73, s72, 7
    s_and_b32 s73, s73, 7
    s_lshl_b32 s67, s73, 7
    s_add_u32 s67, s67, s71
    s_add_u32 m0, s87, 0
    s_add_u32 s67, s67, 0
    buffer_load_dwordx4 v246, s[8:11], s67 offen lds
    s_lshl_b32 s67, s73, 7
    s_add_u32 s67, s67, s71
    s_add_u32 m0, s87, 1024
    s_add_u32 s67, s67, 8192
    buffer_load_dwordx4 v246, s[8:11], s67 offen lds
    s_lshl_b32 s67, s73, 7
    s_add_u32 s67, s67, s71
    s_add_u32 m0, s87, 2048
    s_add_u32 s67, s67, 16384
    buffer_load_dwordx4 v246, s[8:11], s67 offen lds
L_nx_11:
    s_cmp_eq_u32 s68, 7
    s_cbranch_scc1 L_c_12
    s_add_u32 s64, s72, 7
    s_and_b32 s64, s64, 7
    s_lshl_b32 s64, s64, 1
    s_add_u32 s64, s64, s82
    s_lshl_b32 s64, s64, 18
    s_add_u32 s64, s64, s69
    s_add_u32 m0, s75, 0
    s_nop 0
    buffer_load_dwordx4 v184, s[20:23], s64 offen offset:0 lds
    buffer_load_dwordx4 v185, s[20:23], s64 offen offset:1056 lds
    buffer_load_dwordx4 v186, s[20:23], s64 offen offset:2112 lds
    buffer_load_dwordx4 v187, s[20:23], s64 offen offset:3168 lds
    s_add_u32 m0, s75, 4224
    s_nop 0
    buffer_load_dwordx4 v188, s[20:23], s64 offen offset:0 lds
    buffer_load_dwordx4 v189, s[20:23], s64 offen offset:1056 lds
    buffer_load_dwordx4 v190, s[20:23], s64 offen offset:2112 lds
    buffer_load_dwordx4 v191, s[20:23], s64 offen offset:3168 lds
L_c_12:
    s_barrier
    v_mfma_f32_16x16x32_bf16 v[8:11], v[152:155], v[208:211], v[8:11]
    v_mfma_f32_16x16x32_bf16 v[12:15], v[152:155], v[212:215], v[12:15]
    v_mfma_f32_16x16x32_bf16 v[16:19], v[152:155], v[216:219], v[16:19]
    v_mfma_f32_16x16x32_bf16 v[20:23], v[156:159], v[208:211], v[20:23]
    v_mfma_f32_16x16x32_bf16 v[24:27], v[156:159], v[212:215], v[24:27]
    v_mfma_f32_16x16x32_bf16 v[28:31], v[156:159], v[216:219], v[28:31]
    v_mfma_f32_16x16x32_bf16 v[32:35], v[160:163], v[208:211], v[32:35]
    v_mfma_f32_16x16x32_bf16 v[36:39], v[160:163], v[212:215], v[36:39]
    v_mfma_f32_16x16x32_bf16 v[40:43], v[160:163], v[216:219], v[40:43]
    v_mfma_f32_16x16x32_bf16 v[44:47], v[164:167], v[208:211], v[44:47]
    v_mfma_f32_16x16x32_bf16 v[48:51], v[164:167], v[212:215], v[48:51]
    v_mfma_f32_16x16x32_bf16 v[52:55], v[164:167], v[216:219], v[52:55]
    v_mfma_f32_16x16x32_bf16 v[56:59], v[168:171], v[208:211], v[56:59]
    v_mfma_f32_16x16x32_bf16 v[60:63], v[168:171], v[212:215], v[60:63]
    v_mfma_f32_16x16x32_bf16 v[64:67], v[168:171], v[216:219], v[64:67]
    v_mfma_f32_16x16x32_bf16 v[68:71], v[172:175], v[208:211], v[68:71]
    v_mfma_f32_16x16x32_bf16 v[72:75], v[172:175], v[212:215], v[72:75]
    v_mfma_f32_16x16x32_bf16 v[76:79], v[172:175], v[216:219], v[76:79]
    v_mfma_f32_16x16x32_bf16 v[80:83], v[176:179], v[208:211], v[80:83]
    v_mfma_f32_16x16x32_bf16 v[84:87], v[176:179], v[212:215], v[84:87]
    v_mfma_f32_16x16x32_bf16 v[88:91], v[176:179], v[216:219], v[88:91]
    v_mfma_f32_16x16x32_bf16 v[92:95], v[180:183], v[208:211], v[92:95]
    v_mfma_f32_16x16x32_bf16 v[96:99], v[180:183], v[212:215], v[96:99]
    v_mfma_f32_16x16x32_bf16 v[100:103], v[180:183], v[216:219], v[100:103]
    s_cmp_eq_u32 s68, 7
    s_cbranch_scc0 L_c_13
    s_waitcnt vmcnt(0)
L_c_13:
    s_waitcnt vmcnt(8)
    s_barrier
    s_lshl_b32 s65, s83, 6
    v_xor_b32 v248, s65, v245
    v_add_u32 v248, s74, v248
    ds_read_b128 v[208:211], v248 offset:0
    ds_read_b128 v[212:215], v248 offset:2048
    ds_read_b128 v[216:219], v248 offset:4096
    ds_read_b64_tr_b16 v[152:153], v249 offset:8448
    ds_read_b64_tr_b16 v[154:155], v249 offset:8704
    ds_read_b64_tr_b16 v[156:157], v249 offset:8480
    ds_read_b64_tr_b16 v[158:159], v249 offset:8736
    ds_read_b64_tr_b16 v[160:161], v249 offset:8512
    ds_read_b64_tr_b16 v[162:163], v249 offset:8768
    ds_read_b64_tr_b16 v[164:165], v249 offset:8544
    ds_read_b64_tr_b16 v[166:167], v249 offset:8800
    ds_read_b64_tr_b16 v[168:169], v249 offset:8576
    ds_read_b64_tr_b16 v[170:171], v249 offset:8832
    ds_read_b64_tr_b16 v[172:173], v249 offset:8608
    ds_read_b64_tr_b16 v[174:175], v249 offset:8864
    s_waitcnt lgkmcnt(10)
    ds_read_b64_tr_b16 v[176:177], v249 offset:8640
    ds_read_b64_tr_b16 v[178:179], v249 offset:8896
    ds_read_b64_tr_b16 v[180:181], v249 offset:8672
    ds_read_b64_tr_b16 v[182:183], v249 offset:8928
    s_waitcnt lgkmcnt(0)
    s_cmp_eq_u32 s68, 7
    s_cbranch_scc1 L_c_14
    s_add_u32 s64, s72, 7
    s_and_b32 s64, s64, 7
    s_lshl_b32 s64, s64, 1
    s_add_u32 s64, s64, s83
    s_lshl_b32 s64, s64, 18
    s_add_u32 s64, s64, s69
    s_add_u32 m0, s75, 8448
    s_nop 0
    buffer_load_dwordx4 v184, s[20:23], s64 offen offset:0 lds
    buffer_load_dwordx4 v185, s[20:23], s64 offen offset:1056 lds
    buffer_load_dwordx4 v186, s[20:23], s64 offen offset:2112 lds
    buffer_load_dwordx4 v187, s[20:23], s64 offen offset:3168 lds
    s_add_u32 m0, s75, 12672
    s_nop 0
    buffer_load_dwordx4 v188, s[20:23], s64 offen offset:0 lds
    buffer_load_dwordx4 v189, s[20:23], s64 offen offset:1056 lds
    buffer_load_dwordx4 v190, s[20:23], s64 offen offset:2112 lds
    buffer_load_dwordx4 v191, s[20:23], s64 offen offset:3168 lds
L_c_14:
    s_barrier
    v_mfma_f32_16x16x32_bf16 v[8:11], v[152:155], v[208:211], v[8:11]
    v_mfma_f32_16x16x32_bf16 v[12:15], v[152:155], v[212:215], v[12:15]
    v_mfma_f32_16x16x32_bf16 v[16:19], v[152:155], v[216:219], v[16:19]
    v_mfma_f32_16x16x32_bf16 v[20:23], v[156:159], v[208:211], v[20:23]
    v_mfma_f32_16x16x32_bf16 v[24:27], v[156:159], v[212:215], v[24:27]
    v_mfma_f32_16x16x32_bf16 v[28:31], v[156:159], v[216:219], v[28:31]
    v_mfma_f32_16x16x32_bf16 v[32:35], v[160:163], v[208:211], v[32:35]
    v_mfma_f32_16x16x32_bf16 v[36:39], v[160:163], v[212:215], v[36:39]
    v_mfma_f32_16x16x32_bf16 v[40:43], v[160:163], v[216:219], v[40:43]
    v_mfma_f32_16x16x32_bf16 v[44:47], v[164:167], v[208:211], v[44:47]
    v_mfma_f32_16x16x32_bf16 v[48:51], v[164:167], v[212:215], v[48:51]
    v_mfma_f32_16x16x32_bf16 v[52:55], v[164:167], v[216:219], v[52:55]
    v_mfma_f32_16x16x32_bf16 v[56:59], v[168:171], v[208:211], v[56:59]
    v_mfma_f32_16x16x32_bf16 v[60:63], v[168:171], v[212:215], v[60:63]
    v_mfma_f32_16x16x32_bf16 v[64:67], v[168:171], v[216:219], v[64:67]
    v_mfma_f32_16x16x32_bf16 v[68:71], v[172:175], v[208:211], v[68:71]
    v_mfma_f32_16x16x32_bf16 v[72:75], v[172:175], v[212:215], v[72:75]
    v_mfma_f32_16x16x32_bf16 v[76:79], v[172:175], v[216:219], v[76:79]
    v_mfma_f32_16x16x32_bf16 v[80:83], v[176:179], v[208:211], v[80:83]
    v_mfma_f32_16x16x32_bf16 v[84:87], v[176:179], v[212:215], v[84:87]
    v_mfma_f32_16x16x32_bf16 v[88:91], v[176:179], v[216:219], v[88:91]
    v_mfma_f32_16x16x32_bf16 v[92:95], v[180:183], v[208:211], v[92:95]
    v_mfma_f32_16x16x32_bf16 v[96:99], v[180:183], v[212:215], v[96:99]
    v_mfma_f32_16x16x32_bf16 v[100:103], v[180:183], v[216:219], v[100:103]
    s_waitcnt vmcnt(8)
    s_add_u32 s72, s72, 7
    s_and_b32 s72, s72, 7
    s_xor_b32 s74, s74, 30720
    s_add_u32 s68, s68, 1
    s_cmp_lt_u32 s68, 8
    s_cbranch_scc1 L_G1_q
    s_barrier
    s_nop 7
    v_pk_mul_f32 v[8:9], v[8:9], s[88:89] op_sel_hi:[1,0]
    v_pk_mul_f32 v[10:11], v[10:11], s[88:89] op_sel_hi:[1,0]
    v_pk_mul_f32 v[12:13], v[12:13], s[88:89] op_sel_hi:[1,0]
    v_pk_mul_f32 v[14:15], v[14:15], s[88:89] op_sel_hi:[1,0]
    v_pk_mul_f32 v[16:17], v[16:17], s[88:89] op_sel_hi:[1,0]
    v_pk_mul_f32 v[18:19], v[18:19], s[88:89] op_sel_hi:[1,0]
    v_pk_mul_f32 v[20:21], v[20:21], s[88:89] op_sel_hi:[1,0]
    v_pk_mul_f32 v[22:23], v[22:23], s[88:89] op_sel_hi:[1,0]
    v_pk_mul_f32 v[24:25], v[24:25], s[88:89] op_sel_hi:[1,0]
    v_pk_mul_f32 v[26:27], v[26:27], s[88:89] op_sel_hi:[1,0]
    v_pk_mul_f32 v[28:29], v[28:29], s[88:89] op_sel_hi:[1,0]
    v_pk_mul_f32 v[30:31], v[30:31], s[88:89] op_sel_hi:[1,0]
    v_pk_mul_f32 v[32:33], v[32:33], s[88:89] op_sel_hi:[1,0]
    v_pk_mul_f32 v[34:35], v[34:35], s[88:89] op_sel_hi:[1,0]
    v_pk_mul_f32 v[36:37], v[36:37], s[88:89] op_sel_hi:[1,0]
    v_pk_mul_f32 v[38:39], v[38:39], s[88:89] op_sel_hi:[1,0]
    v_pk_mul_f32 v[40:41], v[40:41], s[88:89] op_sel_hi:[1,0]
    v_pk_mul_f32 v[42:43], v[42:43], s[88:89] op_sel_hi:[1,0]
    v_pk_mul_f32 v[44:45], v[44:45], s[88:89] op_sel_hi:[1,0]
    v_pk_mul_f32 v[46:47], v[46:47], s[88:89] op_sel_hi:[1,0]
    v_pk_mul_f32 v[48:49], v[48:49], s[88:89] op_sel_hi:[1,0]
    v_pk_mul_f32 v[50:51], v[50:51], s[88:89] op_sel_hi:[1,0]
    v_pk_mul_f32 v[52:53], v[52:53], s[88:89] op_sel_hi:[1,0]
    v_pk_mul_f32 v[54:55], v[54:55], s[88:89] op_sel_hi:[1,0]
    v_pk_mul_f32 v[56:57], v[56:57], s[88:89] op_sel_hi:[1,0]
    v_pk_mul_f32 v[58:59], v[58:59], s[88:89] op_sel_hi:[1,0]
    v_pk_mul_f32 v[60:61], v[60:61], s[88:89] op_sel_hi:[1,0]
    v_pk_mul_f32 v[62:63], v[62:63], s[88:89] op_sel_hi:[1,0]
    v_pk_mul_f32 v[64:65], v[64:65], s[88:89] op_sel_hi:[1,0]
    v_pk_mul_f32 v[66:67], v[66:67], s[88:89] op_sel_hi:[1,0]
    v_pk_mul_f32 v[68:69], v[68:69], s[88:89] op_sel_hi:[1,0]
    v_pk_mul_f32 v[70:71], v[70:71], s[88:89] op_sel_hi:[1,0]
    v_pk_mul_f32 v[72:73], v[72:73], s[88:89] op_sel_hi:[1,0]
    v_pk_mul_f32 v[74:75], v[74:75], s[88:89] op_sel_hi:[1,0]
    v_pk_mul_f32 v[76:77], v[76:77], s[88:89] op_sel_hi:[1,0]
    v_pk_mul_f32 v[78:79], v[78:79], s[88:89] op_sel_hi:[1,0]
    v_pk_mul_f32 v[80:81], v[80:81], s[88:89] op_sel_hi:[1,0]
    v_pk_mul_f32 v[82:83], v[82:83], s[88:89] op_sel_hi:[1,0]
    v_pk_mul_f32 v[84:85], v[84:85], s[88:89] op_sel_hi:[1,0]
    v_pk_mul_f32 v[86:87], v[86:87], s[88:89] op_sel_hi:[1,0]
    v_pk_mul_f32 v[88:89], v[88:89], s[88:89] op_sel_hi:[1,0]
    v_pk_mul_f32 v[90:91], v[90:91], s[88:89] op_sel_hi:[1,0]
    v_pk_mul_f32 v[92:93], v[92:93], s[88:89] op_sel_hi:[1,0]
    v_pk_mul_f32 v[94:95], v[94:95], s[88:89] op_sel_hi:[1,0]
    v_pk_mul_f32 v[96:97], v[96:97], s[88:89] op_sel_hi:[1,0]
    v_pk_mul_f32 v[98:99], v[98:99], s[88:89] op_sel_hi:[1,0]
    v_pk_mul_f32 v[100:101], v[100:101], s[88:89] op_sel_hi:[1,0]
    v_pk_mul_f32 v[102:103], v[102:103], s[88:89] op_sel_hi:[1,0]
    v_cvt_pk_bf16_f32 v104, v8, v9
    v_cvt_pk_bf16_f32 v105, v10, v11
    v_cvt_pk_bf16_f32 v106, v20, v21
    v_cvt_pk_bf16_f32 v107, v22, v23
    v_cvt_pk_bf16_f32 v108, v12, v13
    v_cvt_pk_bf16_f32 v109, v14, v15
    v_cvt_pk_bf16_f32 v110, v24, v25
    v_cvt_pk_bf16_f32 v111, v26, v27
    v_cvt_pk_bf16_f32 v112, v16, v17
    v_cvt_pk_bf16_f32 v113, v18, v19
    v_cvt_pk_bf16_f32 v114, v28, v29
    v_cvt_pk_bf16_f32 v115, v30, v31
    v_cvt_pk_bf16_f32 v116, v32, v33
    v_cvt_pk_bf16_f32 v117, v34, v35
    v_cvt_pk_bf16_f32 v118, v44, v45
    v_cvt_pk_bf16_f32 v119, v46, v47
    v_cvt_pk_bf16_f32 v120, v36, v37
    v_cvt_pk_bf16_f32 v121, v38, v39
    v_cvt_pk_bf16_f32 v122, v48, v49
    v_cvt_pk_bf16_f32 v123, v50, v51
    v_cvt_pk_bf16_f32 v124, v40, v41
    v_cvt_pk_bf16_f32 v125, v42, v43
    v_cvt_pk_bf16_f32 v126, v52, v53
    v_cvt_pk_bf16_f32 v127, v54, v55
    v_cvt_pk_bf16_f32 v128, v56, v57
    v_cvt_pk_bf16_f32 v129, v58, v59
    v_cvt_pk_bf16_f32 v130, v68, v69
    v_cvt_pk_bf16_f32 v131, v70, v71
    v_cvt_pk_bf16_f32 v132, v60, v61
    v_cvt_pk_bf16_f32 v133, v62, v63
    v_cvt_pk_bf16_f32 v134, v72, v73
    v_cvt_pk_bf16_f32 v135, v74, v75
    v_cvt_pk_bf16_f32 v136, v64, v65
    v_cvt_pk_bf16_f32 v137, v66, v67
    v_cvt_pk_bf16_f32 v138, v76, v77
    v_cvt_pk_bf16_f32 v139, v78, v79
    v_cvt_pk_bf16_f32 v140, v80, v81
    v_cvt_pk_bf16_f32 v141, v82, v83
    v_cvt_pk_bf16_f32 v142, v92, v93
    v_cvt_pk_bf16_f32 v143, v94, v95
    v_cvt_pk_bf16_f32 v144, v84, v85
    v_cvt_pk_bf16_f32 v145, v86, v87
    v_cvt_pk_bf16_f32 v146, v96, v97
    v_cvt_pk_bf16_f32 v147, v98, v99
    v_cvt_pk_bf16_f32 v148, v88, v89
    v_cvt_pk_bf16_f32 v149, v90, v91
    v_cvt_pk_bf16_f32 v150, v100, v101
    v_cvt_pk_bf16_f32 v151, v102, v103
    v_permlane32_swap_b32 v104, v106
    v_permlane32_swap_b32 v105, v107
    v_permlane32_swap_b32 v108, v110
    v_permlane32_swap_b32 v109, v111
    v_permlane32_swap_b32 v112, v114
    v_permlane32_swap_b32 v113, v115
    v_permlane32_swap_b32 v116, v118
    v_permlane32_swap_b32 v117, v119
    v_permlane32_swap_b32 v120, v122
    v_permlane32_swap_b32 v121, v123
    v_permlane32_swap_b32 v124, v126
    v_permlane32_swap_b32 v125, v127
    v_permlane32_swap_b32 v128, v130
    v_permlane32_swap_b32 v129, v131
    v_permlane32_swap_b32 v132, v134
    v_permlane32_swap_b32 v133, v135
    v_permlane32_swap_b32 v136, v138
    v_permlane32_swap_b32 v137, v139
    v_permlane32_swap_b32 v140, v142
    v_permlane32_swap_b32 v141, v143
    v_permlane32_swap_b32 v144, v146
    v_permlane32_swap_b32 v145, v147
    v_permlane32_swap_b32 v148, v150
    v_permlane32_swap_b32 v149, v151
    v_permlane16_swap_b32 v104, v106
    v_permlane16_swap_b32 v105, v107
    v_permlane16_swap_b32 v108, v110
    v_permlane16_swap_b32 v109, v111
    v_permlane16_swap_b32 v112, v114
    v_permlane16_swap_b32 v113, v115
    v_permlane16_swap_b32 v116, v118
    v_permlane16_swap_b32 v117, v119
    v_permlane16_swap_b32 v120, v122
    v_permlane16_swap_b32 v121, v123
    v_permlane16_swap_b32 v124, v126
    v_permlane16_swap_b32 v125, v127
    v_permlane16_swap_b32 v128, v130
    v_permlane16_swap_b32 v129, v131
    v_permlane16_swap_b32 v132, v134
    v_permlane16_swap_b32 v133, v135
    v_permlane16_swap_b32 v136, v138
    v_permlane16_swap_b32 v137, v139
    v_permlane16_swap_b32 v140, v142
    v_permlane16_swap_b32 v141, v143
    v_permlane16_swap_b32 v144, v146
    v_permlane16_swap_b32 v145, v147
    v_permlane16_swap_b32 v148, v150
    v_permlane16_swap_b32 v149, v151
    s_barrier
    v_mov_b32 v8, 0
    v_mov_b32 v9, 0
    v_mov_b32 v10, 0
    v_mov_b32 v11, 0
    v_mov_b32 v12, 0
    v_mov_b32 v13, 0
    v_mov_b32 v14, 0
    v_mov_b32 v15, 0
    v_mov_b32 v16, 0
    v_mov_b32 v17, 0
    v_mov_b32 v18, 0
    v_mov_b32 v19, 0
    v_mov_b32 v20, 0
    v_mov_b32 v21, 0
    v_mov_b32 v22, 0
    v_mov_b32 v23, 0
    v_mov_b32 v24, 0
    v_mov_b32 v25, 0
    v_mov_b32 v26, 0
    v_mov_b32 v27, 0
    v_mov_b32 v28, 0
    v_mov_b32 v29, 0
    v_mov_b32 v30, 0
    v_mov_b32 v31, 0
    v_mov_b32 v32, 0
    v_mov_b32 v33, 0
    v_mov_b32 v34, 0
    v_mov_b32 v35, 0
    v_mov_b32 v36, 0
    v_mov_b32 v37, 0
    v_mov_b32 v38, 0
    v_mov_b32 v39, 0
    v_mov_b32 v40, 0
    v_mov_b32 v41, 0
    v_mov_b32 v42, 0
    v_mov_b32 v43, 0
    v_mov_b32 v44, 0
    v_mov_b32 v45, 0
    v_mov_b32 v46, 0
    v_mov_b32 v47, 0
    v_mov_b32 v48, 0
    v_mov_b32 v49, 0
    v_mov_b32 v50, 0
    v_mov_b32 v51, 0
    v_mov_b32 v52, 0
    v_mov_b32 v53, 0
    v_mov_b32 v54, 0
    v_mov_b32 v55, 0
    v_mov_b32 v56, 0
    v_mov_b32 v57, 0
    v_mov_b32 v58, 0
    v_mov_b32 v59, 0
    v_mov_b32 v60, 0
    v_mov_b32 v61, 0
    v_mov_b32 v62, 0
    v_mov_b32 v63, 0
    v_mov_b32 v64, 0
    v_mov_b32 v65, 0
    v_mov_b32 v66, 0
    v_mov_b32 v67, 0
    v_mov_b32 v68, 0
    v_mov_b32 v69, 0
    v_mov_b32 v70, 0
    v_mov_b32 v71, 0
    v_mov_b32 v72, 0
    v_mov_b32 v73, 0
    v_mov_b32 v74, 0
    v_mov_b32 v75, 0
    v_mov_b32 v76, 0
    v_mov_b32 v77, 0
    v_mov_b32 v78, 0
    v_mov_b32 v79, 0
    v_mov_b32 v80, 0
    v_mov_b32 v81, 0
    v_mov_b32 v82, 0
    v_mov_b32 v83, 0
    v_mov_b32 v84, 0
    v_mov_b32 v85, 0
    v_mov_b32 v86, 0
    v_mov_b32 v87, 0
    v_mov_b32 v88, 0
    v_mov_b32 v89, 0
    v_mov_b32 v90, 0
    v_mov_b32 v91, 0
    v_mov_b32 v92, 0
    v_mov_b32 v93, 0
    v_mov_b32 v94, 0
    v_mov_b32 v95, 0
    v_mov_b32 v96, 0
    v_mov_b32 v97, 0
    v_mov_b32 v98, 0
    v_mov_b32 v99, 0
    v_mov_b32 v100, 0
    v_mov_b32 v101, 0
    v_mov_b32 v102, 0
    v_mov_b32 v103, 0
    v_mov_b32 v220, 0
    v_mov_b32 v221, 0
    v_mov_b32 v222, 0
    v_mov_b32 v223, 0
    v_mov_b32 v224, 0
    v_mov_b32 v225, 0
    v_mov_b32 v226, 0
    v_mov_b32 v227, 0
    v_mov_b32 v228, 0
    v_mov_b32 v229, 0
    v_mov_b32 v230, 0
    v_mov_b32 v231, 0
    v_mov_b32 v232, 0
    v_mov_b32 v233, 0
    v_mov_b32 v234, 0
    v_mov_b32 v235, 0
    v_mov_b32 v236, 0
    v_mov_b32 v237, 0
    v_mov_b32 v238, 0
    v_mov_b32 v239, 0
    v_mov_b32 v240, 0
    v_mov_b32 v241, 0
    v_mov_b32 v242, 0
    v_mov_b32 v243, 0
    v_mov_b32 v244, 0x3f803f80
    v_mov_b32 v245, 0x3f803f80
    v_mov_b32 v246, 0x3f803f80
    v_mov_b32 v247, 0x3f803f80
    s_mov_b32 s77, 0xff61b1e6
    s_mov_b32 s1, 0
    s_mov_b32 s7, 0x40004000
    s_cmp_eq_u32 s6, 2
    s_cbranch_scc0 L_c_15
    s_mov_b32 s32, s58
    s_mov_b32 s33, s59
    s_mov_b32 s34, 256
    s_mov_b32 s35, 0x20000
    s_lshl_b32 s66, s4, 3
    v_mov_b32 v250, 0
    s_mov_b32 s67, 200000
L_st_16:
    s_sub_u32 s67, s67, 1
    s_cbranch_scc1 L_se_17
    buffer_load_dword v251, v250, s[32:35], s66 offen sc1
    s_waitcnt vmcnt(0)
    v_readfirstlane_b32 s65, v251
    s_and_b32 s65, s65, 7
    s_cbranch_scc0 L_se_17
    s_sleep 8
    s_branch L_st_16
L_se_17:
L_c_15:
    s_lshl_b32 s65, s2, 2
    s_add_u32 s65, s65, s6
    s_lshl_b32 s62, s65, 17
    s_and_b32 s63, s65, 15
    s_sub_u32 s65, s76, 16896
    v_add_u32 v2, s65, v2
    v_add_u32 v3, s65, v3
    s_and_b32 s86, s4, 7
    s_lshl_b32 s73, s6, 1
    s_sub_u32 s73, s73, 3
    s_lshl_b32 s70, s5, 19
    s_lshl_b32 s66, s73, 8
    s_add_u32 s70, s70, s66
    s_add_u32 s70, s70, 262144
    s_mul_i32 s75, s6, 8448
    s_add_u32 s75, s75, 28672
    s_barrier
    s_waitcnt vmcnt(0)
    s_barrier
    s_mov_b32 s32, s54
    s_mov_b32 s33, s55
    s_mov_b32 s34, 0x400000
    s_mov_b32 s35, 0x20000
    s_lshl_b32 s65, s4, 1
    s_and_b32 s66, s6, 1
    s_add_u32 s65, s65, s66
    s_lshl_b32 s65, s65, 13
    s_lshl_b32 s66, s5, 19
    s_add_u32 s65, s65, s66
    v_lshlrev_b32 v248, 7, v0
    buffer_load_dword v249, v248, s[32:35], s65 offen
    s_waitcnt vmcnt(1)
    s_barrier
    s_mov_b32 s32, s44
    s_mov_b32 s33, s45
    s_mov_b32 s34, 0x400000
    s_mov_b32 s35, 0x20000
    s_lshl_b32 s65, s4, 1
    s_and_b32 s66, s6, 1
    s_add_u32 s65, s65, s66
    s_lshl_b32 s65, s65, 13
    s_lshl_b32 s66, s5, 19
    s_add_u32 s65, s65, s66
    v_lshlrev_b32 v248, 7, v0
    buffer_load_dword v249, v248, s[32:35], s65 offen
    s_waitcnt vmcnt(1)
    s_barrier
    s_waitcnt vmcnt(0)
    s_barrier
    s_waitcnt vmcnt(0)
    s_barrier
    s_add_u32 s64, s63, 0
    s_and_b32 s64, s64, 15
    s_lshl_b32 s64, s64, 13
    s_add_u32 s64, s64, s62
    s_add_u32 m0, s76, 0
    s_nop 0
    buffer_load_dwordx4 v4, s[12:15], s64 offen offset:0 nt lds
    s_add_u32 m0, s76, 800
    s_nop 0
    buffer_load_dwordx4 v4, s[12:15], s64 offen offset:256 nt lds
    s_add_u32 m0, s76, 1600
    s_nop 0
    buffer_load_dwordx4 v4, s[12:15], s64 offen offset:512 nt lds
    s_add_u32 m0, s76, 2400
    s_nop 0
    buffer_load_dwordx4 v4, s[12:15], s64 offen offset:768 nt lds
    s_add_u32 m0, s76, 3200
    s_nop 0
    buffer_load_dwordx4 v5, s[12:15], s64 offen offset:1024 nt lds
    s_add_u32 m0, s76, 4000
    s_nop 0
    buffer_load_dwordx4 v5, s[12:15], s64 offen offset:1280 nt lds
    s_add_u32 m0, s76, 4800
    s_nop 0
    buffer_load_dwordx4 v5, s[12:15], s64 offen offset:1536 nt lds
    s_add_u32 m0, s76, 5600
    s_nop 0
    buffer_load_dwordx4 v5, s[12:15], s64 offen offset:1792 nt lds
    s_add_u32 m0, s76, 8448
    s_nop 0
    buffer_load_dwordx4 v6, s[16:19], s64 offen offset:0 nt lds
    s_add_u32 m0, s76, 9248
    s_nop 0
    buffer_load_dwordx4 v6, s[16:19], s64 offen offset:256 nt lds
    s_add_u32 m0, s76, 10048
    s_nop 0
    buffer_load_dwordx4 v6, s[16:19], s64 offen offset:512 nt lds
    s_add_u32 m0, s76, 10848
    s_nop 0
    buffer_load_dwordx4 v6, s[16:19], s64 offen offset:768 nt lds
    s_add_u32 m0, s76, 11648
    s_nop 0
    buffer_load_dwordx4 v6, s[16:19], s64 offen offset:1024 nt lds
    s_add_u32 m0, s76, 12448
    s_nop 0
    buffer_load_dwordx4 v6, s[16:19], s64 offen offset:1280 nt lds
    s_add_u32 m0, s76, 13248
    s_nop 0
    buffer_load_dwordx4 v6, s[16:19], s64 offen offset:1536 nt lds
    s_add_u32 m0, s76, 14048
    s_nop 0
    buffer_load_dwordx4 v6, s[16:19], s64 offen offset:1792 nt lds
    s_waitcnt vmcnt(16)
    s_barrier
    s_add_u32 s64, s63, 1
    s_and_b32 s64, s64, 15
    s_lshl_b32 s64, s64, 13
    s_add_u32 s64, s64, s62
    s_add_u32 m0, s76, 33792
    s_nop 0
    buffer_load_dwordx4 v4, s[12:15], s64 offen offset:0 nt lds
    s_add_u32 m0, s76, 34592
    s_nop 0
    buffer_load_dwordx4 v4, s[12:15], s64 offen offset:256 nt lds
    s_add_u32 m0, s76, 35392
    s_nop 0
    buffer_load_dwordx4 v4, s[12:15], s64 offen offset:512 nt lds
    s_add_u32 m0, s76, 36192
    s_nop 0
    buffer_load_dwordx4 v4, s[12:15], s64 offen offset:768 nt lds
    s_add_u32 m0, s76, 36992
    s_nop 0
    buffer_load_dwordx4 v5, s[12:15], s64 offen offset:1024 nt lds
    s_add_u32 m0, s76, 37792
    s_nop 0
    buffer_load_dwordx4 v5, s[12:15], s64 offen offset:1280 nt lds
    s_add_u32 m0, s76, 38592
    s_nop 0
    buffer_load_dwordx4 v5, s[12:15], s64 offen offset:1536 nt lds
    s_add_u32 m0, s76, 39392
    s_nop 0
    buffer_load_dwordx4 v5, s[12:15], s64 offen offset:1792 nt lds
    s_add_u32 m0, s76, 42240
    s_nop 0
    buffer_load_dwordx4 v6, s[16:19], s64 offen offset:0 nt lds
    s_add_u32 m0, s76, 43040
    s_nop 0
    buffer_load_dwordx4 v6, s[16:19], s64 offen offset:256 nt lds
    s_add_u32 m0, s76, 43840
    s_nop 0
    buffer_load_dwordx4 v6, s[16:19], s64 offen offset:512 nt lds
    s_add_u32 m0, s76, 44640
    s_nop 0
    buffer_load_dwordx4 v6, s[16:19], s64 offen offset:768 nt lds
    s_add_u32 m0, s76, 45440
    s_nop 0
    buffer_load_dwordx4 v6, s[16:19], s64 offen offset:1024 nt lds
    s_add_u32 m0, s76, 46240
    s_nop 0
    buffer_load_dwordx4 v6, s[16:19], s64 offen offset:1280 nt lds
    s_add_u32 m0, s76, 47040
    s_nop 0
    buffer_load_dwordx4 v6, s[16:19], s64 offen offset:1536 nt lds
    s_add_u32 m0, s76, 47840
    s_nop 0
    buffer_load_dwordx4 v6, s[16:19], s64 offen offset:1792 nt lds
    s_waitcnt vmcnt(16)
    s_barrier
    s_call_b64 s[80:81], L_tile
    v_add_u32 v2, 33792, v2
    v_add_u32 v3, 33792, v3
    s_barrier
    s_add_u32 s64, s63, 2
    s_and_b32 s64, s64, 15
    s_lshl_b32 s64, s64, 13
    s_add_u32 s64, s64, s62
    s_add_u32 m0, s76, 67584
    s_nop 0
    buffer_load_dwordx4 v4, s[12:15], s64 offen offset:0 nt lds
    s_add_u32 m0, s76, 68384
    s_nop 0
    buffer_load_dwordx4 v4, s[12:15], s64 offen offset:256 nt lds
    s_add_u32 m0, s76, 69184
    s_nop 0
    buffer_load_dwordx4 v4, s[12:15], s64 offen offset:512 nt lds
    s_add_u32 m0, s76, 69984
    s_nop 0
    buffer_load_dwordx4 v4, s[12:15], s64 offen offset:768 nt lds
    s_add_u32 m0, s76, 70784
    s_nop 0
    buffer_load_dwordx4 v5, s[12:15], s64 offen offset:1024 nt lds
    s_add_u32 m0, s76, 71584
    s_nop 0
    buffer_load_dwordx4 v5, s[12:15], s64 offen offset:1280 nt lds
    s_add_u32 m0, s76, 72384
    s_nop 0
    buffer_load_dwordx4 v5, s[12:15], s64 offen offset:1536 nt lds
    s_add_u32 m0, s76, 73184
    s_nop 0
    buffer_load_dwordx4 v5, s[12:15], s64 offen offset:1792 nt lds
    s_add_u32 m0, s76, 76032
    s_nop 0
    buffer_load_dwordx4 v6, s[16:19], s64 offen offset:0 nt lds
    s_add_u32 m0, s76, 76832
    s_nop 0
    buffer_load_dwordx4 v6, s[16:19], s64 offen offset:256 nt lds
    s_add_u32 m0, s76, 77632
    s_nop 0
    buffer_load_dwordx4 v6, s[16:19], s64 offen offset:512 nt lds
    s_add_u32 m0, s76, 78432
    s_nop 0
    buffer_load_dwordx4 v6, s[16:19], s64 offen offset:768 nt lds
    s_add_u32 m0, s76, 79232
    s_nop 0
    buffer_load_dwordx4 v6, s[16:19], s64 offen offset:1024 nt lds
    s_add_u32 m0, s76, 80032
    s_nop 0
    buffer_load_dwordx4 v6, s[16:19], s64 offen offset:1280 nt lds
    s_waitcnt vmcnt(14)
    s_barrier
    s_call_b64 s[80:81], L_tile
    v_add_u32 v2, 33792, v2
    v_add_u32 v3, 33792, v3
    s_barrier
    s_add_u32 s64, s63, 2
    s_and_b32 s64, s64, 15
    s_lshl_b32 s64, s64, 13
    s_add_u32 s64, s64, s62
    s_add_u32 m0, s76, 80832
    s_nop 0
    buffer_load_dwordx4 v6, s[16:19], s64 offen offset:1536 nt lds
    s_add_u32 m0, s76, 81632
    s_nop 0
    buffer_load_dwordx4 v6, s[16:19], s64 offen offset:1792 nt lds
    s_add_u32 s64, s63, 3
    s_and_b32 s64, s64, 15
    s_lshl_b32 s64, s64, 13
    s_add_u32 s64, s64, s62
    s_add_u32 m0, s76, 0
    s_nop 0
    buffer_load_dwordx4 v4, s[12:15], s64 offen offset:0 nt lds
    s_add_u32 m0, s76, 800
    s_nop 0
    buffer_load_dwordx4 v4, s[12:15], s64 offen offset:256 nt lds
    s_add_u32 m0, s76, 1600
    s_nop 0
    buffer_load_dwordx4 v4, s[12:15], s64 offen offset:512 nt lds
    s_add_u32 m0, s76, 2400
    s_nop 0
    buffer_load_dwordx4 v4, s[12:15], s64 offen offset:768 nt lds
    s_add_u32 m0, s76, 3200
    s_nop 0
    buffer_load_dwordx4 v5, s[12:15], s64 offen offset:1024 nt lds
    s_add_u32 m0, s76, 4000
    s_nop 0
    buffer_load_dwordx4 v5, s[12:15], s64 offen offset:1280 nt lds
    s_add_u32 m0, s76, 4800
    s_nop 0
    buffer_load_dwordx4 v5, s[12:15], s64 offen offset:1536 nt lds
    s_add_u32 m0, s76, 5600
    s_nop 0
    buffer_load_dwordx4 v5, s[12:15], s64 offen offset:1792 nt lds
    s_add_u32 m0, s76, 8448
    s_nop 0
    buffer_load_dwordx4 v6, s[16:19], s64 offen offset:0 nt lds
    s_add_u32 m0, s76, 9248
    s_nop 0
    buffer_load_dwordx4 v6, s[16:19], s64 offen offset:256 nt lds
    s_add_u32 m0, s76, 10048
    s_nop 0
    buffer_load_dwordx4 v6, s[16:19], s64 offen offset:512 nt lds
    s_add_u32 m0, s76, 10848
    s_nop 0
    buffer_load_dwordx4 v6, s[16:19], s64 offen offset:768 nt lds
    s_waitcnt vmcnt(14)
    s_barrier
    s_barrier
    s_add_u32 s64, s63, 3
    s_and_b32 s64, s64, 15
    s_lshl_b32 s64, s64, 13
    s_add_u32 s64, s64, s62
    s_add_u32 m0, s76, 11648
    s_nop 0
    buffer_load_dwordx4 v6, s[16:19], s64 offen offset:1024 nt lds
    s_add_u32 m0, s76, 12448
    s_nop 0
    buffer_load_dwordx4 v6, s[16:19], s64 offen offset:1280 nt lds
    s_add_u32 m0, s76, 13248
    s_nop 0
    buffer_load_dwordx4 v6, s[16:19], s64 offen offset:1536 nt lds
    s_add_u32 m0, s76, 14048
    s_nop 0
    buffer_load_dwordx4 v6, s[16:19], s64 offen offset:1792 nt lds
    s_add_u32 s64, s63, 4
    s_and_b32 s64, s64, 15
    s_lshl_b32 s64, s64, 13
    s_add_u32 s64, s64, s62
    s_add_u32 m0, s76, 33792
    s_nop 0
    buffer_load_dwordx4 v4, s[12:15], s64 offen offset:0 nt lds
    s_add_u32 m0, s76, 34592
    s_nop 0
    buffer_load_dwordx4 v4, s[12:15], s64 offen offset:256 nt lds
    s_add_u32 m0, s76, 35392
    s_nop 0
    buffer_load_dwordx4 v4, s[12:15], s64 offen offset:512 nt lds
    s_add_u32 m0, s76, 36192
    s_nop 0
    buffer_load_dwordx4 v4, s[12:15], s64 offen offset:768 nt lds
    s_add_u32 m0, s76, 36992
    s_nop 0
    buffer_load_dwordx4 v5, s[12:15], s64 offen offset:1024 nt lds
    s_add_u32 m0, s76, 37792
    s_nop 0
    buffer_load_dwordx4 v5, s[12:15], s64 offen offset:1280 nt lds
    s_add_u32 m0, s76, 38592
    s_nop 0
    buffer_load_dwordx4 v5, s[12:15], s64 offen offset:1536 nt lds
    s_add_u32 m0, s76, 39392
    s_nop 0
    buffer_load_dwordx4 v5, s[12:15], s64 offen offset:1792 nt lds
    s_add_u32 m0, s76, 42240
    s_nop 0
    buffer_load_dwordx4 v6, s[16:19], s64 offen offset:0 nt lds
    s_add_u32 m0, s76, 43040
    s_nop 0
    buffer_load_dwordx4 v6, s[16:19], s64 offen offset:256 nt lds
    s_waitcnt vmcnt(14)
    s_barrier
    s_call_b64 s[80:81], L_tile
    v_add_u32 v2, -67584, v2
    v_add_u32 v3, -67584, v3
    s_barrier
    s_add_u32 s64, s63, 4
    s_and_b32 s64, s64, 15
    s_lshl_b32 s64, s64, 13
    s_add_u32 s64, s64, s62
    s_add_u32 m0, s76, 43840
    s_nop 0
    buffer_load_dwordx4 v6, s[16:19], s64 offen offset:512 nt lds
    s_add_u32 m0, s76, 44640
    s_nop 0
    buffer_load_dwordx4 v6, s[16:19], s64 offen offset:768 nt lds
    s_add_u32 m0, s76, 45440
    s_nop 0
    buffer_load_dwordx4 v6, s[16:19], s64 offen offset:1024 nt lds
    s_add_u32 m0, s76, 46240
    s_nop 0
    buffer_load_dwordx4 v6, s[16:19], s64 offen offset:1280 nt lds
    s_add_u32 m0, s76, 47040
    s_nop 0
    buffer_load_dwordx4 v6, s[16:19], s64 offen offset:1536 nt lds
    s_add_u32 m0, s76, 47840
    s_nop 0
    buffer_load_dwordx4 v6, s[16:19], s64 offen offset:1792 nt lds
    s_add_u32 s64, s63, 5
    s_and_b32 s64, s64, 15
    s_lshl_b32 s64, s64, 13
    s_add_u32 s64, s64, s62
    s_add_u32 m0, s76, 67584
    s_nop 0
    buffer_load_dwordx4 v4, s[12:15], s64 offen offset:0 nt lds
    s_add_u32 m0, s76, 68384
    s_nop 0
    buffer_load_dwordx4 v4, s[12:15], s64 offen offset:256 nt lds
    s_add_u32 m0, s76, 69184
    s_nop 0
    buffer_load_dwordx4 v4, s[12:15], s64 offen offset:512 nt lds
    s_add_u32 m0, s76, 69984
    s_nop 0
    buffer_load_dwordx4 v4, s[12:15], s64 offen offset:768 nt lds
    s_add_u32 m0, s76, 70784
    s_nop 0
    buffer_load_dwordx4 v5, s[12:15], s64 offen offset:1024 nt lds
    s_add_u32 m0, s76, 71584
    s_nop 0
    buffer_load_dwordx4 v5, s[12:15], s64 offen offset:1280 nt lds
    s_add_u32 m0, s76, 72384
    s_nop 0
    buffer_load_dwordx4 v5, s[12:15], s64 offen offset:1536 nt lds
    s_add_u32 m0, s76, 73184
    s_nop 0
    buffer_load_dwordx4 v5, s[12:15], s64 offen offset:1792 nt lds
    s_waitcnt vmcnt(14)
    s_barrier
    s_call_b64 s[80:81], L_tile
    v_add_u32 v2, 33792, v2
    v_add_u32 v3, 33792, v3
    s_barrier
    s_add_u32 s64, s63, 5
    s_and_b32 s64, s64, 15
    s_lshl_b32 s64, s64, 13
    s_add_u32 s64, s64, s62
    s_add_u32 m0, s76, 76032
    s_nop 0
    buffer_load_dwordx4 v6, s[16:19], s64 offen offset:0 nt lds
    s_add_u32 m0, s76, 76832
    s_nop 0
    buffer_load_dwordx4 v6, s[16:19], s64 offen offset:256 nt lds
    s_add_u32 m0, s76, 77632
    s_nop 0
    buffer_load_dwordx4 v6, s[16:19], s64 offen offset:512 nt lds
    s_add_u32 m0, s76, 78432
    s_nop 0
    buffer_load_dwordx4 v6, s[16:19], s64 offen offset:768 nt lds
    s_add_u32 m0, s76, 79232
    s_nop 0
    buffer_load_dwordx4 v6, s[16:19], s64 offen offset:1024 nt lds
    s_add_u32 m0, s76, 80032
    s_nop 0
    buffer_load_dwordx4 v6, s[16:19], s64 offen offset:1280 nt lds
    s_add_u32 m0, s76, 80832
    s_nop 0
    buffer_load_dwordx4 v6, s[16:19], s64 offen offset:1536 nt lds
    s_add_u32 m0, s76, 81632
    s_nop 0
    buffer_load_dwordx4 v6, s[16:19], s64 offen offset:1792 nt lds
    s_add_u32 s64, s63, 6
    s_and_b32 s64, s64, 15
    s_lshl_b32 s64, s64, 13
    s_add_u32 s64, s64, s62
    s_add_u32 m0, s76, 0
    s_nop 0
    buffer_load_dwordx4 v4, s[12:15], s64 offen offset:0 nt lds
    s_add_u32 m0, s76, 800
    s_nop 0
    buffer_load_dwordx4 v4, s[12:15], s64 offen offset:256 nt lds
    s_add_u32 m0, s76, 1600
    s_nop 0
    buffer_load_dwordx4 v4, s[12:15], s64 offen offset:512 nt lds
    s_add_u32 m0, s76, 2400
    s_nop 0
    buffer_load_dwordx4 v4, s[12:15], s64 offen offset:768 nt lds
    s_add_u32 m0, s76, 3200
    s_nop 0
    buffer_load_dwordx4 v5, s[12:15], s64 offen offset:1024 nt lds
    s_add_u32 m0, s76, 4000
    s_nop 0
    buffer_load_dwordx4 v5, s[12:15], s64 offen offset:1280 nt lds
    s_waitcnt vmcnt(14)
    s_barrier
    s_call_b64 s[80:81], L_tile
    v_add_u32 v2, 33792, v2
    v_add_u32 v3, 33792, v3
    s_barrier
    s_add_u32 s64, s63, 6
    s_and_b32 s64, s64, 15
    s_lshl_b32 s64, s64, 13
    s_add_u32 s64, s64, s62
    s_add_u32 m0, s76, 4800
    s_nop 0
    buffer_load_dwordx4 v5, s[12:15], s64 offen offset:1536 nt lds
    s_add_u32 m0, s76, 5600
    s_nop 0
    buffer_load_dwordx4 v5, s[12:15], s64 offen offset:1792 nt lds
    s_add_u32 m0, s76, 8448
    s_nop 0
    buffer_load_dwordx4 v6, s[16:19], s64 offen offset:0 nt lds
    s_add_u32 m0, s76, 9248
    s_nop 0
    buffer_load_dwordx4 v6, s[16:19], s64 offen offset:256 nt lds
    s_add_u32 m0, s76, 10048
    s_nop 0
    buffer_load_dwordx4 v6, s[16:19], s64 offen offset:512 nt lds
    s_add_u32 m0, s76, 10848
    s_nop 0
    buffer_load_dwordx4 v6, s[16:19], s64 offen offset:768 nt lds
    s_add_u32 m0, s76, 11648
    s_nop 0
    buffer_load_dwordx4 v6, s[16:19], s64 offen offset:1024 nt lds
    s_add_u32 m0, s76, 12448
    s_nop 0
    buffer_load_dwordx4 v6, s[16:19], s64 offen offset:1280 nt lds
    s_add_u32 m0, s76, 13248
    s_nop 0
    buffer_load_dwordx4 v6, s[16:19], s64 offen offset:1536 nt lds
    s_add_u32 m0, s76, 14048
    s_nop 0
    buffer_load_dwordx4 v6, s[16:19], s64 offen offset:1792 nt lds
    s_add_u32 s64, s63, 7
    s_and_b32 s64, s64, 15
    s_lshl_b32 s64, s64, 13
    s_add_u32 s64, s64, s62
    s_add_u32 m0, s76, 33792
    s_nop 0
    buffer_load_dwordx4 v4, s[12:15], s64 offen offset:0 nt lds
    s_add_u32 m0, s76, 34592
    s_nop 0
    buffer_load_dwordx4 v4, s[12:15], s64 offen offset:256 nt lds
    s_add_u32 m0, s76, 35392
    s_nop 0
    buffer_load_dwordx4 v4, s[12:15], s64 offen offset:512 nt lds
    s_add_u32 m0, s76, 36192
    s_nop 0
    buffer_load_dwordx4 v4, s[12:15], s64 offen offset:768 nt lds
    s_waitcnt vmcnt(14)
    s_barrier
    s_call_b64 s[80:81], L_tile
    v_add_u32 v2, -67584, v2
    v_add_u32 v3, -67584, v3
    s_barrier
    s_add_u32 s64, s63, 7
    s_and_b32 s64, s64, 15
    s_lshl_b32 s64, s64, 13
    s_add_u32 s64, s64, s62
    s_add_u32 m0, s76, 36992
    s_nop 0
    buffer_load_dwordx4 v5, s[12:15], s64 offen offset:1024 nt lds
    s_add_u32 m0, s76, 37792
    s_nop 0
    buffer_load_dwordx4 v5, s[12:15], s64 offen offset:1280 nt lds
    s_add_u32 m0, s76, 38592
    s_nop 0
    buffer_load_dwordx4 v5, s[12:15], s64 offen offset:1536 nt lds
    s_add_u32 m0, s76, 39392
    s_nop 0
    buffer_load_dwordx4 v5, s[12:15], s64 offen offset:1792 nt lds
    s_add_u32 m0, s76, 42240
    s_nop 0
    buffer_load_dwordx4 v6, s[16:19], s64 offen offset:0 nt lds
    s_add_u32 m0, s76, 43040
    s_nop 0
    buffer_load_dwordx4 v6, s[16:19], s64 offen offset:256 nt lds
    s_add_u32 m0, s76, 43840
    s_nop 0
    buffer_load_dwordx4 v6, s[16:19], s64 offen offset:512 nt lds
    s_add_u32 m0, s76, 44640
    s_nop 0
    buffer_load_dwordx4 v6, s[16:19], s64 offen offset:768 nt lds
    s_add_u32 m0, s76, 45440
    s_nop 0
    buffer_load_dwordx4 v6, s[16:19], s64 offen offset:1024 nt lds
    s_add_u32 m0, s76, 46240
    s_nop 0
    buffer_load_dwordx4 v6, s[16:19], s64 offen offset:1280 nt lds
    s_add_u32 m0, s76, 47040
    s_nop 0
    buffer_load_dwordx4 v6, s[16:19], s64 offen offset:1536 nt lds
    s_add_u32 m0, s76, 47840
    s_nop 0
    buffer_load_dwordx4 v6, s[16:19], s64 offen offset:1792 nt lds
    s_add_u32 s64, s63, 8
    s_and_b32 s64, s64, 15
    s_lshl_b32 s64, s64, 13
    s_add_u32 s64, s64, s62
    s_add_u32 m0, s76, 67584
    s_nop 0
    buffer_load_dwordx4 v4, s[12:15], s64 offen offset:0 nt lds
    s_add_u32 m0, s76, 68384
    s_nop 0
    buffer_load_dwordx4 v4, s[12:15], s64 offen offset:256 nt lds
    s_waitcnt vmcnt(14)
    s_barrier
    s_call_b64 s[80:81], L_tile
    v_add_u32 v2, 33792, v2
    v_add_u32 v3, 33792, v3
    s_barrier
    s_add_u32 s64, s63, 8
    s_and_b32 s64, s64, 15
    s_lshl_b32 s64, s64, 13
    s_add_u32 s64, s64, s62
    s_add_u32 m0, s76, 69184
    s_nop 0
    buffer_load_dwordx4 v4, s[12:15], s64 offen offset:512 nt lds
    s_add_u32 m0, s76, 69984
    s_nop 0
    buffer_load_dwordx4 v4, s[12:15], s64 offen offset:768 nt lds
    s_add_u32 m0, s76, 70784
    s_nop 0
    buffer_load_dwordx4 v5, s[12:15], s64 offen offset:1024 nt lds
    s_add_u32 m0, s76, 71584
    s_nop 0
    buffer_load_dwordx4 v5, s[12:15], s64 offen offset:1280 nt lds
    s_add_u32 m0, s76, 72384
    s_nop 0
    buffer_load_dwordx4 v5, s[12:15], s64 offen offset:1536 nt lds
    s_add_u32 m0, s76, 73184
    s_nop 0
    buffer_load_dwordx4 v5, s[12:15], s64 offen offset:1792 nt lds
    s_add_u32 m0, s76, 76032
    s_nop 0
    buffer_load_dwordx4 v6, s[16:19], s64 offen offset:0 nt lds
    s_add_u32 m0, s76, 76832
    s_nop 0
    buffer_load_dwordx4 v6, s[16:19], s64 offen offset:256 nt lds
    s_add_u32 m0, s76, 77632
    s_nop 0
    buffer_load_dwordx4 v6, s[16:19], s64 offen offset:512 nt lds
    s_add_u32 m0, s76, 78432
    s_nop 0
    buffer_load_dwordx4 v6, s[16:19], s64 offen offset:768 nt lds
    s_add_u32 m0, s76, 79232
    s_nop 0
    buffer_load_dwordx4 v6, s[16:19], s64 offen offset:1024 nt lds
    s_add_u32 m0, s76, 80032
    s_nop 0
    buffer_load_dwordx4 v6, s[16:19], s64 offen offset:1280 nt lds
    s_add_u32 m0, s76, 80832
    s_nop 0
    buffer_load_dwordx4 v6, s[16:19], s64 offen offset:1536 nt lds
    s_add_u32 m0, s76, 81632
    s_nop 0
    buffer_load_dwordx4 v6, s[16:19], s64 offen offset:1792 nt lds
    s_waitcnt vmcnt(14)
    s_barrier
    s_call_b64 s[80:81], L_tile
    v_add_u32 v2, 33792, v2
    v_add_u32 v3, 33792, v3
    s_barrier
    s_add_u32 s64, s63, 9
    s_and_b32 s64, s64, 15
    s_lshl_b32 s64, s64, 13
    s_add_u32 s64, s64, s62
    s_add_u32 m0, s76, 0
    s_nop 0
    buffer_load_dwordx4 v4, s[12:15], s64 offen offset:0 nt lds
    s_add_u32 m0, s76, 800
    s_nop 0
    buffer_load_dwordx4 v4, s[12:15], s64 offen offset:256 nt lds
    s_add_u32 m0, s76, 1600
    s_nop 0
    buffer_load_dwordx4 v4, s[12:15], s64 offen offset:512 nt lds
    s_add_u32 m0, s76, 2400
    s_nop 0
    buffer_load_dwordx4 v4, s[12:15], s64 offen offset:768 nt lds
    s_add_u32 m0, s76, 3200
    s_nop 0
    buffer_load_dwordx4 v5, s[12:15], s64 offen offset:1024 nt lds
    s_add_u32 m0, s76, 4000
    s_nop 0
    buffer_load_dwordx4 v5, s[12:15], s64 offen offset:1280 nt lds
    s_add_u32 m0, s76, 4800
    s_nop 0
    buffer_load_dwordx4 v5, s[12:15], s64 offen offset:1536 nt lds
    s_add_u32 m0, s76, 5600
    s_nop 0
    buffer_load_dwordx4 v5, s[12:15], s64 offen offset:1792 nt lds
    s_add_u32 m0, s76, 8448
    s_nop 0
    buffer_load_dwordx4 v6, s[16:19], s64 offen offset:0 nt lds
    s_add_u32 m0, s76, 9248
    s_nop 0
    buffer_load_dwordx4 v6, s[16:19], s64 offen offset:256 nt lds
    s_add_u32 m0, s76, 10048
    s_nop 0
    buffer_load_dwordx4 v6, s[16:19], s64 offen offset:512 nt lds
    s_add_u32 m0, s76, 10848
    s_nop 0
    buffer_load_dwordx4 v6, s[16:19], s64 offen offset:768 nt lds
    s_add_u32 m0, s76, 11648
    s_nop 0
    buffer_load_dwordx4 v6, s[16:19], s64 offen offset:1024 nt lds
    s_add_u32 m0, s76, 12448
    s_nop 0
    buffer_load_dwordx4 v6, s[16:19], s64 offen offset:1280 nt lds
    s_waitcnt vmcnt(14)
    s_barrier
    s_call_b64 s[80:81], L_tile
    v_add_u32 v2, -67584, v2
    v_add_u32 v3, -67584, v3
    s_barrier
    s_add_u32 s64, s63, 9
    s_and_b32 s64, s64, 15
    s_lshl_b32 s64, s64, 13
    s_add_u32 s64, s64, s62
    s_add_u32 m0, s76, 13248
    s_nop 0
    buffer_load_dwordx4 v6, s[16:19], s64 offen offset:1536 nt lds
    s_add_u32 m0, s76, 14048
    s_nop 0
    buffer_load_dwordx4 v6, s[16:19], s64 offen offset:1792 nt lds
    s_add_u32 s64, s63, 10
    s_and_b32 s64, s64, 15
    s_lshl_b32 s64, s64, 13
    s_add_u32 s64, s64, s62
    s_add_u32 m0, s76, 33792
    s_nop 0
    buffer_load_dwordx4 v4, s[12:15], s64 offen offset:0 nt lds
    s_add_u32 m0, s76, 34592
    s_nop 0
    buffer_load_dwordx4 v4, s[12:15], s64 offen offset:256 nt lds
    s_add_u32 m0, s76, 35392
    s_nop 0
    buffer_load_dwordx4 v4, s[12:15], s64 offen offset:512 nt lds
    s_add_u32 m0, s76, 36192
    s_nop 0
    buffer_load_dwordx4 v4, s[12:15], s64 offen offset:768 nt lds
    s_add_u32 m0, s76, 36992
    s_nop 0
    buffer_load_dwordx4 v5, s[12:15], s64 offen offset:1024 nt lds
    s_add_u32 m0, s76, 37792
    s_nop 0
    buffer_load_dwordx4 v5, s[12:15], s64 offen offset:1280 nt lds
    s_add_u32 m0, s76, 38592
    s_nop 0
    buffer_load_dwordx4 v5, s[12:15], s64 offen offset:1536 nt lds
    s_add_u32 m0, s76, 39392
    s_nop 0
    buffer_load_dwordx4 v5, s[12:15], s64 offen offset:1792 nt lds
    s_add_u32 m0, s76, 42240
    s_nop 0
    buffer_load_dwordx4 v6, s[16:19], s64 offen offset:0 nt lds
    s_add_u32 m0, s76, 43040
    s_nop 0
    buffer_load_dwordx4 v6, s[16:19], s64 offen offset:256 nt lds
    s_add_u32 m0, s76, 43840
    s_nop 0
    buffer_load_dwordx4 v6, s[16:19], s64 offen offset:512 nt lds
    s_add_u32 m0, s76, 44640
    s_nop 0
    buffer_load_dwordx4 v6, s[16:19], s64 offen offset:768 nt lds
    s_waitcnt vmcnt(14)
    s_barrier
    s_barrier
    s_add_u32 s64, s63, 10
    s_and_b32 s64, s64, 15
    s_lshl_b32 s64, s64, 13
    s_add_u32 s64, s64, s62
    s_add_u32 m0, s76, 45440
    s_nop 0
    buffer_load_dwordx4 v6, s[16:19], s64 offen offset:1024 nt lds
    s_add_u32 m0, s76, 46240
    s_nop 0
    buffer_load_dwordx4 v6, s[16:19], s64 offen offset:1280 nt lds
    s_add_u32 m0, s76, 47040
    s_nop 0
    buffer_load_dwordx4 v6, s[16:19], s64 offen offset:1536 nt lds
    s_add_u32 m0, s76, 47840
    s_nop 0
    buffer_load_dwordx4 v6, s[16:19], s64 offen offset:1792 nt lds
    s_add_u32 s64, s63, 11
    s_and_b32 s64, s64, 15
    s_lshl_b32 s64, s64, 13
    s_add_u32 s64, s64, s62
    s_add_u32 m0, s76, 67584
    s_nop 0
    buffer_load_dwordx4 v4, s[12:15], s64 offen offset:0 nt lds
    s_add_u32 m0, s76, 68384
    s_nop 0
    buffer_load_dwordx4 v4, s[12:15], s64 offen offset:256 nt lds
    s_add_u32 m0, s76, 69184
    s_nop 0
    buffer_load_dwordx4 v4, s[12:15], s64 offen offset:512 nt lds
    s_add_u32 m0, s76, 69984
    s_nop 0
    buffer_load_dwordx4 v4, s[12:15], s64 offen offset:768 nt lds
    s_add_u32 m0, s76, 70784
    s_nop 0
    buffer_load_dwordx4 v5, s[12:15], s64 offen offset:1024 nt lds
    s_add_u32 m0, s76, 71584
    s_nop 0
    buffer_load_dwordx4 v5, s[12:15], s64 offen offset:1280 nt lds
    s_add_u32 m0, s76, 72384
    s_nop 0
    buffer_load_dwordx4 v5, s[12:15], s64 offen offset:1536 nt lds
    s_add_u32 m0, s76, 73184
    s_nop 0
    buffer_load_dwordx4 v5, s[12:15], s64 offen offset:1792 nt lds
    s_add_u32 m0, s76, 76032
    s_nop 0
    buffer_load_dwordx4 v6, s[16:19], s64 offen offset:0 nt lds
    s_add_u32 m0, s76, 76832
    s_nop 0
    buffer_load_dwordx4 v6, s[16:19], s64 offen offset:256 nt lds
    s_waitcnt vmcnt(14)
    s_barrier
    s_call_b64 s[80:81], L_tile
    v_add_u32 v2, 33792, v2
    v_add_u32 v3, 33792, v3
    s_barrier
    s_add_u32 s64, s63, 11
    s_and_b32 s64, s64, 15
    s_lshl_b32 s64, s64, 13
    s_add_u32 s64, s64, s62
    s_add_u32 m0, s76, 77632
    s_nop 0
    buffer_load_dwordx4 v6, s[16:19], s64 offen offset:512 nt lds
    s_add_u32 m0, s76, 78432
    s_nop 0
    buffer_load_dwordx4 v6, s[16:19], s64 offen offset:768 nt lds
    s_add_u32 m0, s76, 79232
    s_nop 0
    buffer_load_dwordx4 v6, s[16:19], s64 offen offset:1024 nt lds
    s_add_u32 m0, s76, 80032
    s_nop 0
    buffer_load_dwordx4 v6, s[16:19], s64 offen offset:1280 nt lds
    s_add_u32 m0, s76, 80832
    s_nop 0
    buffer_load_dwordx4 v6, s[16:19], s64 offen offset:1536 nt lds
    s_add_u32 m0, s76, 81632
    s_nop 0
    buffer_load_dwordx4 v6, s[16:19], s64 offen offset:1792 nt lds
    s_add_u32 s64, s63, 12
    s_and_b32 s64, s64, 15
    s_lshl_b32 s64, s64, 13
    s_add_u32 s64, s64, s62
    s_add_u32 m0, s76, 0
    s_nop 0
    buffer_load_dwordx4 v4, s[12:15], s64 offen offset:0 nt lds
    s_add_u32 m0, s76, 800
    s_nop 0
    buffer_load_dwordx4 v4, s[12:15], s64 offen offset:256 nt lds
    s_add_u32 m0, s76, 1600
    s_nop 0
    buffer_load_dwordx4 v4, s[12:15], s64 offen offset:512 nt lds
    s_add_u32 m0, s76, 2400
    s_nop 0
    buffer_load_dwordx4 v4, s[12:15], s64 offen offset:768 nt lds
    s_add_u32 m0, s76, 3200
    s_nop 0
    buffer_load_dwordx4 v5, s[12:15], s64 offen offset:1024 nt lds
    s_add_u32 m0, s76, 4000
    s_nop 0
    buffer_load_dwordx4 v5, s[12:15], s64 offen offset:1280 nt lds
    s_add_u32 m0, s76, 4800
    s_nop 0
    buffer_load_dwordx4 v5, s[12:15], s64 offen offset:1536 nt lds
    s_add_u32 m0, s76, 5600
    s_nop 0
    buffer_load_dwordx4 v5, s[12:15], s64 offen offset:1792 nt lds
    s_waitcnt vmcnt(14)
    s_barrier
    s_call_b64 s[80:81], L_tile
    v_add_u32 v2, 33792, v2
    v_add_u32 v3, 33792, v3
    s_barrier
    s_add_u32 s64, s63, 12
    s_and_b32 s64, s64, 15
    s_lshl_b32 s64, s64, 13
    s_add_u32 s64, s64, s62
    s_add_u32 m0, s76, 8448
    s_nop 0
    buffer_load_dwordx4 v6, s[16:19], s64 offen offset:0 nt lds
    s_add_u32 m0, s76, 9248
    s_nop 0
    buffer_load_dwordx4 v6, s[16:19], s64 offen offset:256 nt lds
    s_add_u32 m0, s76, 10048
    s_nop 0
    buffer_load_dwordx4 v6, s[16:19], s64 offen offset:512 nt lds
    s_add_u32 m0, s76, 10848
    s_nop 0
    buffer_load_dwordx4 v6, s[16:19], s64 offen offset:768 nt lds
    s_add_u32 m0, s76, 11648
    s_nop 0
    buffer_load_dwordx4 v6, s[16:19], s64 offen offset:1024 nt lds
    s_add_u32 m0, s76, 12448
    s_nop 0
    buffer_load_dwordx4 v6, s[16:19], s64 offen offset:1280 nt lds
    s_add_u32 m0, s76, 13248
    s_nop 0
    buffer_load_dwordx4 v6, s[16:19], s64 offen offset:1536 nt lds
    s_add_u32 m0, s76, 14048
    s_nop 0
    buffer_load_dwordx4 v6, s[16:19], s64 offen offset:1792 nt lds
    s_add_u32 s64, s63, 13
    s_and_b32 s64, s64, 15
    s_lshl_b32 s64, s64, 13
    s_add_u32 s64, s64, s62
    s_add_u32 m0, s76, 33792
    s_nop 0
    buffer_load_dwordx4 v4, s[12:15], s64 offen offset:0 nt lds
    s_add_u32 m0, s76, 34592
    s_nop 0
    buffer_load_dwordx4 v4, s[12:15], s64 offen offset:256 nt lds
    s_add_u32 m0, s76, 35392
    s_nop 0
    buffer_load_dwordx4 v4, s[12:15], s64 offen offset:512 nt lds
    s_add_u32 m0, s76, 36192
    s_nop 0
    buffer_load_dwordx4 v4, s[12:15], s64 offen offset:768 nt lds
    s_add_u32 m0, s76, 36992
    s_nop 0
    buffer_load_dwordx4 v5, s[12:15], s64 offen offset:1024 nt lds
    s_add_u32 m0, s76, 37792
    s_nop 0
    buffer_load_dwordx4 v5, s[12:15], s64 offen offset:1280 nt lds
    s_waitcnt vmcnt(14)
    s_barrier
    s_call_b64 s[80:81], L_tile
    v_add_u32 v2, -67584, v2
    v_add_u32 v3, -67584, v3
    s_barrier
    s_add_u32 s64, s63, 13
    s_and_b32 s64, s64, 15
    s_lshl_b32 s64, s64, 13
    s_add_u32 s64, s64, s62
    s_add_u32 m0, s76, 38592
    s_nop 0
    buffer_load_dwordx4 v5, s[12:15], s64 offen offset:1536 nt lds
    s_add_u32 m0, s76, 39392
    s_nop 0
    buffer_load_dwordx4 v5, s[12:15], s64 offen offset:1792 nt lds
    s_add_u32 m0, s76, 42240
    s_nop 0
    buffer_load_dwordx4 v6, s[16:19], s64 offen offset:0 nt lds
    s_add_u32 m0, s76, 43040
    s_nop 0
    buffer_load_dwordx4 v6, s[16:19], s64 offen offset:256 nt lds
    s_add_u32 m0, s76, 43840
    s_nop 0
    buffer_load_dwordx4 v6, s[16:19], s64 offen offset:512 nt lds
    s_add_u32 m0, s76, 44640
    s_nop 0
    buffer_load_dwordx4 v6, s[16:19], s64 offen offset:768 nt lds
    s_add_u32 m0, s76, 45440
    s_nop 0
    buffer_load_dwordx4 v6, s[16:19], s64 offen offset:1024 nt lds
    s_add_u32 m0, s76, 46240
    s_nop 0
    buffer_load_dwordx4 v6, s[16:19], s64 offen offset:1280 nt lds
    s_add_u32 m0, s76, 47040
    s_nop 0
    buffer_load_dwordx4 v6, s[16:19], s64 offen offset:1536 nt lds
    s_add_u32 m0, s76, 47840
    s_nop 0
    buffer_load_dwordx4 v6, s[16:19], s64 offen offset:1792 nt lds
    s_add_u32 s64, s63, 14
    s_and_b32 s64, s64, 15
    s_lshl_b32 s64, s64, 13
    s_add_u32 s64, s64, s62
    s_add_u32 m0, s76, 67584
    s_nop 0
    buffer_load_dwordx4 v4, s[12:15], s64 offen offset:0 nt lds
    s_add_u32 m0, s76, 68384
    s_nop 0
    buffer_load_dwordx4 v4, s[12:15], s64 offen offset:256 nt lds
    s_add_u32 m0, s76, 69184
    s_nop 0
    buffer_load_dwordx4 v4, s[12:15], s64 offen offset:512 nt lds
    s_add_u32 m0, s76, 69984
    s_nop 0
    buffer_load_dwordx4 v4, s[12:15], s64 offen offset:768 nt lds
    s_waitcnt vmcnt(14)
    s_barrier
    s_call_b64 s[80:81], L_tile
    v_add_u32 v2, 33792, v2
    v_add_u32 v3, 33792, v3
    s_barrier
    s_add_u32 s64, s63, 14
    s_and_b32 s64, s64, 15
    s_lshl_b32 s64, s64, 13
    s_add_u32 s64, s64, s62
    s_add_u32 m0, s76, 70784
    s_nop 0
    buffer_load_dwordx4 v5, s[12:15], s64 offen offset:1024 nt lds
    s_add_u32 m0, s76, 71584
    s_nop 0
    buffer_load_dwordx4 v5, s[12:15], s64 offen offset:1280 nt lds
    s_add_u32 m0, s76, 72384
    s_nop 0
    buffer_load_dwordx4 v5, s[12:15], s64 offen offset:1536 nt lds
    s_add_u32 m0, s76, 73184
    s_nop 0
    buffer_load_dwordx4 v5, s[12:15], s64 offen offset:1792 nt lds
    s_add_u32 m0, s76, 76032
    s_nop 0
    buffer_load_dwordx4 v6, s[16:19], s64 offen offset:0 nt lds
    s_add_u32 m0, s76, 76832
    s_nop 0
    buffer_load_dwordx4 v6, s[16:19], s64 offen offset:256 nt lds
    s_add_u32 m0, s76, 77632
    s_nop 0
    buffer_load_dwordx4 v6, s[16:19], s64 offen offset:512 nt lds
    s_add_u32 m0, s76, 78432
    s_nop 0
    buffer_load_dwordx4 v6, s[16:19], s64 offen offset:768 nt lds
    s_add_u32 m0, s76, 79232
    s_nop 0
    buffer_load_dwordx4 v6, s[16:19], s64 offen offset:1024 nt lds
    s_add_u32 m0, s76, 80032
    s_nop 0
    buffer_load_dwordx4 v6, s[16:19], s64 offen offset:1280 nt lds
    s_add_u32 m0, s76, 80832
    s_nop 0
    buffer_load_dwordx4 v6, s[16:19], s64 offen offset:1536 nt lds
    s_add_u32 m0, s76, 81632
    s_nop 0
    buffer_load_dwordx4 v6, s[16:19], s64 offen offset:1792 nt lds
    s_add_u32 s64, s63, 15
    s_and_b32 s64, s64, 15
    s_lshl_b32 s64, s64, 13
    s_add_u32 s64, s64, s62
    s_add_u32 m0, s76, 0
    s_nop 0
    buffer_load_dwordx4 v4, s[12:15], s64 offen offset:0 nt lds
    s_add_u32 m0, s76, 800
    s_nop 0
    buffer_load_dwordx4 v4, s[12:15], s64 offen offset:256 nt lds
    s_waitcnt vmcnt(14)
    s_barrier
    s_call_b64 s[80:81], L_tile
    v_add_u32 v2, 33792, v2
    v_add_u32 v3, 33792, v3
    s_barrier
    s_add_u32 s64, s63, 15
    s_and_b32 s64, s64, 15
    s_lshl_b32 s64, s64, 13
    s_add_u32 s64, s64, s62
    s_add_u32 m0, s76, 1600
    s_nop 0
    buffer_load_dwordx4 v4, s[12:15], s64 offen offset:512 nt lds
    s_add_u32 m0, s76, 2400
    s_nop 0
    buffer_load_dwordx4 v4, s[12:15], s64 offen offset:768 nt lds
    s_add_u32 m0, s76, 3200
    s_nop 0
    buffer_load_dwordx4 v5, s[12:15], s64 offen offset:1024 nt lds
    s_add_u32 m0, s76, 4000
    s_nop 0
    buffer_load_dwordx4 v5, s[12:15], s64 offen offset:1280 nt lds
    s_add_u32 m0, s76, 4800
    s_nop 0
    buffer_load_dwordx4 v5, s[12:15], s64 offen offset:1536 nt lds
    s_add_u32 m0, s76, 5600
    s_nop 0
    buffer_load_dwordx4 v5, s[12:15], s64 offen offset:1792 nt lds
    s_add_u32 m0, s76, 8448
    s_nop 0
    buffer_load_dwordx4 v6, s[16:19], s64 offen offset:0 nt lds
    s_add_u32 m0, s76, 9248
    s_nop 0
    buffer_load_dwordx4 v6, s[16:19], s64 offen offset:256 nt lds
    s_add_u32 m0, s76, 10048
    s_nop 0
    buffer_load_dwordx4 v6, s[16:19], s64 offen offset:512 nt lds
    s_add_u32 m0, s76, 10848
    s_nop 0
    buffer_load_dwordx4 v6, s[16:19], s64 offen offset:768 nt lds
    s_add_u32 m0, s76, 11648
    s_nop 0
    buffer_load_dwordx4 v6, s[16:19], s64 offen offset:1024 nt lds
    s_add_u32 m0, s76, 12448
    s_nop 0
    buffer_load_dwordx4 v6, s[16:19], s64 offen offset:1280 nt lds
    s_add_u32 m0, s76, 13248
    s_nop 0
    buffer_load_dwordx4 v6, s[16:19], s64 offen offset:1536 nt lds
    s_add_u32 m0, s76, 14048
    s_nop 0
    buffer_load_dwordx4 v6, s[16:19], s64 offen offset:1792 nt lds
    s_waitcnt vmcnt(14)
    s_barrier
    s_add_u32 s64, s86, 0
    s_and_b32 s64, s64, 7
    s_lshl_b32 s64, s64, 15
    s_add_u32 s64, s64, s70
    s_add_u32 m0, s75, 33792
    s_nop 0
    buffer_load_dwordx4 v7, s[24:27], s64 offen offset:0 lds
    s_add_u32 m0, s75, 33824
    s_nop 0
    buffer_load_dwordx4 v7, s[24:27], s64 offen offset:1024 lds
    s_add_u32 m0, s75, 33856
    s_nop 0
    buffer_load_dwordx4 v7, s[24:27], s64 offen offset:2048 lds
    s_add_u32 m0, s75, 33888
    s_nop 0
    buffer_load_dwordx4 v7, s[24:27], s64 offen offset:3072 lds
    s_add_u32 m0, s75, 38016
    s_add_u32 s64, s64, 4096
    buffer_load_dwordx4 v7, s[24:27], s64 offen offset:0 lds
    s_add_u32 m0, s75, 38048
    s_nop 0
    buffer_load_dwordx4 v7, s[24:27], s64 offen offset:1024 lds
    s_add_u32 m0, s75, 38080
    s_nop 0
    buffer_load_dwordx4 v7, s[24:27], s64 offen offset:2048 lds
    s_add_u32 m0, s75, 38112
    s_nop 0
    buffer_load_dwordx4 v7, s[24:27], s64 offen offset:3072 lds
    s_call_b64 s[80:81], L_tile
    v_add_u32 v2, -67584, v2
    v_add_u32 v3, -67584, v3
    s_barrier
    s_waitcnt vmcnt(8)
    s_barrier
    s_add_u32 s64, s86, 1
    s_and_b32 s64, s64, 7
    s_lshl_b32 s64, s64, 15
    s_add_u32 s64, s64, s70
    s_add_u32 m0, s75, 67584
    s_nop 0
    buffer_load_dwordx4 v7, s[24:27], s64 offen offset:0 lds
    s_add_u32 m0, s75, 67616
    s_nop 0
    buffer_load_dwordx4 v7, s[24:27], s64 offen offset:1024 lds
    s_add_u32 m0, s75, 67648
    s_nop 0
    buffer_load_dwordx4 v7, s[24:27], s64 offen offset:2048 lds
    s_add_u32 m0, s75, 67680
    s_nop 0
    buffer_load_dwordx4 v7, s[24:27], s64 offen offset:3072 lds
    s_add_u32 m0, s75, 71808
    s_add_u32 s64, s64, 4096
    buffer_load_dwordx4 v7, s[24:27], s64 offen offset:0 lds
    s_add_u32 m0, s75, 71840
    s_nop 0
    buffer_load_dwordx4 v7, s[24:27], s64 offen offset:1024 lds
    s_add_u32 m0, s75, 71872
    s_nop 0
    buffer_load_dwordx4 v7, s[24:27], s64 offen offset:2048 lds
    s_add_u32 m0, s75, 71904
    s_nop 0
    buffer_load_dwordx4 v7, s[24:27], s64 offen offset:3072 lds
    v_bfe_u32 v248, v0, 2, 3
    v_mul_u32_u24 v4, 1056, v248
    v_lshrrev_b32 v248, 5, v0
    v_lshl_add_u32 v4, v248, 9, v4
    v_and_b32 v248, 3, v0
    v_lshl_add_u32 v4, v248, 3, v4
    v_add_u32 v4, s75, v4
    v_add_u32 v5, 67584, v4
    s_call_b64 s[80:81], L_tile
    s_barrier
    s_nop 7
    v_rcp_f32 v232, v232
    v_rcp_f32 v233, v233
    v_rcp_f32 v236, v236
    v_rcp_f32 v237, v237
    v_rcp_f32 v240, v240
    v_rcp_f32 v241, v241
    v_pk_mul_f32 v[8:9], v[8:9], v[232:233]
    v_pk_mul_f32 v[10:11], v[10:11], v[232:233]
    v_pk_mul_f32 v[12:13], v[12:13], v[236:237]
    v_pk_mul_f32 v[14:15], v[14:15], v[236:237]
    v_pk_mul_f32 v[16:17], v[16:17], v[240:241]
    v_pk_mul_f32 v[18:19], v[18:19], v[240:241]
    v_pk_mul_f32 v[20:21], v[20:21], v[232:233]
    v_pk_mul_f32 v[22:23], v[22:23], v[232:233]
    v_pk_mul_f32 v[24:25], v[24:25], v[236:237]
    v_pk_mul_f32 v[26:27], v[26:27], v[236:237]
    v_pk_mul_f32 v[28:29], v[28:29], v[240:241]
    v_pk_mul_f32 v[30:31], v[30:31], v[240:241]
    v_pk_mul_f32 v[32:33], v[32:33], v[232:233]
    v_pk_mul_f32 v[34:35], v[34:35], v[232:233]
    v_pk_mul_f32 v[36:37], v[36:37], v[236:237]
    v_pk_mul_f32 v[38:39], v[38:39], v[236:237]
    v_pk_mul_f32 v[40:41], v[40:41], v[240:241]
    v_pk_mul_f32 v[42:43], v[42:43], v[240:241]
    v_pk_mul_f32 v[44:45], v[44:45], v[232:233]
    v_pk_mul_f32 v[46:47], v[46:47], v[232:233]
    v_pk_mul_f32 v[48:49], v[48:49], v[236:237]
    v_pk_mul_f32 v[50:51], v[50:51], v[236:237]
    v_pk_mul_f32 v[52:53], v[52:53], v[240:241]
    v_pk_mul_f32 v[54:55], v[54:55], v[240:241]
    v_pk_mul_f32 v[56:57], v[56:57], v[232:233]
    v_pk_mul_f32 v[58:59], v[58:59], v[232:233]
    v_pk_mul_f32 v[60:61], v[60:61], v[236:237]
    v_pk_mul_f32 v[62:63], v[62:63], v[236:237]
    v_pk_mul_f32 v[64:65], v[64:65], v[240:241]
    v_pk_mul_f32 v[66:67], v[66:67], v[240:241]
    v_pk_mul_f32 v[68:69], v[68:69], v[232:233]
    v_pk_mul_f32 v[70:71], v[70:71], v[232:233]
    v_pk_mul_f32 v[72:73], v[72:73], v[236:237]
    v_pk_mul_f32 v[74:75], v[74:75], v[236:237]
    v_pk_mul_f32 v[76:77], v[76:77], v[240:241]
    v_pk_mul_f32 v[78:79], v[78:79], v[240:241]
    v_pk_mul_f32 v[80:81], v[80:81], v[232:233]
    v_pk_mul_f32 v[82:83], v[82:83], v[232:233]
    v_pk_mul_f32 v[84:85], v[84:85], v[236:237]
    v_pk_mul_f32 v[86:87], v[86:87], v[236:237]
    v_pk_mul_f32 v[88:89], v[88:89], v[240:241]
    v_pk_mul_f32 v[90:91], v[90:91], v[240:241]
    v_pk_mul_f32 v[92:93], v[92:93], v[232:233]
    v_pk_mul_f32 v[94:95], v[94:95], v[232:233]
    v_pk_mul_f32 v[96:97], v[96:97], v[236:237]
    v_pk_mul_f32 v[98:99], v[98:99], v[236:237]
    v_pk_mul_f32 v[100:101], v[100:101], v[240:241]
    v_pk_mul_f32 v[102:103], v[102:103], v[240:241]
    v_cvt_pk_bf16_f32 v104, v8, v9
    v_cvt_pk_bf16_f32 v105, v10, v11
    v_cvt_pk_bf16_f32 v106, v20, v21
    v_cvt_pk_bf16_f32 v107, v22, v23
    v_cvt_pk_bf16_f32 v108, v12, v13
    v_cvt_pk_bf16_f32 v109, v14, v15
    v_cvt_pk_bf16_f32 v110, v24, v25
    v_cvt_pk_bf16_f32 v111, v26, v27
    v_cvt_pk_bf16_f32 v112, v16, v17
    v_cvt_pk_bf16_f32 v113, v18, v19
    v_cvt_pk_bf16_f32 v114, v28, v29
    v_cvt_pk_bf16_f32 v115, v30, v31
    v_cvt_pk_bf16_f32 v116, v32, v33
    v_cvt_pk_bf16_f32 v117, v34, v35
    v_cvt_pk_bf16_f32 v118, v44, v45
    v_cvt_pk_bf16_f32 v119, v46, v47
    v_cvt_pk_bf16_f32 v120, v36, v37
    v_cvt_pk_bf16_f32 v121, v38, v39
    v_cvt_pk_bf16_f32 v122, v48, v49
    v_cvt_pk_bf16_f32 v123, v50, v51
    v_cvt_pk_bf16_f32 v124, v40, v41
    v_cvt_pk_bf16_f32 v125, v42, v43
    v_cvt_pk_bf16_f32 v126, v52, v53
    v_cvt_pk_bf16_f32 v127, v54, v55
    v_cvt_pk_bf16_f32 v128, v56, v57
    v_cvt_pk_bf16_f32 v129, v58, v59
    v_cvt_pk_bf16_f32 v130, v68, v69
    v_cvt_pk_bf16_f32 v131, v70, v71
    v_cvt_pk_bf16_f32 v132, v60, v61
    v_cvt_pk_bf16_f32 v133, v62, v63
    v_cvt_pk_bf16_f32 v134, v72, v73
    v_cvt_pk_bf16_f32 v135, v74, v75
    v_cvt_pk_bf16_f32 v136, v64, v65
    v_cvt_pk_bf16_f32 v137, v66, v67
    v_cvt_pk_bf16_f32 v138, v76, v77
    v_cvt_pk_bf16_f32 v139, v78, v79
    v_cvt_pk_bf16_f32 v140, v80, v81
    v_cvt_pk_bf16_f32 v141, v82, v83
    v_cvt_pk_bf16_f32 v142, v92, v93
    v_cvt_pk_bf16_f32 v143, v94, v95
    v_cvt_pk_bf16_f32 v144, v84, v85
    v_cvt_pk_bf16_f32 v145, v86, v87
    v_cvt_pk_bf16_f32 v146, v96, v97
    v_cvt_pk_bf16_f32 v147, v98, v99
    v_cvt_pk_bf16_f32 v148, v88, v89
    v_cvt_pk_bf16_f32 v149, v90, v91
    v_cvt_pk_bf16_f32 v150, v100, v101
    v_cvt_pk_bf16_f32 v151, v102, v103
    s_and_b32 s65, s6, 1
    s_mul_i32 s65, s65, 12288
    s_add_u32 s66, s65, 130048
    v_add_u32 v251, s66, v1
    ds_read_b128 v[152:155], v251 offset:0
    ds_read_b128 v[156:159], v251 offset:1024
    ds_read_b128 v[160:163], v251 offset:2048
    ds_read_b128 v[164:167], v251 offset:3072
    ds_read_b128 v[168:171], v251 offset:4096
    ds_read_b128 v[172:175], v251 offset:5120
    ds_read_b128 v[176:179], v251 offset:6144
    ds_read_b128 v[180:183], v251 offset:7168
    ds_read_b128 v[184:187], v251 offset:8192
    ds_read_b128 v[188:191], v251 offset:9216
    ds_read_b128 v[192:195], v251 offset:10240
    ds_read_b128 v[196:199], v251 offset:11264
    v_add_u32 v250, s65, v1
    ds_write_b128 v250, v[104:107] offset:0
    ds_write_b128 v250, v[108:111] offset:1024
    ds_write_b128 v250, v[112:115] offset:2048
    ds_write_b128 v250, v[116:119] offset:3072
    ds_write_b128 v250, v[120:123] offset:4096
    ds_write_b128 v250, v[124:127] offset:5120
    ds_write_b128 v250, v[128:131] offset:6144
    ds_write_b128 v250, v[132:135] offset:7168
    ds_write_b128 v250, v[136:139] offset:8192
    ds_write_b128 v250, v[140:143] offset:9216
    ds_write_b128 v250, v[144:147] offset:10240
    ds_write_b128 v250, v[148:151] offset:11264
    s_waitcnt lgkmcnt(15)
    v_lshlrev_b32 v8, 16, v152
    v_and_b32 v9, 0xffff0000, v152
    v_lshlrev_b32 v10, 16, v153
    v_and_b32 v11, 0xffff0000, v153
    v_lshlrev_b32 v20, 16, v154
    v_and_b32 v21, 0xffff0000, v154
    v_lshlrev_b32 v22, 16, v155
    v_and_b32 v23, 0xffff0000, v155
    v_lshlrev_b32 v12, 16, v156
    v_and_b32 v13, 0xffff0000, v156
    v_lshlrev_b32 v14, 16, v157
    v_and_b32 v15, 0xffff0000, v157
    v_lshlrev_b32 v24, 16, v158
    v_and_b32 v25, 0xffff0000, v158
    v_lshlrev_b32 v26, 16, v159
    v_and_b32 v27, 0xffff0000, v159
    v_lshlrev_b32 v16, 16, v160
    v_and_b32 v17, 0xffff0000, v160
    v_lshlrev_b32 v18, 16, v161
    v_and_b32 v19, 0xffff0000, v161
    v_lshlrev_b32 v28, 16, v162
    v_and_b32 v29, 0xffff0000, v162
    v_lshlrev_b32 v30, 16, v163
    v_and_b32 v31, 0xffff0000, v163
    s_waitcnt lgkmcnt(15)
    v_lshlrev_b32 v32, 16, v164
    v_and_b32 v33, 0xffff0000, v164
    v_lshlrev_b32 v34, 16, v165
    v_and_b32 v35, 0xffff0000, v165
    v_lshlrev_b32 v44, 16, v166
    v_and_b32 v45, 0xffff0000, v166
    v_lshlrev_b32 v46, 16, v167
    v_and_b32 v47, 0xffff0000, v167
    v_lshlrev_b32 v36, 16, v168
    v_and_b32 v37, 0xffff0000, v168
    v_lshlrev_b32 v38, 16, v169
    v_and_b32 v39, 0xffff0000, v169
    v_lshlrev_b32 v48, 16, v170
    v_and_b32 v49, 0xffff0000, v170
    v_lshlrev_b32 v50, 16, v171
    v_and_b32 v51, 0xffff0000, v171
    v_lshlrev_b32 v40, 16, v172
    v_and_b32 v41, 0xffff0000, v172
    v_lshlrev_b32 v42, 16, v173
    v_and_b32 v43, 0xffff0000, v173
    v_lshlrev_b32 v52, 16, v174
    v_and_b32 v53, 0xffff0000, v174
    v_lshlrev_b32 v54, 16, v175
    v_and_b32 v55, 0xffff0000, v175
    s_waitcnt lgkmcnt(15)
    v_lshlrev_b32 v56, 16, v176
    v_and_b32 v57, 0xffff0000, v176
    v_lshlrev_b32 v58, 16, v177
    v_and_b32 v59, 0xffff0000, v177
    v_lshlrev_b32 v68, 16, v178
    v_and_b32 v69, 0xffff0000, v178
    v_lshlrev_b32 v70, 16, v179
    v_and_b32 v71, 0xffff0000, v179
    v_lshlrev_b32 v60, 16, v180
    v_and_b32 v61, 0xffff0000, v180
    v_lshlrev_b32 v62, 16, v181
    v_and_b32 v63, 0xffff0000, v181
    v_lshlrev_b32 v72, 16, v182
    v_and_b32 v73, 0xffff0000, v182
    v_lshlrev_b32 v74, 16, v183
    v_and_b32 v75, 0xffff0000, v183
    v_lshlrev_b32 v64, 16, v184
    v_and_b32 v65, 0xffff0000, v184
    v_lshlrev_b32 v66, 16, v185
    v_and_b32 v67, 0xffff0000, v185
    v_lshlrev_b32 v76, 16, v186
    v_and_b32 v77, 0xffff0000, v186
    v_lshlrev_b32 v78, 16, v187
    v_and_b32 v79, 0xffff0000, v187
    s_waitcnt lgkmcnt(12)
    v_lshlrev_b32 v80, 16, v188
    v_and_b32 v81, 0xffff0000, v188
    v_lshlrev_b32 v82, 16, v189
    v_and_b32 v83, 0xffff0000, v189
    v_lshlrev_b32 v92, 16, v190
    v_and_b32 v93, 0xffff0000, v190
    v_lshlrev_b32 v94, 16, v191
    v_and_b32 v95, 0xffff0000, v191
    v_lshlrev_b32 v84, 16, v192
    v_and_b32 v85, 0xffff0000, v192
    v_lshlrev_b32 v86, 16, v193
    v_and_b32 v87, 0xffff0000, v193
    v_lshlrev_b32 v96, 16, v194
    v_and_b32 v97, 0xffff0000, v194
    v_lshlrev_b32 v98, 16, v195
    v_and_b32 v99, 0xffff0000, v195
    v_lshlrev_b32 v88, 16, v196
    v_and_b32 v89, 0xffff0000, v196
    v_lshlrev_b32 v90, 16, v197
    v_and_b32 v91, 0xffff0000, v197
    v_lshlrev_b32 v100, 16, v198
    v_and_b32 v101, 0xffff0000, v198
    v_lshlrev_b32 v102, 16, v199
    v_and_b32 v103, 0xffff0000, v199
    s_branch L_P3
L_A:
    s_cmp_eq_u32 s6, 0
    s_cbranch_scc0 L_c_18
    v_mov_b32 v16, 163808
    v_mov_b32 v18, 0
    v_mov_b32 v19, 0
    v_mov_b32 v21, 0
    s_lshl_b32 s66, s2, 7
    s_add_u32 s66, s66, 0x3000000
    buffer_load_dword v20, v18, s[28:31], s66 offen sc1
    buffer_load_dword v28, v18, s[28:31], s66 offen offset:4 sc1
    v_mov_b32 v26, 0
    v_mov_b32 v27, 0
    v_mov_b32 v29, 0
    s_mov_b32 s32, s58
    s_mov_b32 s33, s59
    s_mov_b32 s34, 256
    s_mov_b32 s35, 0x20000
    s_lshl_b32 s66, s4, 3
    v_mov_b32 v22, 1
    s_waitcnt vmcnt(0)
    ds_write_b128 v16, v[18:21]
    ds_write_b128 v16, v[26:29] offset:16
    s_mov_b64 exec, 1
    buffer_atomic_add v22, v18, s[32:35], s66 offen sc1
    s_mov_b64 exec, -1
    s_waitcnt lgkmcnt(0)
L_c_18:
    s_mov_b32 s0, 0x05040100
    s_mov_b32 s61, 0x07060302
    v_lshrrev_b32 v24, 4, v0
    v_and_b32 v25, 15, v0
    v_lshlrev_b32 v25, 4, v25
    v_lshl_add_u32 v244, v24, 16, v25
    v_lshl_add_u32 v7, v24, 12, v25
    s_lshl_b32 s65, s6, 13
    s_add_u32 s71, s71, s65
    s_lshl_b32 s70, s6, 10
    s_mov_b32 s72, s86
    v_mov_b32 v26, 0
    s_mov_b64 exec, 1
    buffer_load_dword v27, v26, s[8:11], s71 offen
    s_lshl_b32 s65, s6, 20
    buffer_load_dword v27, v26, s[20:23], s65 offen
    s_lshl_b32 s65, s5, 19
    buffer_load_dword v27, v26, s[24:27], s65 offen
    s_mov_b64 exec, -1
    s_barrier
    s_barrier
    s_waitcnt vmcnt(0)
    v_mov_b32 v8, 0
    v_mov_b32 v9, 0
    v_mov_b32 v10, 0
    v_mov_b32 v11, 0
    v_mov_b32 v12, 0
    v_mov_b32 v13, 0
    v_mov_b32 v14, 0
    v_mov_b32 v15, 0
    v_mov_b32 v16, 0
    v_mov_b32 v17, 0
    v_mov_b32 v18, 0
    v_mov_b32 v19, 0
    v_mov_b32 v20, 0
    v_mov_b32 v21, 0
    v_mov_b32 v22, 0
    v_mov_b32 v23, 0
    v_mov_b32 v24, 0
    v_mov_b32 v25, 0
    v_mov_b32 v26, 0
    v_mov_b32 v27, 0
    v_mov_b32 v28, 0
    v_mov_b32 v29, 0
    v_mov_b32 v30, 0
    v_mov_b32 v31, 0
    v_mov_b32 v32, 0
    v_mov_b32 v33, 0
    v_mov_b32 v34, 0
    v_mov_b32 v35, 0
    v_mov_b32 v36, 0
    v_mov_b32 v37, 0
    v_mov_b32 v38, 0
    v_mov_b32 v39, 0
    v_mov_b32 v40, 0
    v_mov_b32 v41, 0
    v_mov_b32 v42, 0
    v_mov_b32 v43, 0
    v_mov_b32 v44, 0
    v_mov_b32 v45, 0
    v_mov_b32 v46, 0
    v_mov_b32 v47, 0
    v_mov_b32 v48, 0
    v_mov_b32 v49, 0
    v_mov_b32 v50, 0
    v_mov_b32 v51, 0
    v_mov_b32 v52, 0
    v_mov_b32 v53, 0
    v_mov_b32 v54, 0
    v_mov_b32 v55, 0
    v_mov_b32 v56, 0
    v_mov_b32 v57, 0
    v_mov_b32 v58, 0
    v_mov_b32 v59, 0
    v_mov_b32 v60, 0
    v_mov_b32 v61, 0
    v_mov_b32 v62, 0
    v_mov_b32 v63, 0
    v_mov_b32 v64, 0
    v_mov_b32 v65, 0
    v_mov_b32 v66, 0
    v_mov_b32 v67, 0
    v_mov_b32 v68, 0
    v_mov_b32 v69, 0
    v_mov_b32 v70, 0
    v_mov_b32 v71, 0
    v_mov_b32 v72, 0
    v_mov_b32 v73, 0
    v_mov_b32 v74, 0
    v_mov_b32 v75, 0
    v_mov_b32 v76, 0
    v_mov_b32 v77, 0
    v_mov_b32 v78, 0
    v_mov_b32 v79, 0
    v_mov_b32 v80, 0
    v_mov_b32 v81, 0
    v_mov_b32 v82, 0
    v_mov_b32 v83, 0
    v_mov_b32 v84, 0
    v_mov_b32 v85, 0
    v_mov_b32 v86, 0
    v_mov_b32 v87, 0
    v_mov_b32 v88, 0
    v_mov_b32 v89, 0
    v_mov_b32 v90, 0
    v_mov_b32 v91, 0
    v_mov_b32 v92, 0
    v_mov_b32 v93, 0
    v_mov_b32 v94, 0
    v_mov_b32 v95, 0
    v_mov_b32 v96, 0
    v_mov_b32 v97, 0
    v_mov_b32 v98, 0
    v_mov_b32 v99, 0
    v_mov_b32 v100, 0
    v_mov_b32 v101, 0
    v_mov_b32 v102, 0
    v_mov_b32 v103, 0
    s_barrier
    s_add_u32 s64, s72, 0
    s_and_b32 s64, s64, 7
    s_lshl_b32 s64, s64, 1
    s_add_u32 s64, s64, s82
    s_lshl_b32 s64, s64, 18
    s_add_u32 s64, s64, s69
    buffer_load_dwordx4 v[152:155], v244, s[20:23], s64 offen
    s_add_u32 s64, s64, 8192
    buffer_load_dwordx4 v[156:159], v244, s[20:23], s64 offen
    s_add_u32 s64, s64, 8192
    buffer_load_dwordx4 v[160:163], v244, s[20:23], s64 offen
    s_add_u32 s64, s64, 8192
    buffer_load_dwordx4 v[164:167], v244, s[20:23], s64 offen
    s_add_u32 s64, s64, 8192
    buffer_load_dwordx4 v[168:171], v244, s[20:23], s64 offen
    s_add_u32 s64, s64, 8192
    buffer_load_dwordx4 v[172:175], v244, s[20:23], s64 offen
    s_add_u32 s64, s64, 8192
    buffer_load_dwordx4 v[176:179], v244, s[20:23], s64 offen
    s_add_u32 s64, s64, 8192
    buffer_load_dwordx4 v[180:183], v244, s[20:23], s64 offen
    s_add_u32 s64, s72, 0
    s_and_b32 s64, s64, 7
    s_lshl_b32 s64, s64, 1
    s_add_u32 s64, s64, s83
    s_lshl_b32 s64, s64, 18
    s_add_u32 s64, s64, s69
    buffer_load_dwordx4 v[184:187], v244, s[20:23], s64 offen
    s_add_u32 s64, s64, 8192
    buffer_load_dwordx4 v[188:191], v244, s[20:23], s64 offen
    s_add_u32 s64, s64, 8192
    buffer_load_dwordx4 v[192:195], v244, s[20:23], s64 offen
    s_add_u32 s64, s64, 8192
    buffer_load_dwordx4 v[196:199], v244, s[20:23], s64 offen
    s_add_u32 s64, s64, 8192
    buffer_load_dwordx4 v[200:203], v244, s[20:23], s64 offen
    s_add_u32 s64, s64, 8192
    buffer_load_dwordx4 v[204:207], v244, s[20:23], s64 offen
    s_add_u32 s64, s64, 8192
    buffer_load_dwordx4 v[208:211], v244, s[20:23], s64 offen
    s_add_u32 s64, s64, 8192
    buffer_load_dwordx4 v[212:215], v244, s[20:23], s64 offen
    s_barrier
    s_barrier
    s_barrier
    s_barrier
    s_add_u32 s87, s70, 0
    s_add_u32 s73, s72, 0
    s_and_b32 s73, s73, 7
    s_lshl_b32 s67, s73, 7
    s_add_u32 s67, s67, s71
    s_add_u32 m0, s87, 0
    s_add_u32 s67, s67, 0
    buffer_load_dwordx4 v246, s[8:11], s67 offen lds
    s_cmp_lt_u32 s6, 2
    s_cbranch_scc0 L_c_19
    s_lshl_b32 s67, s73, 7
    s_add_u32 s67, s67, s71
    s_add_u32 m0, s87, 4096
    s_add_u32 s67, s67, 32768
    buffer_load_dwordx4 v246, s[8:11], s67 offen lds
L_c_19:
    s_add_u32 s87, s70, 6144
    s_add_u32 s73, s72, 1
    s_and_b32 s73, s73, 7
    s_lshl_b32 s67, s73, 7
    s_add_u32 s67, s67, s71
    s_add_u32 m0, s87, 0
    s_add_u32 s67, s67, 0
    buffer_load_dwordx4 v246, s[8:11], s67 offen lds
    s_cmp_lt_u32 s6, 2
    s_cbranch_scc0 L_c_20
    s_lshl_b32 s67, s73, 7
    s_add_u32 s67, s67, s71
    s_add_u32 m0, s87, 4096
    s_add_u32 s67, s67, 32768
    buffer_load_dwordx4 v246, s[8:11], s67 offen lds
L_c_20:
    s_barrier
    s_barrier
    s_mov_b32 s74, 0
    s_mov_b32 s68, 0
    s_waitcnt vmcnt(8)
    v_perm_b32 v104, v156, v152, s0
    v_perm_b32 v105, v164, v160, s0
    v_perm_b32 v106, v172, v168, s0
    v_perm_b32 v107, v180, v176, s0
    v_perm_b32 v108, v156, v152, s61
    v_perm_b32 v109, v164, v160, s61
    v_perm_b32 v110, v172, v168, s61
    v_perm_b32 v111, v180, v176, s61
    v_perm_b32 v112, v157, v153, s0
    v_perm_b32 v113, v165, v161, s0
    v_perm_b32 v114, v173, v169, s0
    v_perm_b32 v115, v181, v177, s0
    v_perm_b32 v116, v157, v153, s61
    v_perm_b32 v117, v165, v161, s61
    v_perm_b32 v118, v173, v169, s61
    v_perm_b32 v119, v181, v177, s61
    v_perm_b32 v120, v158, v154, s0
    v_perm_b32 v121, v166, v162, s0
    v_perm_b32 v122, v174, v170, s0
    v_perm_b32 v123, v182, v178, s0
    v_perm_b32 v124, v158, v154, s61
    v_perm_b32 v125, v166, v162, s61
    v_perm_b32 v126, v174, v170, s61
    v_perm_b32 v127, v182, v178, s61
    v_perm_b32 v128, v159, v155, s0
    v_perm_b32 v129, v167, v163, s0
    v_perm_b32 v130, v175, v171, s0
    v_perm_b32 v131, v183, v179, s0
    v_perm_b32 v132, v159, v155, s61
    v_perm_b32 v133, v167, v163, s61
    v_perm_b32 v134, v175, v171, s61
    v_perm_b32 v135, v183, v179, s61
L_A_q:
    s_barrier
    s_lshl_b32 s65, s82, 6
    v_xor_b32 v248, s65, v245
    v_add_u32 v248, s74, v248
    ds_read_b128 v[232:235], v248 offset:0
    ds_read_b128 v[236:239], v248 offset:2048
    ds_read_b128 v[240:243], v248 offset:4096
    s_waitcnt lgkmcnt(0)
    v_mfma_f32_16x16x32_bf16 v[8:11], v[104:107], v[232:235], v[8:11]
    v_mfma_f32_16x16x32_bf16 v[12:15], v[104:107], v[236:239], v[12:15]
    v_mfma_f32_16x16x32_bf16 v[16:19], v[104:107], v[240:243], v[16:19]
    v_mfma_f32_16x16x32_bf16 v[20:23], v[108:111], v[232:235], v[20:23]
    v_mfma_f32_16x16x32_bf16 v[24:27], v[108:111], v[236:239], v[24:27]
    v_mfma_f32_16x16x32_bf16 v[28:31], v[108:111], v[240:243], v[28:31]
    v_mfma_f32_16x16x32_bf16 v[32:35], v[112:115], v[232:235], v[32:35]
    v_mfma_f32_16x16x32_bf16 v[36:39], v[112:115], v[236:239], v[36:39]
    v_mfma_f32_16x16x32_bf16 v[40:43], v[112:115], v[240:243], v[40:43]
    v_mfma_f32_16x16x32_bf16 v[44:47], v[116:119], v[232:235], v[44:47]
    v_mfma_f32_16x16x32_bf16 v[48:51], v[116:119], v[236:239], v[48:51]
    v_mfma_f32_16x16x32_bf16 v[52:55], v[116:119], v[240:243], v[52:55]
    v_mfma_f32_16x16x32_bf16 v[56:59], v[120:123], v[232:235], v[56:59]
    v_mfma_f32_16x16x32_bf16 v[60:63], v[120:123], v[236:239], v[60:63]
    v_mfma_f32_16x16x32_bf16 v[64:67], v[120:123], v[240:243], v[64:67]
    v_mfma_f32_16x16x32_bf16 v[68:71], v[124:127], v[232:235], v[68:71]
    v_mfma_f32_16x16x32_bf16 v[72:75], v[124:127], v[236:239], v[72:75]
    v_mfma_f32_16x16x32_bf16 v[76:79], v[124:127], v[240:243], v[76:79]
    v_mfma_f32_16x16x32_bf16 v[80:83], v[128:131], v[232:235], v[80:83]
    v_mfma_f32_16x16x32_bf16 v[84:87], v[128:131], v[236:239], v[84:87]
    v_mfma_f32_16x16x32_bf16 v[88:91], v[128:131], v[240:243], v[88:91]
    v_mfma_f32_16x16x32_bf16 v[92:95], v[132:135], v[232:235], v[92:95]
    v_mfma_f32_16x16x32_bf16 v[96:99], v[132:135], v[236:239], v[96:99]
    v_mfma_f32_16x16x32_bf16 v[100:103], v[132:135], v[240:243], v[100:103]
    s_sub_u32 s65, s68, 1
    s_cmp_lt_u32 s65, 6
    s_cbranch_scc0 L_nx_21
    s_xor_b32 s87, s74, 6144
    s_add_u32 s87, s87, s70
    s_add_u32 s73, s72, 1
    s_and_b32 s73, s73, 7
    s_lshl_b32 s67, s73, 7
    s_add_u32 s67, s67, s71
    s_add_u32 m0, s87, 0
    s_add_u32 s67, s67, 0
    buffer_load_dwordx4 v246, s[8:11], s67 offen lds
    s_cmp_lt_u32 s6, 2
    s_cbranch_scc0 L_c_22
    s_lshl_b32 s67, s73, 7
    s_add_u32 s67, s67, s71
    s_add_u32 m0, s87, 4096
    s_add_u32 s67, s67, 32768
    buffer_load_dwordx4 v246, s[8:11], s67 offen lds
L_c_22:
L_nx_21:
    s_cmp_eq_u32 s68, 7
    s_cbranch_scc1 L_c_23
    s_add_u32 s64, s72, 1
    s_and_b32 s64, s64, 7
    s_lshl_b32 s64, s64, 1
    s_add_u32 s64, s64, s82
    s_lshl_b32 s64, s64, 18
    s_add_u32 s64, s64, s69
    buffer_load_dwordx4 v[152:155], v244, s[20:23], s64 offen
    s_add_u32 s64, s64, 8192
    buffer_load_dwordx4 v[156:159], v244, s[20:23], s64 offen
    s_add_u32 s64, s64, 8192
    buffer_load_dwordx4 v[160:163], v244, s[20:23], s64 offen
    s_add_u32 s64, s64, 8192
    buffer_load_dwordx4 v[164:167], v244, s[20:23], s64 offen
    s_add_u32 s64, s64, 8192
    buffer_load_dwordx4 v[168:171], v244, s[20:23], s64 offen
    s_add_u32 s64, s64, 8192
    buffer_load_dwordx4 v[172:175], v244, s[20:23], s64 offen
    s_add_u32 s64, s64, 8192
    buffer_load_dwordx4 v[176:179], v244, s[20:23], s64 offen
    s_add_u32 s64, s64, 8192
    buffer_load_dwordx4 v[180:183], v244, s[20:23], s64 offen
L_c_23:
    s_barrier
    s_cmp_eq_u32 s68, 7
    s_cbranch_scc0 L_c_24
    s_waitcnt vmcnt(0)
L_c_24:
    s_waitcnt vmcnt(8)
    v_perm_b32 v104, v188, v184, s0
    v_perm_b32 v105, v196, v192, s0
    v_perm_b32 v106, v204, v200, s0
    v_perm_b32 v107, v212, v208, s0
    v_perm_b32 v108, v188, v184, s61
    v_perm_b32 v109, v196, v192, s61
    v_perm_b32 v110, v204, v200, s61
    v_perm_b32 v111, v212, v208, s61
    v_perm_b32 v112, v189, v185, s0
    v_perm_b32 v113, v197, v193, s0
    v_perm_b32 v114, v205, v201, s0
    v_perm_b32 v115, v213, v209, s0
    v_perm_b32 v116, v189, v185, s61
    v_perm_b32 v117, v197, v193, s61
    v_perm_b32 v118, v205, v201, s61
    v_perm_b32 v119, v213, v209, s61
    v_perm_b32 v120, v190, v186, s0
    v_perm_b32 v121, v198, v194, s0
    v_perm_b32 v122, v206, v202, s0
    v_perm_b32 v123, v214, v210, s0
    v_perm_b32 v124, v190, v186, s61
    v_perm_b32 v125, v198, v194, s61
    v_perm_b32 v126, v206, v202, s61
    v_perm_b32 v127, v214, v210, s61
    v_perm_b32 v128, v191, v187, s0
    v_perm_b32 v129, v199, v195, s0
    v_perm_b32 v130, v207, v203, s0
    v_perm_b32 v131, v215, v211, s0
    v_perm_b32 v132, v191, v187, s61
    v_perm_b32 v133, v199, v195, s61
    v_perm_b32 v134, v207, v203, s61
    v_perm_b32 v135, v215, v211, s61
    s_barrier
    s_lshl_b32 s65, s83, 6
    v_xor_b32 v248, s65, v245
    v_add_u32 v248, s74, v248
    ds_read_b128 v[232:235], v248 offset:0
    ds_read_b128 v[236:239], v248 offset:2048
    ds_read_b128 v[240:243], v248 offset:4096
    s_waitcnt lgkmcnt(0)
    v_mfma_f32_16x16x32_bf16 v[8:11], v[104:107], v[232:235], v[8:11]
    v_mfma_f32_16x16x32_bf16 v[12:15], v[104:107], v[236:239], v[12:15]
    v_mfma_f32_16x16x32_bf16 v[16:19], v[104:107], v[240:243], v[16:19]
    v_mfma_f32_16x16x32_bf16 v[20:23], v[108:111], v[232:235], v[20:23]
    v_mfma_f32_16x16x32_bf16 v[24:27], v[108:111], v[236:239], v[24:27]
    v_mfma_f32_16x16x32_bf16 v[28:31], v[108:111], v[240:243], v[28:31]
    v_mfma_f32_16x16x32_bf16 v[32:35], v[112:115], v[232:235], v[32:35]
    v_mfma_f32_16x16x32_bf16 v[36:39], v[112:115], v[236:239], v[36:39]
    v_mfma_f32_16x16x32_bf16 v[40:43], v[112:115], v[240:243], v[40:43]
    v_mfma_f32_16x16x32_bf16 v[44:47], v[116:119], v[232:235], v[44:47]
    v_mfma_f32_16x16x32_bf16 v[48:51], v[116:119], v[236:239], v[48:51]
    v_mfma_f32_16x16x32_bf16 v[52:55], v[116:119], v[240:243], v[52:55]
    v_mfma_f32_16x16x32_bf16 v[56:59], v[120:123], v[232:235], v[56:59]
    v_mfma_f32_16x16x32_bf16 v[60:63], v[120:123], v[236:239], v[60:63]
    v_mfma_f32_16x16x32_bf16 v[64:67], v[120:123], v[240:243], v[64:67]
    v_mfma_f32_16x16x32_bf16 v[68:71], v[124:127], v[232:235], v[68:71]
    v_mfma_f32_16x16x32_bf16 v[72:75], v[124:127], v[236:239], v[72:75]
    v_mfma_f32_16x16x32_bf16 v[76:79], v[124:127], v[240:243], v[76:79]
    v_mfma_f32_16x16x32_bf16 v[80:83], v[128:131], v[232:235], v[80:83]
    v_mfma_f32_16x16x32_bf16 v[84:87], v[128:131], v[236:239], v[84:87]
    v_mfma_f32_16x16x32_bf16 v[88:91], v[128:131], v[240:243], v[88:91]
    v_mfma_f32_16x16x32_bf16 v[92:95], v[132:135], v[232:235], v[92:95]
    v_mfma_f32_16x16x32_bf16 v[96:99], v[132:135], v[236:239], v[96:99]
    v_mfma_f32_16x16x32_bf16 v[100:103], v[132:135], v[240:243], v[100:103]
    s_cmp_eq_u32 s68, 7
    s_cbranch_scc1 L_c_25
    s_add_u32 s64, s72, 1
    s_and_b32 s64, s64, 7
    s_lshl_b32 s64, s64, 1
    s_add_u32 s64, s64, s83
    s_lshl_b32 s64, s64, 18
    s_add_u32 s64, s64, s69
    buffer_load_dwordx4 v[184:187], v244, s[20:23], s64 offen
    s_add_u32 s64, s64, 8192
    buffer_load_dwordx4 v[188:191], v244, s[20:23], s64 offen
    s_add_u32 s64, s64, 8192
    buffer_load_dwordx4 v[192:195], v244, s[20:23], s64 offen
    s_add_u32 s64, s64, 8192
    buffer_load_dwordx4 v[196:199], v244, s[20:23], s64 offen
    s_add_u32 s64, s64, 8192
    buffer_load_dwordx4 v[200:203], v244, s[20:23], s64 offen
    s_add_u32 s64, s64, 8192
    buffer_load_dwordx4 v[204:207], v244, s[20:23], s64 offen
    s_add_u32 s64, s64, 8192
    buffer_load_dwordx4 v[208:211], v244, s[20:23], s64 offen
    s_add_u32 s64, s64, 8192
    buffer_load_dwordx4 v[212:215], v244, s[20:23], s64 offen
L_c_25:
    s_barrier
    s_waitcnt vmcnt(8)
    s_cmp_eq_u32 s68, 7
    s_cbranch_scc1 L_c_26
    v_perm_b32 v104, v156, v152, s0
    v_perm_b32 v105, v164, v160, s0
    v_perm_b32 v106, v172, v168, s0
    v_perm_b32 v107, v180, v176, s0
    v_perm_b32 v108, v156, v152, s61
    v_perm_b32 v109, v164, v160, s61
    v_perm_b32 v110, v172, v168, s61
    v_perm_b32 v111, v180, v176, s61
    v_perm_b32 v112, v157, v153, s0
    v_perm_b32 v113, v165, v161, s0
    v_perm_b32 v114, v173, v169, s0
    v_perm_b32 v115, v181, v177, s0
    v_perm_b32 v116, v157, v153, s61
    v_perm_b32 v117, v165, v161, s61
    v_perm_b32 v118, v173, v169, s61
    v_perm_b32 v119, v181, v177, s61
    v_perm_b32 v120, v158, v154, s0
    v_perm_b32 v121, v166, v162, s0
    v_perm_b32 v122, v174, v170, s0
    v_perm_b32 v123, v182, v178, s0
    v_perm_b32 v124, v158, v154, s61
    v_perm_b32 v125, v166, v162, s61
    v_perm_b32 v126, v174, v170, s61
    v_perm_b32 v127, v182, v178, s61
    v_perm_b32 v128, v159, v155, s0
    v_perm_b32 v129, v167, v163, s0
    v_perm_b32 v130, v175, v171, s0
    v_perm_b32 v131, v183, v179, s0
    v_perm_b32 v132, v159, v155, s61
    v_perm_b32 v133, v167, v163, s61
    v_perm_b32 v134, v175, v171, s61
    v_perm_b32 v135, v183, v179, s61
L_c_26:
    s_add_u32 s72, s72, 1
    s_and_b32 s72, s72, 7
    s_xor_b32 s74, s74, 6144
    s_add_u32 s68, s68, 1
    s_cmp_lt_u32 s68, 8
    s_cbranch_scc1 L_A_q
    s_barrier
    s_nop 7
    v_pk_mul_f32 v[8:9], v[8:9], s[88:89] op_sel_hi:[1,0]
    v_pk_mul_f32 v[10:11], v[10:11], s[88:89] op_sel_hi:[1,0]
    v_pk_mul_f32 v[12:13], v[12:13], s[88:89] op_sel_hi:[1,0]
    v_pk_mul_f32 v[14:15], v[14:15], s[88:89] op_sel_hi:[1,0]
    v_pk_mul_f32 v[16:17], v[16:17], s[88:89] op_sel_hi:[1,0]
    v_pk_mul_f32 v[18:19], v[18:19], s[88:89] op_sel_hi:[1,0]
    v_pk_mul_f32 v[20:21], v[20:21], s[88:89] op_sel_hi:[1,0]
    v_pk_mul_f32 v[22:23], v[22:23], s[88:89] op_sel_hi:[1,0]
    v_pk_mul_f32 v[24:25], v[24:25], s[88:89] op_sel_hi:[1,0]
    v_pk_mul_f32 v[26:27], v[26:27], s[88:89] op_sel_hi:[1,0]
    v_pk_mul_f32 v[28:29], v[28:29], s[88:89] op_sel_hi:[1,0]
    v_pk_mul_f32 v[30:31], v[30:31], s[88:89] op_sel_hi:[1,0]
    v_pk_mul_f32 v[32:33], v[32:33], s[88:89] op_sel_hi:[1,0]
    v_pk_mul_f32 v[34:35], v[34:35], s[88:89] op_sel_hi:[1,0]
    v_pk_mul_f32 v[36:37], v[36:37], s[88:89] op_sel_hi:[1,0]
    v_pk_mul_f32 v[38:39], v[38:39], s[88:89] op_sel_hi:[1,0]
    v_pk_mul_f32 v[40:41], v[40:41], s[88:89] op_sel_hi:[1,0]
    v_pk_mul_f32 v[42:43], v[42:43], s[88:89] op_sel_hi:[1,0]
    v_pk_mul_f32 v[44:45], v[44:45], s[88:89] op_sel_hi:[1,0]
    v_pk_mul_f32 v[46:47], v[46:47], s[88:89] op_sel_hi:[1,0]
    v_pk_mul_f32 v[48:49], v[48:49], s[88:89] op_sel_hi:[1,0]
    v_pk_mul_f32 v[50:51], v[50:51], s[88:89] op_sel_hi:[1,0]
    v_pk_mul_f32 v[52:53], v[52:53], s[88:89] op_sel_hi:[1,0]
    v_pk_mul_f32 v[54:55], v[54:55], s[88:89] op_sel_hi:[1,0]
    v_pk_mul_f32 v[56:57], v[56:57], s[88:89] op_sel_hi:[1,0]
    v_pk_mul_f32 v[58:59], v[58:59], s[88:89] op_sel_hi:[1,0]
    v_pk_mul_f32 v[60:61], v[60:61], s[88:89] op_sel_hi:[1,0]
    v_pk_mul_f32 v[62:63], v[62:63], s[88:89] op_sel_hi:[1,0]
    v_pk_mul_f32 v[64:65], v[64:65], s[88:89] op_sel_hi:[1,0]
    v_pk_mul_f32 v[66:67], v[66:67], s[88:89] op_sel_hi:[1,0]
    v_pk_mul_f32 v[68:69], v[68:69], s[88:89] op_sel_hi:[1,0]
    v_pk_mul_f32 v[70:71], v[70:71], s[88:89] op_sel_hi:[1,0]
    v_pk_mul_f32 v[72:73], v[72:73], s[88:89] op_sel_hi:[1,0]
    v_pk_mul_f32 v[74:75], v[74:75], s[88:89] op_sel_hi:[1,0]
    v_pk_mul_f32 v[76:77], v[76:77], s[88:89] op_sel_hi:[1,0]
    v_pk_mul_f32 v[78:79], v[78:79], s[88:89] op_sel_hi:[1,0]
    v_pk_mul_f32 v[80:81], v[80:81], s[88:89] op_sel_hi:[1,0]
    v_pk_mul_f32 v[82:83], v[82:83], s[88:89] op_sel_hi:[1,0]
    v_pk_mul_f32 v[84:85], v[84:85], s[88:89] op_sel_hi:[1,0]
    v_pk_mul_f32 v[86:87], v[86:87], s[88:89] op_sel_hi:[1,0]
    v_pk_mul_f32 v[88:89], v[88:89], s[88:89] op_sel_hi:[1,0]
    v_pk_mul_f32 v[90:91], v[90:91], s[88:89] op_sel_hi:[1,0]
    v_pk_mul_f32 v[92:93], v[92:93], s[88:89] op_sel_hi:[1,0]
    v_pk_mul_f32 v[94:95], v[94:95], s[88:89] op_sel_hi:[1,0]
    v_pk_mul_f32 v[96:97], v[96:97], s[88:89] op_sel_hi:[1,0]
    v_pk_mul_f32 v[98:99], v[98:99], s[88:89] op_sel_hi:[1,0]
    v_pk_mul_f32 v[100:101], v[100:101], s[88:89] op_sel_hi:[1,0]
    v_pk_mul_f32 v[102:103], v[102:103], s[88:89] op_sel_hi:[1,0]
    v_cvt_pk_bf16_f32 v104, v8, v20
    v_cvt_pk_bf16_f32 v105, v32, v44
    v_cvt_pk_bf16_f32 v106, v56, v68
    v_cvt_pk_bf16_f32 v107, v80, v92
    v_cvt_pk_bf16_f32 v108, v12, v24
    v_cvt_pk_bf16_f32 v109, v36, v48
    v_cvt_pk_bf16_f32 v110, v60, v72
    v_cvt_pk_bf16_f32 v111, v84, v96
    v_cvt_pk_bf16_f32 v112, v16, v28
    v_cvt_pk_bf16_f32 v113, v40, v52
    v_cvt_pk_bf16_f32 v114, v64, v76
    v_cvt_pk_bf16_f32 v115, v88, v100
    v_cvt_pk_bf16_f32 v116, v9, v21
    v_cvt_pk_bf16_f32 v117, v33, v45
    v_cvt_pk_bf16_f32 v118, v57, v69
    v_cvt_pk_bf16_f32 v119, v81, v93
    v_cvt_pk_bf16_f32 v120, v13, v25
    v_cvt_pk_bf16_f32 v121, v37, v49
    v_cvt_pk_bf16_f32 v122, v61, v73
    v_cvt_pk_bf16_f32 v123, v85, v97
    v_cvt_pk_bf16_f32 v124, v17, v29
    v_cvt_pk_bf16_f32 v125, v41, v53
    v_cvt_pk_bf16_f32 v126, v65, v77
    v_cvt_pk_bf16_f32 v127, v89, v101
    v_cvt_pk_bf16_f32 v128, v10, v22
    v_cvt_pk_bf16_f32 v129, v34, v46
    v_cvt_pk_bf16_f32 v130, v58, v70
    v_cvt_pk_bf16_f32 v131, v82, v94
    v_cvt_pk_bf16_f32 v132, v14, v26
    v_cvt_pk_bf16_f32 v133, v38, v50
    v_cvt_pk_bf16_f32 v134, v62, v74
    v_cvt_pk_bf16_f32 v135, v86, v98
    v_cvt_pk_bf16_f32 v136, v18, v30
    v_cvt_pk_bf16_f32 v137, v42, v54
    v_cvt_pk_bf16_f32 v138, v66, v78
    v_cvt_pk_bf16_f32 v139, v90, v102
    v_cvt_pk_bf16_f32 v140, v11, v23
    v_cvt_pk_bf16_f32 v141, v35, v47
    v_cvt_pk_bf16_f32 v142, v59, v71
    v_cvt_pk_bf16_f32 v143, v83, v95
    v_cvt_pk_bf16_f32 v144, v15, v27
    v_cvt_pk_bf16_f32 v145, v39, v51
    v_cvt_pk_bf16_f32 v146, v63, v75
    v_cvt_pk_bf16_f32 v147, v87, v99
    v_cvt_pk_bf16_f32 v148, v19, v31
    v_cvt_pk_bf16_f32 v149, v43, v55
    v_cvt_pk_bf16_f32 v150, v67, v79
    v_cvt_pk_bf16_f32 v151, v91, v103
    v_permlane32_swap_b32 v104, v128
    v_permlane32_swap_b32 v105, v129
    v_permlane32_swap_b32 v106, v130
    v_permlane32_swap_b32 v107, v131
    v_permlane32_swap_b32 v116, v140
    v_permlane32_swap_b32 v117, v141
    v_permlane32_swap_b32 v118, v142
    v_permlane32_swap_b32 v119, v143
    v_permlane32_swap_b32 v108, v132
    v_permlane32_swap_b32 v109, v133
    v_permlane32_swap_b32 v110, v134
    v_permlane32_swap_b32 v111, v135
    v_permlane32_swap_b32 v120, v144
    v_permlane32_swap_b32 v121, v145
    v_permlane32_swap_b32 v122, v146
    v_permlane32_swap_b32 v123, v147
    v_permlane32_swap_b32 v112, v136
    v_permlane32_swap_b32 v113, v137
    v_permlane32_swap_b32 v114, v138
    v_permlane32_swap_b32 v115, v139
    v_permlane32_swap_b32 v124, v148
    v_permlane32_swap_b32 v125, v149
    v_permlane32_swap_b32 v126, v150
    v_permlane32_swap_b32 v127, v151
    v_permlane16_swap_b32 v104, v116
    v_permlane16_swap_b32 v105, v117
    v_permlane16_swap_b32 v106, v118
    v_permlane16_swap_b32 v107, v119
    v_permlane16_swap_b32 v128, v140
    v_permlane16_swap_b32 v129, v141
    v_permlane16_swap_b32 v130, v142
    v_permlane16_swap_b32 v131, v143
    v_permlane16_swap_b32 v108, v120
    v_permlane16_swap_b32 v109, v121
    v_permlane16_swap_b32 v110, v122
    v_permlane16_swap_b32 v111, v123
    v_permlane16_swap_b32 v132, v144
    v_permlane16_swap_b32 v133, v145
    v_permlane16_swap_b32 v134, v146
    v_permlane16_swap_b32 v135, v147
    v_permlane16_swap_b32 v112, v124
    v_permlane16_swap_b32 v113, v125
    v_permlane16_swap_b32 v114, v126
    v_permlane16_swap_b32 v115, v127
    v_permlane16_swap_b32 v136, v148
    v_permlane16_swap_b32 v137, v149
    v_permlane16_swap_b32 v138, v150
    v_permlane16_swap_b32 v139, v151
    v_mov_b32 v8, 0
    v_mov_b32 v9, 0
    v_mov_b32 v10, 0
    v_mov_b32 v11, 0
    v_mov_b32 v12, 0
    v_mov_b32 v13, 0
    v_mov_b32 v14, 0
    v_mov_b32 v15, 0
    v_mov_b32 v16, 0
    v_mov_b32 v17, 0
    v_mov_b32 v18, 0
    v_mov_b32 v19, 0
    v_mov_b32 v20, 0
    v_mov_b32 v21, 0
    v_mov_b32 v22, 0
    v_mov_b32 v23, 0
    v_mov_b32 v24, 0
    v_mov_b32 v25, 0
    v_mov_b32 v26, 0
    v_mov_b32 v27, 0
    v_mov_b32 v28, 0
    v_mov_b32 v29, 0
    v_mov_b32 v30, 0
    v_mov_b32 v31, 0
    v_mov_b32 v32, 0
    v_mov_b32 v33, 0
    v_mov_b32 v34, 0
    v_mov_b32 v35, 0
    v_mov_b32 v36, 0
    v_mov_b32 v37, 0
    v_mov_b32 v38, 0
    v_mov_b32 v39, 0
    v_mov_b32 v40, 0
    v_mov_b32 v41, 0
    v_mov_b32 v42, 0
    v_mov_b32 v43, 0
    v_mov_b32 v44, 0
    v_mov_b32 v45, 0
    v_mov_b32 v46, 0
    v_mov_b32 v47, 0
    v_mov_b32 v48, 0
    v_mov_b32 v49, 0
    v_mov_b32 v50, 0
    v_mov_b32 v51, 0
    v_mov_b32 v52, 0
    v_mov_b32 v53, 0
    v_mov_b32 v54, 0
    v_mov_b32 v55, 0
    v_mov_b32 v56, 0
    v_mov_b32 v57, 0
    v_mov_b32 v58, 0
    v_mov_b32 v59, 0
    v_mov_b32 v60, 0
    v_mov_b32 v61, 0
    v_mov_b32 v62, 0
    v_mov_b32 v63, 0
    v_mov_b32 v64, 0
    v_mov_b32 v65, 0
    v_mov_b32 v66, 0
    v_mov_b32 v67, 0
    v_mov_b32 v68, 0
    v_mov_b32 v69, 0
    v_mov_b32 v70, 0
    v_mov_b32 v71, 0
    v_mov_b32 v72, 0
    v_mov_b32 v73, 0
    v_mov_b32 v74, 0
    v_mov_b32 v75, 0
    v_mov_b32 v76, 0
    v_mov_b32 v77, 0
    v_mov_b32 v78, 0
    v_mov_b32 v79, 0
    v_mov_b32 v80, 0
    v_mov_b32 v81, 0
    v_mov_b32 v82, 0
    v_mov_b32 v83, 0
    v_mov_b32 v84, 0
    v_mov_b32 v85, 0
    v_mov_b32 v86, 0
    v_mov_b32 v87, 0
    v_mov_b32 v88, 0
    v_mov_b32 v89, 0
    v_mov_b32 v90, 0
    v_mov_b32 v91, 0
    v_mov_b32 v92, 0
    v_mov_b32 v93, 0
    v_mov_b32 v94, 0
    v_mov_b32 v95, 0
    v_mov_b32 v96, 0
    v_mov_b32 v97, 0
    v_mov_b32 v98, 0
    v_mov_b32 v99, 0
    v_mov_b32 v100, 0
    v_mov_b32 v101, 0
    v_mov_b32 v102, 0
    v_mov_b32 v103, 0
    v_mov_b32 v220, 0
    v_mov_b32 v221, 0
    v_mov_b32 v222, 0
    v_mov_b32 v223, 0
    v_mov_b32 v224, 0
    v_mov_b32 v225, 0
    v_mov_b32 v226, 0
    v_mov_b32 v227, 0
    v_mov_b32 v228, 0
    v_mov_b32 v229, 0
    v_mov_b32 v230, 0
    v_mov_b32 v231, 0
    v_mov_b32 v232, 0
    v_mov_b32 v233, 0
    v_mov_b32 v234, 0
    v_mov_b32 v235, 0
    v_mov_b32 v236, 0
    v_mov_b32 v237, 0
    v_mov_b32 v238, 0
    v_mov_b32 v239, 0
    v_mov_b32 v240, 0
    v_mov_b32 v241, 0
    v_mov_b32 v242, 0
    v_mov_b32 v243, 0
    v_mov_b32 v244, 0x3f803f80
    v_mov_b32 v245, 0x3f803f80
    v_mov_b32 v246, 0x3f803f80
    v_mov_b32 v247, 0x3f803f80
    s_mov_b32 s77, 0xff61b1e6
    s_mov_b32 s1, 0
    s_mov_b32 s7, 0x40004000
    v_add_u32 v2, 62464, v2
    v_add_u32 v3, 62464, v3
    s_lshl_b32 s70, s5, 19
    s_lshl_b32 s66, s6, 8
    s_add_u32 s70, s70, s66
    s_and_b32 s86, s4, 3
    s_lshr_b32 s82, s4, 2
    s_and_b32 s73, s4, 7
    s_mul_i32 s73, s73, 3072
    s_lshl_b32 s74, s2, 17
    s_lshr_b32 s65, s6, 1
    s_lshl_b32 s65, s65, 13
    s_add_u32 s74, s74, s65
    s_mul_i32 s89, s2, 3
    s_add_u32 s89, s89, s4
    s_and_b32 s89, s89, 7
    s_mul_i32 s76, s6, 8448
    s_add_u32 s76, s76, 28672
    s_and_b32 s65, s6, 1
    s_cmp_eq_u32 s65, 1
    s_cselect_b32 s12, s40, s38
    s_cselect_b32 s13, s41, s39
    s_mov_b32 s14, 0x2000000
    s_cselect_b64 vcc, -1, 0
    v_cndmask_b32 v4, v4, v6, vcc
    v_cndmask_b32 v5, v5, v6, vcc
    s_barrier
    s_call_b64 s[80:81], L_att
    s_waitcnt vmcnt(0)
    v_add_u32 v2, 33792, v2
    v_add_u32 v3, 33792, v3
    s_barrier
    ds_read_b128 v[152:155], v3 offset:0
    ds_read_b128 v[156:159], v3 offset:64
    ds_read_b128 v[160:163], v3 offset:128
    ds_read_b128 v[164:167], v3 offset:192
    s_add_u32 s64, s89, 3
    s_and_b32 s64, s64, 7
    s_lshl_b32 s64, s64, 14
    s_add_u32 s64, s64, s74
    s_add_u32 m0, s76, 33792
    s_nop 0
    buffer_load_dwordx4 v4, s[12:15], s64 offen offset:0 nt lds
    s_add_u32 m0, s76, 34592
    s_nop 0
    buffer_load_dwordx4 v4, s[12:15], s64 offen offset:256 nt lds
    s_add_u32 m0, s76, 35392
    s_nop 0
    buffer_load_dwordx4 v4, s[12:15], s64 offen offset:512 nt lds
    s_add_u32 m0, s76, 36192
    s_nop 0
    buffer_load_dwordx4 v4, s[12:15], s64 offen offset:768 nt lds
    s_add_u32 m0, s76, 36992
    s_nop 0
    buffer_load_dwordx4 v5, s[12:15], s64 offen offset:1024 nt lds
    s_add_u32 m0, s76, 37792
    s_nop 0
    buffer_load_dwordx4 v5, s[12:15], s64 offen offset:1280 nt lds
    s_add_u32 m0, s76, 38592
    s_nop 0
    buffer_load_dwordx4 v5, s[12:15], s64 offen offset:1536 nt lds
    s_add_u32 m0, s76, 39392
    s_nop 0
    buffer_load_dwordx4 v5, s[12:15], s64 offen offset:1792 nt lds
    s_call_b64 s[80:81], L_att1
    s_waitcnt vmcnt(8)
    v_add_u32 v2, -67584, v2
    v_add_u32 v3, -67584, v3
    s_barrier
    ds_read_b128 v[152:155], v3 offset:0
    ds_read_b128 v[156:159], v3 offset:64
    ds_read_b128 v[160:163], v3 offset:128
    ds_read_b128 v[164:167], v3 offset:192
    s_add_u32 s64, s89, 4
    s_and_b32 s64, s64, 7
    s_lshl_b32 s64, s64, 14
    s_add_u32 s64, s64, s74
    s_add_u32 m0, s76, 67584
    s_nop 0
    buffer_load_dwordx4 v4, s[12:15], s64 offen offset:0 nt lds
    s_add_u32 m0, s76, 68384
    s_nop 0
    buffer_load_dwordx4 v4, s[12:15], s64 offen offset:256 nt lds
    s_add_u32 m0, s76, 69184
    s_nop 0
    buffer_load_dwordx4 v4, s[12:15], s64 offen offset:512 nt lds
    s_add_u32 m0, s76, 69984
    s_nop 0
    buffer_load_dwordx4 v4, s[12:15], s64 offen offset:768 nt lds
    s_add_u32 m0, s76, 70784
    s_nop 0
    buffer_load_dwordx4 v5, s[12:15], s64 offen offset:1024 nt lds
    s_add_u32 m0, s76, 71584
    s_nop 0
    buffer_load_dwordx4 v5, s[12:15], s64 offen offset:1280 nt lds
    s_add_u32 m0, s76, 72384
    s_nop 0
    buffer_load_dwordx4 v5, s[12:15], s64 offen offset:1536 nt lds
    s_add_u32 m0, s76, 73184
    s_nop 0
    buffer_load_dwordx4 v5, s[12:15], s64 offen offset:1792 nt lds
    s_call_b64 s[80:81], L_att1
    s_waitcnt vmcnt(8)
    v_add_u32 v2, 33792, v2
    v_add_u32 v3, 33792, v3
    s_barrier
    ds_read_b128 v[152:155], v3 offset:0
    ds_read_b128 v[156:159], v3 offset:64
    ds_read_b128 v[160:163], v3 offset:128
    ds_read_b128 v[164:167], v3 offset:192
    s_add_u32 s64, s89, 5
    s_and_b32 s64, s64, 7
    s_lshl_b32 s64, s64, 14
    s_add_u32 s64, s64, s74
    s_add_u32 m0, s76, 0
    s_nop 0
    buffer_load_dwordx4 v4, s[12:15], s64 offen offset:0 nt lds
    s_add_u32 m0, s76, 800
    s_nop 0
    buffer_load_dwordx4 v4, s[12:15], s64 offen offset:256 nt lds
    s_add_u32 m0, s76, 1600
    s_nop 0
    buffer_load_dwordx4 v4, s[12:15], s64 offen offset:512 nt lds
    s_add_u32 m0, s76, 2400
    s_nop 0
    buffer_load_dwordx4 v4, s[12:15], s64 offen offset:768 nt lds
    s_add_u32 m0, s76, 3200
    s_nop 0
    buffer_load_dwordx4 v5, s[12:15], s64 offen offset:1024 nt lds
    s_add_u32 m0, s76, 4000
    s_nop 0
    buffer_load_dwordx4 v5, s[12:15], s64 offen offset:1280 nt lds
    s_add_u32 m0, s76, 4800
    s_nop 0
    buffer_load_dwordx4 v5, s[12:15], s64 offen offset:1536 nt lds
    s_add_u32 m0, s76, 5600
    s_nop 0
    buffer_load_dwordx4 v5, s[12:15], s64 offen offset:1792 nt lds
    s_call_b64 s[80:81], L_att1
    s_waitcnt vmcnt(8)
    v_add_u32 v2, 33792, v2
    v_add_u32 v3, 33792, v3
    s_barrier
    ds_read_b128 v[152:155], v3 offset:0
    ds_read_b128 v[156:159], v3 offset:64
    ds_read_b128 v[160:163], v3 offset:128
    ds_read_b128 v[164:167], v3 offset:192
    s_add_u32 s64, s89, 6
    s_and_b32 s64, s64, 7
    s_lshl_b32 s64, s64, 14
    s_add_u32 s64, s64, s74
    s_add_u32 m0, s76, 33792
    s_nop 0
    buffer_load_dwordx4 v4, s[12:15], s64 offen offset:0 nt lds
    s_add_u32 m0, s76, 34592
    s_nop 0
    buffer_load_dwordx4 v4, s[12:15], s64 offen offset:256 nt lds
    s_add_u32 m0, s76, 35392
    s_nop 0
    buffer_load_dwordx4 v4, s[12:15], s64 offen offset:512 nt lds
    s_add_u32 m0, s76, 36192
    s_nop 0
    buffer_load_dwordx4 v4, s[12:15], s64 offen offset:768 nt lds
    s_add_u32 m0, s76, 36992
    s_nop 0
    buffer_load_dwordx4 v5, s[12:15], s64 offen offset:1024 nt lds
    s_add_u32 m0, s76, 37792
    s_nop 0
    buffer_load_dwordx4 v5, s[12:15], s64 offen offset:1280 nt lds
    s_add_u32 m0, s76, 38592
    s_nop 0
    buffer_load_dwordx4 v5, s[12:15], s64 offen offset:1536 nt lds
    s_add_u32 m0, s76, 39392
    s_nop 0
    buffer_load_dwordx4 v5, s[12:15], s64 offen offset:1792 nt lds
    s_call_b64 s[80:81], L_att1
    s_waitcnt vmcnt(8)
    v_add_u32 v2, -67584, v2
    v_add_u32 v3, -67584, v3
    s_barrier
    ds_read_b128 v[152:155], v3 offset:0
    ds_read_b128 v[156:159], v3 offset:64
    ds_read_b128 v[160:163], v3 offset:128
    ds_read_b128 v[164:167], v3 offset:192
    s_add_u32 s64, s89, 7
    s_and_b32 s64, s64, 7
    s_lshl_b32 s64, s64, 14
    s_add_u32 s64, s64, s74
    s_add_u32 m0, s76, 67584
    s_nop 0
    buffer_load_dwordx4 v4, s[12:15], s64 offen offset:0 nt lds
    s_add_u32 m0, s76, 68384
    s_nop 0
    buffer_load_dwordx4 v4, s[12:15], s64 offen offset:256 nt lds
    s_add_u32 m0, s76, 69184
    s_nop 0
    buffer_load_dwordx4 v4, s[12:15], s64 offen offset:512 nt lds
    s_add_u32 m0, s76, 69984
    s_nop 0
    buffer_load_dwordx4 v4, s[12:15], s64 offen offset:768 nt lds
    s_add_u32 m0, s76, 70784
    s_nop 0
    buffer_load_dwordx4 v5, s[12:15], s64 offen offset:1024 nt lds
    s_add_u32 m0, s76, 71584
    s_nop 0
    buffer_load_dwordx4 v5, s[12:15], s64 offen offset:1280 nt lds
    s_add_u32 m0, s76, 72384
    s_nop 0
    buffer_load_dwordx4 v5, s[12:15], s64 offen offset:1536 nt lds
    s_add_u32 m0, s76, 73184
    s_nop 0
    buffer_load_dwordx4 v5, s[12:15], s64 offen offset:1792 nt lds
    s_call_b64 s[80:81], L_att1
    s_waitcnt vmcnt(8)
    v_add_u32 v2, 33792, v2
    v_add_u32 v3, 33792, v3
    s_barrier
    s_call_b64 s[80:81], L_att
    s_waitcnt vmcnt(0)
    v_add_u32 v2, 33792, v2
    v_add_u32 v3, 33792, v3
    s_barrier
    s_call_b64 s[80:81], L_att
    s_waitcnt vmcnt(0)
    s_barrier
    v_mov_b32 v2, v7
    s_mov_b32 s68, 0
    s_add_u32 s67, s68, 0
    s_lshr_b32 s65, s67, 2
    s_add_u32 s65, s65, s86
    s_and_b32 s65, s65, 3
    s_add_u32 s66, s67, s82
    s_and_b32 s66, s66, 3
    s_lshl_b32 s64, s65, 2
    s_add_u32 s64, s64, s66
    s_lshl_b32 s64, s64, 15
    s_add_u32 s64, s64, s70
    buffer_load_dwordx4 v[152:155], v2, s[24:27], s64 offen offset:0
    buffer_load_dwordx4 v[156:159], v2, s[24:27], s64 offen offset:1024
    buffer_load_dwordx4 v[160:163], v2, s[24:27], s64 offen offset:2048
    buffer_load_dwordx4 v[164:167], v2, s[24:27], s64 offen offset:3072
    s_add_u32 s64, s64, 16384
    buffer_load_dwordx4 v[168:171], v2, s[24:27], s64 offen offset:0
    buffer_load_dwordx4 v[172:175], v2, s[24:27], s64 offen offset:1024
    buffer_load_dwordx4 v[176:179], v2, s[24:27], s64 offen offset:2048
    buffer_load_dwordx4 v[180:183], v2, s[24:27], s64 offen offset:3072
    s_add_u32 s67, s68, 1
    s_lshr_b32 s65, s67, 2
    s_add_u32 s65, s65, s86
    s_and_b32 s65, s65, 3
    s_add_u32 s66, s67, s82
    s_and_b32 s66, s66, 3
    s_lshl_b32 s64, s65, 2
    s_add_u32 s64, s64, s66
    s_lshl_b32 s64, s64, 15
    s_add_u32 s64, s64, s70
    buffer_load_dwordx4 v[184:187], v2, s[24:27], s64 offen offset:0
    buffer_load_dwordx4 v[188:191], v2, s[24:27], s64 offen offset:1024
    buffer_load_dwordx4 v[192:195], v2, s[24:27], s64 offen offset:2048
    buffer_load_dwordx4 v[196:199], v2, s[24:27], s64 offen offset:3072
    s_add_u32 s64, s64, 16384
    buffer_load_dwordx4 v[200:203], v2, s[24:27], s64 offen offset:0
    buffer_load_dwordx4 v[204:207], v2, s[24:27], s64 offen offset:1024
    buffer_load_dwordx4 v[208:211], v2, s[24:27], s64 offen offset:2048
    buffer_load_dwordx4 v[212:215], v2, s[24:27], s64 offen offset:3072
    s_barrier
    s_nop 7
    v_rcp_f32 v232, v232
    v_rcp_f32 v233, v233
    v_rcp_f32 v236, v236
    v_rcp_f32 v237, v237
    v_rcp_f32 v240, v240
    v_rcp_f32 v241, v241
    v_pk_mul_f32 v[8:9], v[8:9], v[232:233]
    v_pk_mul_f32 v[10:11], v[10:11], v[232:233]
    v_pk_mul_f32 v[12:13], v[12:13], v[236:237]
    v_pk_mul_f32 v[14:15], v[14:15], v[236:237]
    v_pk_mul_f32 v[16:17], v[16:17], v[240:241]
    v_pk_mul_f32 v[18:19], v[18:19], v[240:241]
    v_pk_mul_f32 v[20:21], v[20:21], v[232:233]
    v_pk_mul_f32 v[22:23], v[22:23], v[232:233]
    v_pk_mul_f32 v[24:25], v[24:25], v[236:237]
    v_pk_mul_f32 v[26:27], v[26:27], v[236:237]
    v_pk_mul_f32 v[28:29], v[28:29], v[240:241]
    v_pk_mul_f32 v[30:31], v[30:31], v[240:241]
    v_pk_mul_f32 v[32:33], v[32:33], v[232:233]
    v_pk_mul_f32 v[34:35], v[34:35], v[232:233]
    v_pk_mul_f32 v[36:37], v[36:37], v[236:237]
    v_pk_mul_f32 v[38:39], v[38:39], v[236:237]
    v_pk_mul_f32 v[40:41], v[40:41], v[240:241]
    v_pk_mul_f32 v[42:43], v[42:43], v[240:241]
    v_pk_mul_f32 v[44:45], v[44:45], v[232:233]
    v_pk_mul_f32 v[46:47], v[46:47], v[232:233]
    v_pk_mul_f32 v[48:49], v[48:49], v[236:237]
    v_pk_mul_f32 v[50:51], v[50:51], v[236:237]
    v_pk_mul_f32 v[52:53], v[52:53], v[240:241]
    v_pk_mul_f32 v[54:55], v[54:55], v[240:241]
    v_pk_mul_f32 v[56:57], v[56:57], v[232:233]
    v_pk_mul_f32 v[58:59], v[58:59], v[232:233]
    v_pk_mul_f32 v[60:61], v[60:61], v[236:237]
    v_pk_mul_f32 v[62:63], v[62:63], v[236:237]
    v_pk_mul_f32 v[64:65], v[64:65], v[240:241]
    v_pk_mul_f32 v[66:67], v[66:67], v[240:241]
    v_pk_mul_f32 v[68:69], v[68:69], v[232:233]
    v_pk_mul_f32 v[70:71], v[70:71], v[232:233]
    v_pk_mul_f32 v[72:73], v[72:73], v[236:237]
    v_pk_mul_f32 v[74:75], v[74:75], v[236:237]
    v_pk_mul_f32 v[76:77], v[76:77], v[240:241]
    v_pk_mul_f32 v[78:79], v[78:79], v[240:241]
    v_pk_mul_f32 v[80:81], v[80:81], v[232:233]
    v_pk_mul_f32 v[82:83], v[82:83], v[232:233]
    v_pk_mul_f32 v[84:85], v[84:85], v[236:237]
    v_pk_mul_f32 v[86:87], v[86:87], v[236:237]
    v_pk_mul_f32 v[88:89], v[88:89], v[240:241]
    v_pk_mul_f32 v[90:91], v[90:91], v[240:241]
    v_pk_mul_f32 v[92:93], v[92:93], v[232:233]
    v_pk_mul_f32 v[94:95], v[94:95], v[232:233]
    v_pk_mul_f32 v[96:97], v[96:97], v[236:237]
    v_pk_mul_f32 v[98:99], v[98:99], v[236:237]
    v_pk_mul_f32 v[100:101], v[100:101], v[240:241]
    v_pk_mul_f32 v[102:103], v[102:103], v[240:241]
    v_cvt_pk_bf16_f32 v104, v8, v9
    v_cvt_pk_bf16_f32 v105, v10, v11
    v_cvt_pk_bf16_f32 v106, v20, v21
    v_cvt_pk_bf16_f32 v107, v22, v23
    v_cvt_pk_bf16_f32 v108, v12, v13
    v_cvt_pk_bf16_f32 v109, v14, v15
    v_cvt_pk_bf16_f32 v110, v24, v25
    v_cvt_pk_bf16_f32 v111, v26, v27
    v_cvt_pk_bf16_f32 v112, v16, v17
    v_cvt_pk_bf16_f32 v113, v18, v19
    v_cvt_pk_bf16_f32 v114, v28, v29
    v_cvt_pk_bf16_f32 v115, v30, v31
    v_cvt_pk_bf16_f32 v116, v32, v33
    v_cvt_pk_bf16_f32 v117, v34, v35
    v_cvt_pk_bf16_f32 v118, v44, v45
    v_cvt_pk_bf16_f32 v119, v46, v47
    v_cvt_pk_bf16_f32 v120, v36, v37
    v_cvt_pk_bf16_f32 v121, v38, v39
    v_cvt_pk_bf16_f32 v122, v48, v49
    v_cvt_pk_bf16_f32 v123, v50, v51
    v_cvt_pk_bf16_f32 v124, v40, v41
    v_cvt_pk_bf16_f32 v125, v42, v43
    v_cvt_pk_bf16_f32 v126, v52, v53
    v_cvt_pk_bf16_f32 v127, v54, v55
    v_cvt_pk_bf16_f32 v128, v56, v57
    v_cvt_pk_bf16_f32 v129, v58, v59
    v_cvt_pk_bf16_f32 v130, v68, v69
    v_cvt_pk_bf16_f32 v131, v70, v71
    v_cvt_pk_bf16_f32 v132, v60, v61
    v_cvt_pk_bf16_f32 v133, v62, v63
    v_cvt_pk_bf16_f32 v134, v72, v73
    v_cvt_pk_bf16_f32 v135, v74, v75
    v_cvt_pk_bf16_f32 v136, v64, v65
    v_cvt_pk_bf16_f32 v137, v66, v67
    v_cvt_pk_bf16_f32 v138, v76, v77
    v_cvt_pk_bf16_f32 v139, v78, v79
    v_cvt_pk_bf16_f32 v140, v80, v81
    v_cvt_pk_bf16_f32 v141, v82, v83
    v_cvt_pk_bf16_f32 v142, v92, v93
    v_cvt_pk_bf16_f32 v143, v94, v95
    v_cvt_pk_bf16_f32 v144, v84, v85
    v_cvt_pk_bf16_f32 v145, v86, v87
    v_cvt_pk_bf16_f32 v146, v96, v97
    v_cvt_pk_bf16_f32 v147, v98, v99
    v_cvt_pk_bf16_f32 v148, v88, v89
    v_cvt_pk_bf16_f32 v149, v90, v91
    v_cvt_pk_bf16_f32 v150, v100, v101
    v_cvt_pk_bf16_f32 v151, v102, v103
    s_barrier
    s_add_u32 s67, s68, 0
    s_lshr_b32 s65, s67, 2
    s_add_u32 s65, s65, s86
    s_and_b32 s65, s65, 3
    s_add_u32 s66, s67, s82
    s_and_b32 s66, s66, 3
    s_mov_b32 s87, 24576
    s_call_b64 s[80:81], L_jit
    s_barrier
    v_mov_b32 v8, 0
    v_mov_b32 v9, 0
    v_mov_b32 v10, 0
    v_mov_b32 v11, 0
    v_mov_b32 v12, 0
    v_mov_b32 v13, 0
    v_mov_b32 v14, 0
    v_mov_b32 v15, 0
    v_mov_b32 v16, 0
    v_mov_b32 v17, 0
    v_mov_b32 v18, 0
    v_mov_b32 v19, 0
    v_mov_b32 v20, 0
    v_mov_b32 v21, 0
    v_mov_b32 v22, 0
    v_mov_b32 v23, 0
    v_mov_b32 v24, 0
    v_mov_b32 v25, 0
    v_mov_b32 v26, 0
    v_mov_b32 v27, 0
    v_mov_b32 v28, 0
    v_mov_b32 v29, 0
    v_mov_b32 v30, 0
    v_mov_b32 v31, 0
    v_mov_b32 v32, 0
    v_mov_b32 v33, 0
    v_mov_b32 v34, 0
    v_mov_b32 v35, 0
    v_mov_b32 v36, 0
    v_mov_b32 v37, 0
    v_mov_b32 v38, 0
    v_mov_b32 v39, 0
    v_mov_b32 v40, 0
    v_mov_b32 v41, 0
    v_mov_b32 v42, 0
    v_mov_b32 v43, 0
    v_mov_b32 v44, 0
    v_mov_b32 v45, 0
    v_mov_b32 v46, 0
    v_mov_b32 v47, 0
    v_mov_b32 v48, 0
    v_mov_b32 v49, 0
    v_mov_b32 v50, 0
    v_mov_b32 v51, 0
    v_mov_b32 v52, 0
    v_mov_b32 v53, 0
    v_mov_b32 v54, 0
    v_mov_b32 v55, 0
    v_mov_b32 v56, 0
    v_mov_b32 v57, 0
    v_mov_b32 v58, 0
    v_mov_b32 v59, 0
    v_mov_b32 v60, 0
    v_mov_b32 v61, 0
    v_mov_b32 v62, 0
    v_mov_b32 v63, 0
    v_mov_b32 v64, 0
    v_mov_b32 v65, 0
    v_mov_b32 v66, 0
    v_mov_b32 v67, 0
    v_mov_b32 v68, 0
    v_mov_b32 v69, 0
    v_mov_b32 v70, 0
    v_mov_b32 v71, 0
    v_mov_b32 v72, 0
    v_mov_b32 v73, 0
    v_mov_b32 v74, 0
    v_mov_b32 v75, 0
    v_mov_b32 v76, 0
    v_mov_b32 v77, 0
    v_mov_b32 v78, 0
    v_mov_b32 v79, 0
    v_mov_b32 v80, 0
    v_mov_b32 v81, 0
    v_mov_b32 v82, 0
    v_mov_b32 v83, 0
    v_mov_b32 v84, 0
    v_mov_b32 v85, 0
    v_mov_b32 v86, 0
    v_mov_b32 v87, 0
    v_mov_b32 v88, 0
    v_mov_b32 v89, 0
    v_mov_b32 v90, 0
    v_mov_b32 v91, 0
    v_mov_b32 v92, 0
    v_mov_b32 v93, 0
    v_mov_b32 v94, 0
    v_mov_b32 v95, 0
    v_mov_b32 v96, 0
    v_mov_b32 v97, 0
    v_mov_b32 v98, 0
    v_mov_b32 v99, 0
    v_mov_b32 v100, 0
    v_mov_b32 v101, 0
    v_mov_b32 v102, 0
    v_mov_b32 v103, 0
    s_waitcnt vmcnt(0)
    v_perm_b32 v216, v156, v152, s0
    v_perm_b32 v217, v164, v160, s0
    v_perm_b32 v218, v172, v168, s0
    v_perm_b32 v219, v180, v176, s0
    v_perm_b32 v220, v156, v152, s61
    v_perm_b32 v221, v164, v160, s61
    v_perm_b32 v222, v172, v168, s61
    v_perm_b32 v223, v180, v176, s61
    v_perm_b32 v224, v157, v153, s0
    v_perm_b32 v225, v165, v161, s0
    v_perm_b32 v226, v173, v169, s0
    v_perm_b32 v227, v181, v177, s0
    v_perm_b32 v228, v157, v153, s61
    v_perm_b32 v229, v165, v161, s61
    v_perm_b32 v230, v173, v169, s61
    v_perm_b32 v231, v181, v177, s61
    v_perm_b32 v232, v158, v154, s0
    v_perm_b32 v233, v166, v162, s0
    v_perm_b32 v234, v174, v170, s0
    v_perm_b32 v235, v182, v178, s0
    v_perm_b32 v236, v158, v154, s61
    v_perm_b32 v237, v166, v162, s61
    v_perm_b32 v238, v174, v170, s61
    v_perm_b32 v239, v182, v178, s61
    v_perm_b32 v240, v159, v155, s0
    v_perm_b32 v241, v167, v163, s0
    v_perm_b32 v242, v175, v171, s0
    v_perm_b32 v243, v183, v179, s0
    v_perm_b32 v244, v159, v155, s61
    v_perm_b32 v245, v167, v163, s61
    v_perm_b32 v246, v175, v171, s61
    v_perm_b32 v247, v183, v179, s61
L_A_o:
    s_barrier
    v_add_u32 v3, 24576, v1
    s_cmp_eq_u32 s68, 14
    s_cselect_b32 s73, 154624, s73
    s_add_u32 s67, s68, 1
    s_lshr_b32 s65, s67, 2
    s_add_u32 s65, s65, s86
    s_and_b32 s65, s65, 3
    s_add_u32 s66, s67, s82
    s_and_b32 s66, s66, 3
    s_mov_b32 s87, s73
    s_call_b64 s[80:81], L_jit
    ds_read_b128 v[248:251], v3 offset:0
    ds_read_b128 v[252:255], v3 offset:1024
    ds_read_b128 v[4:7], v3 offset:2048
    s_waitcnt lgkmcnt(0)
    v_mfma_f32_16x16x32_bf16 v[8:11], v[216:219], v[248:251], v[8:11]
    v_mfma_f32_16x16x32_bf16 v[12:15], v[216:219], v[252:255], v[12:15]
    v_mfma_f32_16x16x32_bf16 v[16:19], v[216:219], v[4:7], v[16:19]
    v_mfma_f32_16x16x32_bf16 v[20:23], v[220:223], v[248:251], v[20:23]
    v_mfma_f32_16x16x32_bf16 v[24:27], v[220:223], v[252:255], v[24:27]
    v_mfma_f32_16x16x32_bf16 v[28:31], v[220:223], v[4:7], v[28:31]
    v_mfma_f32_16x16x32_bf16 v[32:35], v[224:227], v[248:251], v[32:35]
    v_mfma_f32_16x16x32_bf16 v[36:39], v[224:227], v[252:255], v[36:39]
    v_mfma_f32_16x16x32_bf16 v[40:43], v[224:227], v[4:7], v[40:43]
    v_mfma_f32_16x16x32_bf16 v[44:47], v[228:231], v[248:251], v[44:47]
    v_mfma_f32_16x16x32_bf16 v[48:51], v[228:231], v[252:255], v[48:51]
    v_mfma_f32_16x16x32_bf16 v[52:55], v[228:231], v[4:7], v[52:55]
    v_mfma_f32_16x16x32_bf16 v[56:59], v[232:235], v[248:251], v[56:59]
    v_mfma_f32_16x16x32_bf16 v[60:63], v[232:235], v[252:255], v[60:63]
    v_mfma_f32_16x16x32_bf16 v[64:67], v[232:235], v[4:7], v[64:67]
    v_mfma_f32_16x16x32_bf16 v[68:71], v[236:239], v[248:251], v[68:71]
    v_mfma_f32_16x16x32_bf16 v[72:75], v[236:239], v[252:255], v[72:75]
    v_mfma_f32_16x16x32_bf16 v[76:79], v[236:239], v[4:7], v[76:79]
    v_mfma_f32_16x16x32_bf16 v[80:83], v[240:243], v[248:251], v[80:83]
    v_mfma_f32_16x16x32_bf16 v[84:87], v[240:243], v[252:255], v[84:87]
    v_mfma_f32_16x16x32_bf16 v[88:91], v[240:243], v[4:7], v[88:91]
    v_mfma_f32_16x16x32_bf16 v[92:95], v[244:247], v[248:251], v[92:95]
    v_mfma_f32_16x16x32_bf16 v[96:99], v[244:247], v[252:255], v[96:99]
    v_mfma_f32_16x16x32_bf16 v[100:103], v[244:247], v[4:7], v[100:103]
    s_cmp_eq_u32 s68, 14
    s_cbranch_scc1 L_c_27
    s_add_u32 s67, s68, 2
    s_lshr_b32 s65, s67, 2
    s_add_u32 s65, s65, s86
    s_and_b32 s65, s65, 3
    s_add_u32 s66, s67, s82
    s_and_b32 s66, s66, 3
    s_lshl_b32 s64, s65, 2
    s_add_u32 s64, s64, s66
    s_lshl_b32 s64, s64, 15
    s_add_u32 s64, s64, s70
    buffer_load_dwordx4 v[152:155], v2, s[24:27], s64 offen offset:0
    buffer_load_dwordx4 v[156:159], v2, s[24:27], s64 offen offset:1024
    buffer_load_dwordx4 v[160:163], v2, s[24:27], s64 offen offset:2048
    buffer_load_dwordx4 v[164:167], v2, s[24:27], s64 offen offset:3072
    s_add_u32 s64, s64, 16384
    buffer_load_dwordx4 v[168:171], v2, s[24:27], s64 offen offset:0
    buffer_load_dwordx4 v[172:175], v2, s[24:27], s64 offen offset:1024
    buffer_load_dwordx4 v[176:179], v2, s[24:27], s64 offen offset:2048
    buffer_load_dwordx4 v[180:183], v2, s[24:27], s64 offen offset:3072
L_c_27:
    s_barrier
    s_cmp_eq_u32 s68, 14
    s_cbranch_scc0 L_c_28
    s_waitcnt vmcnt(0)
L_c_28:
    s_waitcnt vmcnt(8)
    v_perm_b32 v216, v188, v184, s0
    v_perm_b32 v217, v196, v192, s0
    v_perm_b32 v218, v204, v200, s0
    v_perm_b32 v219, v212, v208, s0
    v_perm_b32 v220, v188, v184, s61
    v_perm_b32 v221, v196, v192, s61
    v_perm_b32 v222, v204, v200, s61
    v_perm_b32 v223, v212, v208, s61
    v_perm_b32 v224, v189, v185, s0
    v_perm_b32 v225, v197, v193, s0
    v_perm_b32 v226, v205, v201, s0
    v_perm_b32 v227, v213, v209, s0
    v_perm_b32 v228, v189, v185, s61
    v_perm_b32 v229, v197, v193, s61
    v_perm_b32 v230, v205, v201, s61
    v_perm_b32 v231, v213, v209, s61
    v_perm_b32 v232, v190, v186, s0
    v_perm_b32 v233, v198, v194, s0
    v_perm_b32 v234, v206, v202, s0
    v_perm_b32 v235, v214, v210, s0
    v_perm_b32 v236, v190, v186, s61
    v_perm_b32 v237, v198, v194, s61
    v_perm_b32 v238, v206, v202, s61
    v_perm_b32 v239, v214, v210, s61
    v_perm_b32 v240, v191, v187, s0
    v_perm_b32 v241, v199, v195, s0
    v_perm_b32 v242, v207, v203, s0
    v_perm_b32 v243, v215, v211, s0
    v_perm_b32 v244, v191, v187, s61
    v_perm_b32 v245, v199, v195, s61
    v_perm_b32 v246, v207, v203, s61
    v_perm_b32 v247, v215, v211, s61
    s_barrier
    v_add_u32 v3, s73, v1
    s_cmp_eq_u32 s68, 14
    s_cbranch_scc1 L_c_29
    s_add_u32 s67, s68, 2
    s_lshr_b32 s65, s67, 2
    s_add_u32 s65, s65, s86
    s_and_b32 s65, s65, 3
    s_add_u32 s66, s67, s82
    s_and_b32 s66, s66, 3
    s_mov_b32 s87, 24576
    s_call_b64 s[80:81], L_jit
L_c_29:
    ds_read_b128 v[248:251], v3 offset:0
    ds_read_b128 v[252:255], v3 offset:1024
    ds_read_b128 v[4:7], v3 offset:2048
    s_waitcnt lgkmcnt(0)
    v_mfma_f32_16x16x32_bf16 v[8:11], v[216:219], v[248:251], v[8:11]
    v_mfma_f32_16x16x32_bf16 v[12:15], v[216:219], v[252:255], v[12:15]
    v_mfma_f32_16x16x32_bf16 v[16:19], v[216:219], v[4:7], v[16:19]
    v_mfma_f32_16x16x32_bf16 v[20:23], v[220:223], v[248:251], v[20:23]
    v_mfma_f32_16x16x32_bf16 v[24:27], v[220:223], v[252:255], v[24:27]
    v_mfma_f32_16x16x32_bf16 v[28:31], v[220:223], v[4:7], v[28:31]
    v_mfma_f32_16x16x32_bf16 v[32:35], v[224:227], v[248:251], v[32:35]
    v_mfma_f32_16x16x32_bf16 v[36:39], v[224:227], v[252:255], v[36:39]
    v_mfma_f32_16x16x32_bf16 v[40:43], v[224:227], v[4:7], v[40:43]
    v_mfma_f32_16x16x32_bf16 v[44:47], v[228:231], v[248:251], v[44:47]
    v_mfma_f32_16x16x32_bf16 v[48:51], v[228:231], v[252:255], v[48:51]
    v_mfma_f32_16x16x32_bf16 v[52:55], v[228:231], v[4:7], v[52:55]
    v_mfma_f32_16x16x32_bf16 v[56:59], v[232:235], v[248:251], v[56:59]
    v_mfma_f32_16x16x32_bf16 v[60:63], v[232:235], v[252:255], v[60:63]
    v_mfma_f32_16x16x32_bf16 v[64:67], v[232:235], v[4:7], v[64:67]
    v_mfma_f32_16x16x32_bf16 v[68:71], v[236:239], v[248:251], v[68:71]
    v_mfma_f32_16x16x32_bf16 v[72:75], v[236:239], v[252:255], v[72:75]
    v_mfma_f32_16x16x32_bf16 v[76:79], v[236:239], v[4:7], v[76:79]
    v_mfma_f32_16x16x32_bf16 v[80:83], v[240:243], v[248:251], v[80:83]
    v_mfma_f32_16x16x32_bf16 v[84:87], v[240:243], v[252:255], v[84:87]
    v_mfma_f32_16x16x32_bf16 v[88:91], v[240:243], v[4:7], v[88:91]
    v_mfma_f32_16x16x32_bf16 v[92:95], v[244:247], v[248:251], v[92:95]
    v_mfma_f32_16x16x32_bf16 v[96:99], v[244:247], v[252:255], v[96:99]
    v_mfma_f32_16x16x32_bf16 v[100:103], v[244:247], v[4:7], v[100:103]
    s_cmp_eq_u32 s68, 14
    s_cbranch_scc1 L_c_30
    s_add_u32 s67, s68, 3
    s_lshr_b32 s65, s67, 2
    s_add_u32 s65, s65, s86
    s_and_b32 s65, s65, 3
    s_add_u32 s66, s67, s82
    s_and_b32 s66, s66, 3
    s_lshl_b32 s64, s65, 2
    s_add_u32 s64, s64, s66
    s_lshl_b32 s64, s64, 15
    s_add_u32 s64, s64, s70
    buffer_load_dwordx4 v[184:187], v2, s[24:27], s64 offen offset:0
    buffer_load_dwordx4 v[188:191], v2, s[24:27], s64 offen offset:1024
    buffer_load_dwordx4 v[192:195], v2, s[24:27], s64 offen offset:2048
    buffer_load_dwordx4 v[196:199], v2, s[24:27], s64 offen offset:3072
    s_add_u32 s64, s64, 16384
    buffer_load_dwordx4 v[200:203], v2, s[24:27], s64 offen offset:0
    buffer_load_dwordx4 v[204:207], v2, s[24:27], s64 offen offset:1024
    buffer_load_dwordx4 v[208:211], v2, s[24:27], s64 offen offset:2048
    buffer_load_dwordx4 v[212:215], v2, s[24:27], s64 offen offset:3072
L_c_30:
    s_barrier
    s_waitcnt vmcnt(8)
    s_cmp_eq_u32 s68, 14
    s_cbranch_scc1 L_c_31
    v_perm_b32 v216, v156, v152, s0
    v_perm_b32 v217, v164, v160, s0
    v_perm_b32 v218, v172, v168, s0
    v_perm_b32 v219, v180, v176, s0
    v_perm_b32 v220, v156, v152, s61
    v_perm_b32 v221, v164, v160, s61
    v_perm_b32 v222, v172, v168, s61
    v_perm_b32 v223, v180, v176, s61
    v_perm_b32 v224, v157, v153, s0
    v_perm_b32 v225, v165, v161, s0
    v_perm_b32 v226, v173, v169, s0
    v_perm_b32 v227, v181, v177, s0
    v_perm_b32 v228, v157, v153, s61
    v_perm_b32 v229, v165, v161, s61
    v_perm_b32 v230, v173, v169, s61
    v_perm_b32 v231, v181, v177, s61
    v_perm_b32 v232, v158, v154, s0
    v_perm_b32 v233, v166, v162, s0
    v_perm_b32 v234, v174, v170, s0
    v_perm_b32 v235, v182, v178, s0
    v_perm_b32 v236, v158, v154, s61
    v_perm_b32 v237, v166, v162, s61
    v_perm_b32 v238, v174, v170, s61
    v_perm_b32 v239, v182, v178, s61
    v_perm_b32 v240, v159, v155, s0
    v_perm_b32 v241, v167, v163, s0
    v_perm_b32 v242, v175, v171, s0
    v_perm_b32 v243, v183, v179, s0
    v_perm_b32 v244, v159, v155, s61
    v_perm_b32 v245, v167, v163, s61
    v_perm_b32 v246, v175, v171, s61
    v_perm_b32 v247, v183, v179, s61
L_c_31:
    s_add_u32 s68, s68, 2
    s_cmp_lt_u32 s68, 16
    s_cbranch_scc1 L_A_o
    v_lshrrev_b32 v0, 4, v1
    s_nop 7
    s_add_u32 s65, s4, 0
    s_lshl_b32 s65, s65, 2
    s_add_u32 s65, s65, s6
    s_mul_i32 s65, s65, 98304
    s_lshl_b32 s66, s5, 10
    s_add_u32 s65, s65, s66
    v_cvt_pk_bf16_f32 v104, v8, v20
    v_cvt_pk_bf16_f32 v105, v32, v44
    v_cvt_pk_bf16_f32 v106, v56, v68
    v_cvt_pk_bf16_f32 v107, v80, v92
    v_cvt_pk_bf16_f32 v108, v12, v24
    v_cvt_pk_bf16_f32 v109, v36, v48
    v_cvt_pk_bf16_f32 v110, v60, v72
    v_cvt_pk_bf16_f32 v111, v84, v96
    v_cvt_pk_bf16_f32 v112, v16, v28
    v_cvt_pk_bf16_f32 v113, v40, v52
    v_cvt_pk_bf16_f32 v114, v64, v76
    v_cvt_pk_bf16_f32 v115, v88, v100
    v_cvt_pk_bf16_f32 v116, v9, v21
    v_cvt_pk_bf16_f32 v117, v33, v45
    v_cvt_pk_bf16_f32 v118, v57, v69
    v_cvt_pk_bf16_f32 v119, v81, v93
    v_cvt_pk_bf16_f32 v120, v13, v25
    v_cvt_pk_bf16_f32 v121, v37, v49
    v_cvt_pk_bf16_f32 v122, v61, v73
    v_cvt_pk_bf16_f32 v123, v85, v97
    v_cvt_pk_bf16_f32 v124, v17, v29
    v_cvt_pk_bf16_f32 v125, v41, v53
    v_cvt_pk_bf16_f32 v126, v65, v77
    v_cvt_pk_bf16_f32 v127, v89, v101
    v_cvt_pk_bf16_f32 v128, v10, v22
    v_cvt_pk_bf16_f32 v129, v34, v46
    v_cvt_pk_bf16_f32 v130, v58, v70
    v_cvt_pk_bf16_f32 v131, v82, v94
    v_cvt_pk_bf16_f32 v132, v14, v26
    v_cvt_pk_bf16_f32 v133, v38, v50
    v_cvt_pk_bf16_f32 v134, v62, v74
    v_cvt_pk_bf16_f32 v135, v86, v98
    v_cvt_pk_bf16_f32 v136, v18, v30
    v_cvt_pk_bf16_f32 v137, v42, v54
    v_cvt_pk_bf16_f32 v138, v66, v78
    v_cvt_pk_bf16_f32 v139, v90, v102
    v_cvt_pk_bf16_f32 v140, v11, v23
    v_cvt_pk_bf16_f32 v141, v35, v47
    v_cvt_pk_bf16_f32 v142, v59, v71
    v_cvt_pk_bf16_f32 v143, v83, v95
    v_cvt_pk_bf16_f32 v144, v15, v27
    v_cvt_pk_bf16_f32 v145, v39, v51
    v_cvt_pk_bf16_f32 v146, v63, v75
    v_cvt_pk_bf16_f32 v147, v87, v99
    v_cvt_pk_bf16_f32 v148, v19, v31
    v_cvt_pk_bf16_f32 v149, v43, v55
    v_cvt_pk_bf16_f32 v150, v67, v79
    v_cvt_pk_bf16_f32 v151, v91, v103
    v_permlane32_swap_b32 v104, v128
    v_permlane32_swap_b32 v105, v129
    v_permlane32_swap_b32 v106, v130
    v_permlane32_swap_b32 v107, v131
    v_permlane32_swap_b32 v116, v140
    v_permlane32_swap_b32 v117, v141
    v_permlane32_swap_b32 v118, v142
    v_permlane32_swap_b32 v119, v143
    v_permlane32_swap_b32 v108, v132
    v_permlane32_swap_b32 v109, v133
    v_permlane32_swap_b32 v110, v134
    v_permlane32_swap_b32 v111, v135
    v_permlane32_swap_b32 v120, v144
    v_permlane32_swap_b32 v121, v145
    v_permlane32_swap_b32 v122, v146
    v_permlane32_swap_b32 v123, v147
    v_permlane32_swap_b32 v112, v136
    v_permlane32_swap_b32 v113, v137
    v_permlane32_swap_b32 v114, v138
    v_permlane32_swap_b32 v115, v139
    v_permlane32_swap_b32 v124, v148
    v_permlane32_swap_b32 v125, v149
    v_permlane32_swap_b32 v126, v150
    v_permlane32_swap_b32 v127, v151
    v_permlane16_swap_b32 v104, v116
    v_permlane16_swap_b32 v105, v117
    v_permlane16_swap_b32 v106, v118
    v_permlane16_swap_b32 v107, v119
    v_permlane16_swap_b32 v128, v140
    v_permlane16_swap_b32 v129, v141
    v_permlane16_swap_b32 v130, v142
    v_permlane16_swap_b32 v131, v143
    v_permlane16_swap_b32 v108, v120
    v_permlane16_swap_b32 v109, v121
    v_permlane16_swap_b32 v110, v122
    v_permlane16_swap_b32 v111, v123
    v_permlane16_swap_b32 v132, v144
    v_permlane16_swap_b32 v133, v145
    v_permlane16_swap_b32 v134, v146
    v_permlane16_swap_b32 v135, v147
    v_permlane16_swap_b32 v112, v124
    v_permlane16_swap_b32 v113, v125
    v_permlane16_swap_b32 v114, v126
    v_permlane16_swap_b32 v115, v127
    v_permlane16_swap_b32 v136, v148
    v_permlane16_swap_b32 v137, v149
    v_permlane16_swap_b32 v138, v150
    v_permlane16_swap_b32 v139, v151
    s_lshr_b32 s66, s5, 1
    s_and_b32 s63, s5, 1
    s_cmp_eq_u32 s66, s6
    s_cselect_b32 s63, s63, 2
    s_cmp_eq_u32 s63, 0
    s_cbranch_scc1 L_c_32
    s_add_u32 s66, s65, 0
    buffer_store_dwordx4 v[104:107], v1, s[28:31], s66 offen sc1
    s_add_u32 s66, s65, 8192
    buffer_store_dwordx4 v[108:111], v1, s[28:31], s66 offen sc1
    s_add_u32 s66, s65, 16384
    buffer_store_dwordx4 v[112:115], v1, s[28:31], s66 offen sc1
    s_add_u32 s66, s65, 24576
    buffer_store_dwordx4 v[116:119], v1, s[28:31], s66 offen sc1
    s_add_u32 s66, s65, 32768
    buffer_store_dwordx4 v[120:123], v1, s[28:31], s66 offen sc1
    s_add_u32 s66, s65, 40960
    buffer_store_dwordx4 v[124:127], v1, s[28:31], s66 offen sc1
L_c_32:
    s_cmp_eq_u32 s63, 1
    s_cbranch_scc1 L_c_33
    s_add_u32 s66, s65, 49152
    buffer_store_dwordx4 v[128:131], v1, s[28:31], s66 offen sc1
    s_add_u32 s66, s65, 57344
    buffer_store_dwordx4 v[132:135], v1, s[28:31], s66 offen sc1
    s_add_u32 s66, s65, 65536
    buffer_store_dwordx4 v[136:139], v1, s[28:31], s66 offen sc1
    s_add_u32 s66, s65, 73728
    buffer_store_dwordx4 v[140:143], v1, s[28:31], s66 offen sc1
    s_add_u32 s66, s65, 81920
    buffer_store_dwordx4 v[144:147], v1, s[28:31], s66 offen sc1
    s_add_u32 s66, s65, 90112
    buffer_store_dwordx4 v[148:151], v1, s[28:31], s66 offen sc1
L_c_33:
    s_barrier
    s_cmp_eq_u32 s63, 0
    s_cbranch_scc0 L_c_34
    v_add_u32 v250, 130048, v1
    ds_write_b128 v250, v[104:107] offset:0
    ds_write_b128 v250, v[108:111] offset:1024
    ds_write_b128 v250, v[112:115] offset:2048
    ds_write_b128 v250, v[116:119] offset:3072
    ds_write_b128 v250, v[120:123] offset:4096
    ds_write_b128 v250, v[124:127] offset:5120
L_c_34:
    s_cmp_eq_u32 s63, 1
    s_cbranch_scc0 L_c_35
    v_add_u32 v250, 130048, v1
    ds_write_b128 v250, v[128:131] offset:0
    ds_write_b128 v250, v[132:135] offset:1024
    ds_write_b128 v250, v[136:139] offset:2048
    ds_write_b128 v250, v[140:143] offset:3072
    ds_write_b128 v250, v[144:147] offset:4096
    ds_write_b128 v250, v[148:151] offset:5120
L_c_35:
    v_mov_b32 v248, 163808
    v_mov_b32 v249, 1
    v_lshlrev_b32 v252, 7, v0
    s_lshl_b32 s64, s4, 10
    s_add_u32 s64, s64, 0x3000000
    s_lshl_b32 s66, s2, 7
    s_add_u32 s66, s66, 0x3000000
    s_mov_b64 exec, 1
    ds_read_b32 v253, v248 offset:8
    v_mov_b32 v251, 0
    s_waitcnt vmcnt(0)
    ds_add_rtn_u32 v250, v248, v249
    s_waitcnt lgkmcnt(0)
    v_readfirstlane_b32 s65, v250
    s_cmp_eq_u32 s65, 7
    s_cbranch_scc0 L_d_36
    s_mov_b64 exec, 0xff
    buffer_atomic_add v249, v252, s[28:31], s64 offen offset:0 sc1
    s_mov_b64 exec, 1
    v_readfirstlane_b32 s87, v253
    s_add_u32 s87, s87, 8
    s_mov_b32 s67, 200000
L_poll_38:
    s_sub_u32 s67, s67, 1
    s_cbranch_scc1 L_w_37
    buffer_load_dword v250, v251, s[28:31], s66 offen offset:0 sc1
    s_waitcnt vmcnt(0)
    v_readfirstlane_b32 s65, v250
    s_cmp_eq_u32 s65, s87
    s_cbranch_scc1 L_w_37
    s_sleep 1
    s_branch L_poll_38
L_w_37:
    ds_write_b32 v248, v249 offset:4
    s_waitcnt lgkmcnt(0)
L_d_36:
    s_mov_b64 exec, -1
    v_and_b32 v212, 15, v0
    v_lshrrev_b32 v208, 4, v0
    v_lshlrev_b32 v212, 11, v212
    v_lshl_add_u32 v212, v208, 4, v212
    s_mov_b32 s12, s56
    s_mov_b32 s13, s57
    s_mov_b32 s14, 0x300000
    s_mov_b32 s15, 0x20000
    s_cmp_ge_u32 s6, 2
    s_cbranch_scc1 L_ta_39
    s_add_u32 s87, s6, 4
    s_mul_i32 s65, s5, 6
    s_add_u32 s65, s65, s87
    s_add_u32 s66, s4, 32
    s_mul_i32 s66, s66, 48
    s_add_u32 s66, s66, s65
    s_lshl_b32 s74, s66, 13
    s_mul_i32 s66, s65, 43
    s_lshr_b32 s66, s66, 7
    s_mul_i32 s67, s66, 3
    s_sub_u32 s67, s65, s67
    s_mul_i32 s72, s4, 3
    s_add_u32 s72, s72, s67
    s_lshl_b32 s72, s72, 15
    s_lshl_b32 s66, s66, 6
    s_add_u32 s72, s72, s66
    s_add_u32 s72, s72, 1024
    v_mov_b32 v248, 163808
    s_mov_b32 s67, 4000000
L_f_40:
    s_sub_u32 s67, s67, 1
    s_cbranch_scc1 L_g_41
    ds_read_b32 v249, v248 offset:4
    s_waitcnt lgkmcnt(0)
    v_readfirstlane_b32 s65, v249
    s_cmp_lg_u32 s65, 0
    s_cbranch_scc1 L_g_41
    s_sleep 2
    s_branch L_f_40
L_g_41:
    s_lshl_b32 s65, s87, 10
    s_add_u32 s65, s65, 136192
    v_add_u32 v208, s65, v1
    ds_read_b128 v[224:227], v208
    s_add_u32 s65, s5, 1
    s_and_b32 s65, s65, 7
    s_lshl_b32 s65, s65, 10
    s_add_u32 s65, s65, s74
    buffer_load_dwordx4 v[8:11], v1, s[28:31], s65 offen sc1
    s_add_u32 s65, s5, 2
    s_and_b32 s65, s65, 7
    s_lshl_b32 s65, s65, 10
    s_add_u32 s65, s65, s74
    buffer_load_dwordx4 v[12:15], v1, s[28:31], s65 offen sc1
    s_add_u32 s65, s5, 3
    s_and_b32 s65, s65, 7
    s_lshl_b32 s65, s65, 10
    s_add_u32 s65, s65, s74
    buffer_load_dwordx4 v[16:19], v1, s[28:31], s65 offen sc1
    s_add_u32 s65, s5, 4
    s_and_b32 s65, s65, 7
    s_lshl_b32 s65, s65, 10
    s_add_u32 s65, s65, s74
    buffer_load_dwordx4 v[20:23], v1, s[28:31], s65 offen sc1
    s_add_u32 s65, s5, 5
    s_and_b32 s65, s65, 7
    s_lshl_b32 s65, s65, 10
    s_add_u32 s65, s65, s74
    buffer_load_dwordx4 v[24:27], v1, s[28:31], s65 offen sc1
    s_add_u32 s65, s5, 6
    s_and_b32 s65, s65, 7
    s_lshl_b32 s65, s65, 10
    s_add_u32 s65, s65, s74
    buffer_load_dwordx4 v[28:31], v1, s[28:31], s65 offen sc1
    s_add_u32 s65, s5, 7
    s_and_b32 s65, s65, 7
    s_lshl_b32 s65, s65, 10
    s_add_u32 s65, s65, s74
    buffer_load_dwordx4 v[32:35], v1, s[28:31], s65 offen sc1
    s_waitcnt lgkmcnt(0)
    v_lshlrev_b32 v200, 16, v224
    v_and_b32 v201, 0xffff0000, v224
    v_lshlrev_b32 v202, 16, v225
    v_and_b32 v203, 0xffff0000, v225
    v_lshlrev_b32 v204, 16, v226
    v_and_b32 v205, 0xffff0000, v226
    v_lshlrev_b32 v206, 16, v227
    v_and_b32 v207, 0xffff0000, v227
    s_waitcnt vmcnt(6)
    v_lshlrev_b32 v208, 16, v8
    v_and_b32 v209, 0xffff0000, v8
    v_pk_add_f32 v[200:201], v[200:201], v[208:209]
    v_lshlrev_b32 v210, 16, v9
    v_and_b32 v211, 0xffff0000, v9
    v_pk_add_f32 v[202:203], v[202:203], v[210:211]
    v_lshlrev_b32 v208, 16, v10
    v_and_b32 v209, 0xffff0000, v10
    v_pk_add_f32 v[204:205], v[204:205], v[208:209]
    v_lshlrev_b32 v210, 16, v11
    v_and_b32 v211, 0xffff0000, v11
    v_pk_add_f32 v[206:207], v[206:207], v[210:211]
    s_waitcnt vmcnt(5)
    v_lshlrev_b32 v208, 16, v12
    v_and_b32 v209, 0xffff0000, v12
    v_pk_add_f32 v[200:201], v[200:201], v[208:209]
    v_lshlrev_b32 v210, 16, v13
    v_and_b32 v211, 0xffff0000, v13
    v_pk_add_f32 v[202:203], v[202:203], v[210:211]
    v_lshlrev_b32 v208, 16, v14
    v_and_b32 v209, 0xffff0000, v14
    v_pk_add_f32 v[204:205], v[204:205], v[208:209]
    v_lshlrev_b32 v210, 16, v15
    v_and_b32 v211, 0xffff0000, v15
    v_pk_add_f32 v[206:207], v[206:207], v[210:211]
    s_waitcnt vmcnt(4)
    v_lshlrev_b32 v208, 16, v16
    v_and_b32 v209, 0xffff0000, v16
    v_pk_add_f32 v[200:201], v[200:201], v[208:209]
    v_lshlrev_b32 v210, 16, v17
    v_and_b32 v211, 0xffff0000, v17
    v_pk_add_f32 v[202:203], v[202:203], v[210:211]
    v_lshlrev_b32 v208, 16, v18
    v_and_b32 v209, 0xffff0000, v18
    v_pk_add_f32 v[204:205], v[204:205], v[208:209]
    v_lshlrev_b32 v210, 16, v19
    v_and_b32 v211, 0xffff0000, v19
    v_pk_add_f32 v[206:207], v[206:207], v[210:211]
    s_waitcnt vmcnt(3)
    v_lshlrev_b32 v208, 16, v20
    v_and_b32 v209, 0xffff0000, v20
    v_pk_add_f32 v[200:201], v[200:201], v[208:209]
    v_lshlrev_b32 v210, 16, v21
    v_and_b32 v211, 0xffff0000, v21
    v_pk_add_f32 v[202:203], v[202:203], v[210:211]
    v_lshlrev_b32 v208, 16, v22
    v_and_b32 v209, 0xffff0000, v22
    v_pk_add_f32 v[204:205], v[204:205], v[208:209]
    v_lshlrev_b32 v210, 16, v23
    v_and_b32 v211, 0xffff0000, v23
    v_pk_add_f32 v[206:207], v[206:207], v[210:211]
    s_waitcnt vmcnt(2)
    v_lshlrev_b32 v208, 16, v24
    v_and_b32 v209, 0xffff0000, v24
    v_pk_add_f32 v[200:201], v[200:201], v[208:209]
    v_lshlrev_b32 v210, 16, v25
    v_and_b32 v211, 0xffff0000, v25
    v_pk_add_f32 v[202:203], v[202:203], v[210:211]
    v_lshlrev_b32 v208, 16, v26
    v_and_b32 v209, 0xffff0000, v26
    v_pk_add_f32 v[204:205], v[204:205], v[208:209]
    v_lshlrev_b32 v210, 16, v27
    v_and_b32 v211, 0xffff0000, v27
    v_pk_add_f32 v[206:207], v[206:207], v[210:211]
    s_waitcnt vmcnt(1)
    v_lshlrev_b32 v208, 16, v28
    v_and_b32 v209, 0xffff0000, v28
    v_pk_add_f32 v[200:201], v[200:201], v[208:209]
    v_lshlrev_b32 v210, 16, v29
    v_and_b32 v211, 0xffff0000, v29
    v_pk_add_f32 v[202:203], v[202:203], v[210:211]
    v_lshlrev_b32 v208, 16, v30
    v_and_b32 v209, 0xffff0000, v30
    v_pk_add_f32 v[204:205], v[204:205], v[208:209]
    v_lshlrev_b32 v210, 16, v31
    v_and_b32 v211, 0xffff0000, v31
    v_pk_add_f32 v[206:207], v[206:207], v[210:211]
    s_waitcnt vmcnt(0)
    v_lshlrev_b32 v208, 16, v32
    v_and_b32 v209, 0xffff0000, v32
    v_pk_add_f32 v[200:201], v[200:201], v[208:209]
    v_lshlrev_b32 v210, 16, v33
    v_and_b32 v211, 0xffff0000, v33
    v_pk_add_f32 v[202:203], v[202:203], v[210:211]
    v_lshlrev_b32 v208, 16, v34
    v_and_b32 v209, 0xffff0000, v34
    v_pk_add_f32 v[204:205], v[204:205], v[208:209]
    v_lshlrev_b32 v210, 16, v35
    v_and_b32 v211, 0xffff0000, v35
    v_pk_add_f32 v[206:207], v[206:207], v[210:211]
    v_cvt_pk_bf16_f32 v216, v200, v201
    v_cvt_pk_bf16_f32 v217, v202, v203
    v_cvt_pk_bf16_f32 v218, v204, v205
    v_cvt_pk_bf16_f32 v219, v206, v207
    s_nop 0
    v_permlane32_swap_b32 v216, v218
    v_permlane32_swap_b32 v217, v219
    s_nop 0
    v_permlane16_swap_b32 v216, v218
    v_permlane16_swap_b32 v217, v219
    buffer_store_dwordx4 v[216:219], v212, s[12:15], s72 offen sc1
    s_branch L_fin
L_ta_39:
    s_add_u32 s87, s6, 2
    s_mul_i32 s65, s5, 6
    s_add_u32 s65, s65, s87
    s_add_u32 s66, s4, 0
    s_mul_i32 s66, s66, 48
    s_add_u32 s66, s66, s65
    s_lshl_b32 s74, s66, 13
    s_mul_i32 s66, s65, 43
    s_lshr_b32 s66, s66, 7
    s_mul_i32 s67, s66, 3
    s_sub_u32 s67, s65, s67
    s_mul_i32 s72, s4, 3
    s_add_u32 s72, s72, s67
    s_lshl_b32 s72, s72, 15
    s_lshl_b32 s66, s66, 6
    s_add_u32 s72, s72, s66
    v_mov_b32 v248, 163808
    s_mov_b32 s67, 4000000
L_f_42:
    s_sub_u32 s67, s67, 1
    s_cbranch_scc1 L_g_43
    ds_read_b32 v249, v248 offset:4
    s_waitcnt lgkmcnt(0)
    v_readfirstlane_b32 s65, v249
    s_cmp_lg_u32 s65, 0
    s_cbranch_scc1 L_g_43
    s_sleep 2
    s_branch L_f_42
L_g_43:
    s_lshl_b32 s65, s87, 10
    s_add_u32 s65, s65, 130048
    v_add_u32 v208, s65, v1
    ds_read_b128 v[224:227], v208
    s_add_u32 s65, s5, 1
    s_and_b32 s65, s65, 7
    s_lshl_b32 s65, s65, 10
    s_add_u32 s65, s65, s74
    buffer_load_dwordx4 v[8:11], v1, s[28:31], s65 offen sc1
    s_add_u32 s65, s5, 2
    s_and_b32 s65, s65, 7
    s_lshl_b32 s65, s65, 10
    s_add_u32 s65, s65, s74
    buffer_load_dwordx4 v[12:15], v1, s[28:31], s65 offen sc1
    s_add_u32 s65, s5, 3
    s_and_b32 s65, s65, 7
    s_lshl_b32 s65, s65, 10
    s_add_u32 s65, s65, s74
    buffer_load_dwordx4 v[16:19], v1, s[28:31], s65 offen sc1
    s_add_u32 s65, s5, 4
    s_and_b32 s65, s65, 7
    s_lshl_b32 s65, s65, 10
    s_add_u32 s65, s65, s74
    buffer_load_dwordx4 v[20:23], v1, s[28:31], s65 offen sc1
    s_add_u32 s65, s5, 5
    s_and_b32 s65, s65, 7
    s_lshl_b32 s65, s65, 10
    s_add_u32 s65, s65, s74
    buffer_load_dwordx4 v[24:27], v1, s[28:31], s65 offen sc1
    s_add_u32 s65, s5, 6
    s_and_b32 s65, s65, 7
    s_lshl_b32 s65, s65, 10
    s_add_u32 s65, s65, s74
    buffer_load_dwordx4 v[28:31], v1, s[28:31], s65 offen sc1
    s_add_u32 s65, s5, 7
    s_and_b32 s65, s65, 7
    s_lshl_b32 s65, s65, 10
    s_add_u32 s65, s65, s74
    buffer_load_dwordx4 v[32:35], v1, s[28:31], s65 offen sc1
    s_waitcnt lgkmcnt(0)
    v_lshlrev_b32 v200, 16, v224
    v_and_b32 v201, 0xffff0000, v224
    v_lshlrev_b32 v202, 16, v225
    v_and_b32 v203, 0xffff0000, v225
    v_lshlrev_b32 v204, 16, v226
    v_and_b32 v205, 0xffff0000, v226
    v_lshlrev_b32 v206, 16, v227
    v_and_b32 v207, 0xffff0000, v227
    s_waitcnt vmcnt(6)
    v_lshlrev_b32 v208, 16, v8
    v_and_b32 v209, 0xffff0000, v8
    v_pk_add_f32 v[200:201], v[200:201], v[208:209]
    v_lshlrev_b32 v210, 16, v9
    v_and_b32 v211, 0xffff0000, v9
    v_pk_add_f32 v[202:203], v[202:203], v[210:211]
    v_lshlrev_b32 v208, 16, v10
    v_and_b32 v209, 0xffff0000, v10
    v_pk_add_f32 v[204:205], v[204:205], v[208:209]
    v_lshlrev_b32 v210, 16, v11
    v_and_b32 v211, 0xffff0000, v11
    v_pk_add_f32 v[206:207], v[206:207], v[210:211]
    s_waitcnt vmcnt(5)
    v_lshlrev_b32 v208, 16, v12
    v_and_b32 v209, 0xffff0000, v12
    v_pk_add_f32 v[200:201], v[200:201], v[208:209]
    v_lshlrev_b32 v210, 16, v13
    v_and_b32 v211, 0xffff0000, v13
    v_pk_add_f32 v[202:203], v[202:203], v[210:211]
    v_lshlrev_b32 v208, 16, v14
    v_and_b32 v209, 0xffff0000, v14
    v_pk_add_f32 v[204:205], v[204:205], v[208:209]
    v_lshlrev_b32 v210, 16, v15
    v_and_b32 v211, 0xffff0000, v15
    v_pk_add_f32 v[206:207], v[206:207], v[210:211]
    s_waitcnt vmcnt(4)
    v_lshlrev_b32 v208, 16, v16
    v_and_b32 v209, 0xffff0000, v16
    v_pk_add_f32 v[200:201], v[200:201], v[208:209]
    v_lshlrev_b32 v210, 16, v17
    v_and_b32 v211, 0xffff0000, v17
    v_pk_add_f32 v[202:203], v[202:203], v[210:211]
    v_lshlrev_b32 v208, 16, v18
    v_and_b32 v209, 0xffff0000, v18
    v_pk_add_f32 v[204:205], v[204:205], v[208:209]
    v_lshlrev_b32 v210, 16, v19
    v_and_b32 v211, 0xffff0000, v19
    v_pk_add_f32 v[206:207], v[206:207], v[210:211]
    s_waitcnt vmcnt(3)
    v_lshlrev_b32 v208, 16, v20
    v_and_b32 v209, 0xffff0000, v20
    v_pk_add_f32 v[200:201], v[200:201], v[208:209]
    v_lshlrev_b32 v210, 16, v21
    v_and_b32 v211, 0xffff0000, v21
    v_pk_add_f32 v[202:203], v[202:203], v[210:211]
    v_lshlrev_b32 v208, 16, v22
    v_and_b32 v209, 0xffff0000, v22
    v_pk_add_f32 v[204:205], v[204:205], v[208:209]
    v_lshlrev_b32 v210, 16, v23
    v_and_b32 v211, 0xffff0000, v23
    v_pk_add_f32 v[206:207], v[206:207], v[210:211]
    s_waitcnt vmcnt(2)
    v_lshlrev_b32 v208, 16, v24
    v_and_b32 v209, 0xffff0000, v24
    v_pk_add_f32 v[200:201], v[200:201], v[208:209]
    v_lshlrev_b32 v210, 16, v25
    v_and_b32 v211, 0xffff0000, v25
    v_pk_add_f32 v[202:203], v[202:203], v[210:211]
    v_lshlrev_b32 v208, 16, v26
    v_and_b32 v209, 0xffff0000, v26
    v_pk_add_f32 v[204:205], v[204:205], v[208:209]
    v_lshlrev_b32 v210, 16, v27
    v_and_b32 v211, 0xffff0000, v27
    v_pk_add_f32 v[206:207], v[206:207], v[210:211]
    s_waitcnt vmcnt(1)
    v_lshlrev_b32 v208, 16, v28
    v_and_b32 v209, 0xffff0000, v28
    v_pk_add_f32 v[200:201], v[200:201], v[208:209]
    v_lshlrev_b32 v210, 16, v29
    v_and_b32 v211, 0xffff0000, v29
    v_pk_add_f32 v[202:203], v[202:203], v[210:211]
    v_lshlrev_b32 v208, 16, v30
    v_and_b32 v209, 0xffff0000, v30
    v_pk_add_f32 v[204:205], v[204:205], v[208:209]
    v_lshlrev_b32 v210, 16, v31
    v_and_b32 v211, 0xffff0000, v31
    v_pk_add_f32 v[206:207], v[206:207], v[210:211]
    s_waitcnt vmcnt(0)
    v_lshlrev_b32 v208, 16, v32
    v_and_b32 v209, 0xffff0000, v32
    v_pk_add_f32 v[200:201], v[200:201], v[208:209]
    v_lshlrev_b32 v210, 16, v33
    v_and_b32 v211, 0xffff0000, v33
    v_pk_add_f32 v[202:203], v[202:203], v[210:211]
    v_lshlrev_b32 v208, 16, v34
    v_and_b32 v209, 0xffff0000, v34
    v_pk_add_f32 v[204:205], v[204:205], v[208:209]
    v_lshlrev_b32 v210, 16, v35
    v_and_b32 v211, 0xffff0000, v35
    v_pk_add_f32 v[206:207], v[206:207], v[210:211]
    v_cvt_pk_bf16_f32 v216, v200, v201
    v_cvt_pk_bf16_f32 v217, v202, v203
    v_cvt_pk_bf16_f32 v218, v204, v205
    v_cvt_pk_bf16_f32 v219, v206, v207
    buffer_store_dwordx4 v[216:219], v212, s[12:15], s72 offen sc1
L_fin:
    s_endpgm
L_tile:
    s_setprio 1
    ds_read_b128 v[152:155], v3 offset:16896
    ds_read_b128 v[156:159], v3 offset:16960
    ds_read_b128 v[160:163], v3 offset:17024
    ds_read_b128 v[164:167], v3 offset:17088
    s_branch L_att2
L_att:
    ds_read_b128 v[152:155], v3 offset:0
    ds_read_b128 v[156:159], v3 offset:64
    ds_read_b128 v[160:163], v3 offset:128
    ds_read_b128 v[164:167], v3 offset:192
L_att1:
    s_setprio 1
    s_waitcnt lgkmcnt(3)
    v_mfma_f32_16x16x32_bf16 v[184:187], v[152:155], v[104:107], v[220:223]
    ds_read_b128 v[168:171], v3 offset:512
    s_waitcnt lgkmcnt(3)
    v_mfma_f32_16x16x32_bf16 v[184:187], v[156:159], v[116:119], v[184:187]
    ds_read_b128 v[172:175], v3 offset:576
    s_waitcnt lgkmcnt(3)
    v_mfma_f32_16x16x32_bf16 v[184:187], v[160:163], v[128:131], v[184:187]
    ds_read_b128 v[176:179], v3 offset:640
    s_waitcnt lgkmcnt(3)
    v_mfma_f32_16x16x32_bf16 v[184:187], v[164:167], v[140:143], v[184:187]
    ds_read_b128 v[180:183], v3 offset:704
    v_mfma_f32_16x16x32_bf16 v[188:191], v[152:155], v[108:111], v[224:227]
    v_mfma_f32_16x16x32_bf16 v[188:191], v[156:159], v[120:123], v[188:191]
    v_mfma_f32_16x16x32_bf16 v[188:191], v[160:163], v[132:135], v[188:191]
    v_mfma_f32_16x16x32_bf16 v[188:191], v[164:167], v[144:147], v[188:191]
    v_mfma_f32_16x16x32_bf16 v[192:195], v[152:155], v[112:115], v[228:231]
    s_nop 1
    v_exp_f32 v248, v184
    v_exp_f32 v249, v185
    v_mfma_f32_16x16x32_bf16 v[192:195], v[156:159], v[124:127], v[192:195]
    v_exp_f32 v250, v186
    v_mfma_f32_16x16x32_bf16 v[192:195], v[160:163], v[136:139], v[192:195]
    v_exp_f32 v251, v187
    v_cvt_pk_bf16_f32 v208, v248, v249
    v_mfma_f32_16x16x32_bf16 v[192:195], v[164:167], v[148:151], v[192:195]
    v_cvt_pk_bf16_f32 v209, v250, v251
    s_waitcnt lgkmcnt(0)
    v_mfma_f32_16x16x32_bf16 v[196:199], v[168:171], v[104:107], v[220:223]
    v_exp_f32 v252, v188
    v_exp_f32 v253, v189
    ds_read_b64_tr_b16 v[152:153], v2 offset:8448
    v_mfma_f32_16x16x32_bf16 v[196:199], v[172:175], v[116:119], v[196:199]
    v_exp_f32 v254, v190
    ds_read_b64_tr_b16 v[154:155], v2 offset:8704
    v_mfma_f32_16x16x32_bf16 v[196:199], v[176:179], v[128:131], v[196:199]
    v_exp_f32 v255, v191
    v_cvt_pk_bf16_f32 v212, v252, v253
    ds_read_b64_tr_b16 v[156:157], v2 offset:8480
    v_mfma_f32_16x16x32_bf16 v[196:199], v[180:183], v[140:143], v[196:199]
    v_cvt_pk_bf16_f32 v213, v254, v255
    ds_read_b64_tr_b16 v[158:159], v2 offset:8736
    v_mfma_f32_16x16x32_bf16 v[200:203], v[168:171], v[108:111], v[224:227]
    v_exp_f32 v248, v192
    v_exp_f32 v249, v193
    ds_read_b64_tr_b16 v[160:161], v2 offset:8512
    v_mfma_f32_16x16x32_bf16 v[200:203], v[172:175], v[120:123], v[200:203]
    v_exp_f32 v250, v194
    ds_read_b64_tr_b16 v[162:163], v2 offset:8768
    v_mfma_f32_16x16x32_bf16 v[200:203], v[176:179], v[132:135], v[200:203]
    v_exp_f32 v251, v195
    v_cvt_pk_bf16_f32 v216, v248, v249
    ds_read_b64_tr_b16 v[164:165], v2 offset:8544
    v_mfma_f32_16x16x32_bf16 v[200:203], v[180:183], v[144:147], v[200:203]
    v_cvt_pk_bf16_f32 v217, v250, v251
    ds_read_b64_tr_b16 v[166:167], v2 offset:8800
    v_mfma_f32_16x16x32_bf16 v[204:207], v[168:171], v[112:115], v[228:231]
    v_exp_f32 v252, v196
    v_exp_f32 v253, v197
    v_exp_f32 v254, v198
    v_mfma_f32_16x16x32_bf16 v[204:207], v[172:175], v[124:127], v[204:207]
    v_exp_f32 v255, v199
    v_cvt_pk_bf16_f32 v210, v252, v253
    v_cvt_pk_bf16_f32 v211, v254, v255
    v_mfma_f32_16x16x32_bf16 v[204:207], v[176:179], v[136:139], v[204:207]
    v_or3_b32 v248, v208, v209, v210
    v_bitop3_b32 v248, v248, v211, s7 bitop3:0xa8
    v_cmp_le_u32 vcc, s1, v248
    v_mfma_f32_16x16x32_bf16 v[204:207], v[180:183], v[148:151], v[204:207]
    s_waitcnt lgkmcnt(0)
    s_cbranch_vccnz L_stub_45
L_ok_44:
    v_mfma_f32_16x16x32_bf16 v[232:235], v[244:247], v[208:211], v[232:235]
    v_exp_f32 v248, v200
    v_exp_f32 v249, v201
    v_exp_f32 v250, v202
    v_mfma_f32_16x16x32_bf16 v[8:11], v[152:155], v[208:211], v[8:11]
    v_exp_f32 v251, v203
    v_cvt_pk_bf16_f32 v214, v248, v249
    v_mfma_f32_16x16x32_bf16 v[20:23], v[156:159], v[208:211], v[20:23]
    v_cvt_pk_bf16_f32 v215, v250, v251
    v_or3_b32 v252, v212, v213, v214
    v_mfma_f32_16x16x32_bf16 v[32:35], v[160:163], v[208:211], v[32:35]
    v_bitop3_b32 v252, v252, v215, s7 bitop3:0xa8
    v_cmp_le_u32 vcc, s1, v252
    v_mfma_f32_16x16x32_bf16 v[44:47], v[164:167], v[208:211], v[44:47]
    s_cbranch_vccnz L_stub_47
L_ok_46:
    v_mfma_f32_16x16x32_bf16 v[236:239], v[244:247], v[212:215], v[236:239]
    v_exp_f32 v252, v204
    v_exp_f32 v253, v205
    v_exp_f32 v254, v206
    v_mfma_f32_16x16x32_bf16 v[12:15], v[152:155], v[212:215], v[12:15]
    v_exp_f32 v255, v207
    v_cvt_pk_bf16_f32 v218, v252, v253
    v_mfma_f32_16x16x32_bf16 v[24:27], v[156:159], v[212:215], v[24:27]
    v_cvt_pk_bf16_f32 v219, v254, v255
    v_or3_b32 v248, v216, v217, v218
    v_mfma_f32_16x16x32_bf16 v[36:39], v[160:163], v[212:215], v[36:39]
    v_bitop3_b32 v248, v248, v219, s7 bitop3:0xa8
    v_cmp_le_u32 vcc, s1, v248
    ds_read_b64_tr_b16 v[168:169], v2 offset:8576
    v_mfma_f32_16x16x32_bf16 v[48:51], v[164:167], v[212:215], v[48:51]
    ds_read_b64_tr_b16 v[170:171], v2 offset:8832
    s_cbranch_vccnz L_stub_49
L_ok_48:
    v_mfma_f32_16x16x32_bf16 v[240:243], v[244:247], v[216:219], v[240:243]
    ds_read_b64_tr_b16 v[172:173], v2 offset:8608
    ds_read_b64_tr_b16 v[174:175], v2 offset:8864
    v_mfma_f32_16x16x32_bf16 v[16:19], v[152:155], v[216:219], v[16:19]
    ds_read_b64_tr_b16 v[176:177], v2 offset:8640
    v_mfma_f32_16x16x32_bf16 v[28:31], v[156:159], v[216:219], v[28:31]
    ds_read_b64_tr_b16 v[178:179], v2 offset:8896
    ds_read_b64_tr_b16 v[180:181], v2 offset:8672
    v_mfma_f32_16x16x32_bf16 v[40:43], v[160:163], v[216:219], v[40:43]
    ds_read_b64_tr_b16 v[182:183], v2 offset:8928
    v_mfma_f32_16x16x32_bf16 v[52:55], v[164:167], v[216:219], v[52:55]
    s_waitcnt lgkmcnt(6)
    v_mfma_f32_16x16x32_bf16 v[56:59], v[168:171], v[208:211], v[56:59]
    ds_read_b128 v[152:155], v3 offset:16896
    v_mfma_f32_16x16x32_bf16 v[60:63], v[168:171], v[212:215], v[60:63]
    ds_read_b128 v[156:159], v3 offset:16960
    v_mfma_f32_16x16x32_bf16 v[64:67], v[168:171], v[216:219], v[64:67]
    s_waitcnt lgkmcnt(6)
    v_mfma_f32_16x16x32_bf16 v[68:71], v[172:175], v[208:211], v[68:71]
    ds_read_b128 v[160:163], v3 offset:17024
    v_mfma_f32_16x16x32_bf16 v[72:75], v[172:175], v[212:215], v[72:75]
    ds_read_b128 v[164:167], v3 offset:17088
    v_mfma_f32_16x16x32_bf16 v[76:79], v[172:175], v[216:219], v[76:79]
    s_waitcnt lgkmcnt(6)
    v_mfma_f32_16x16x32_bf16 v[80:83], v[176:179], v[208:211], v[80:83]
    v_mfma_f32_16x16x32_bf16 v[84:87], v[176:179], v[212:215], v[84:87]
    v_mfma_f32_16x16x32_bf16 v[88:91], v[176:179], v[216:219], v[88:91]
    s_waitcnt lgkmcnt(4)
    v_mfma_f32_16x16x32_bf16 v[92:95], v[180:183], v[208:211], v[92:95]
    v_mfma_f32_16x16x32_bf16 v[96:99], v[180:183], v[212:215], v[96:99]
    v_mfma_f32_16x16x32_bf16 v[100:103], v[180:183], v[216:219], v[100:103]
L_att2:
    s_waitcnt lgkmcnt(3)
    v_mfma_f32_16x16x32_bf16 v[184:187], v[152:155], v[104:107], v[220:223]
    ds_read_b128 v[168:171], v3 offset:17408
    s_waitcnt lgkmcnt(3)
    v_mfma_f32_16x16x32_bf16 v[184:187], v[156:159], v[116:119], v[184:187]
    ds_read_b128 v[172:175], v3 offset:17472
    s_waitcnt lgkmcnt(3)
    v_mfma_f32_16x16x32_bf16 v[184:187], v[160:163], v[128:131], v[184:187]
    ds_read_b128 v[176:179], v3 offset:17536
    s_waitcnt lgkmcnt(3)
    v_mfma_f32_16x16x32_bf16 v[184:187], v[164:167], v[140:143], v[184:187]
    ds_read_b128 v[180:183], v3 offset:17600
    v_mfma_f32_16x16x32_bf16 v[188:191], v[152:155], v[108:111], v[224:227]
    v_mfma_f32_16x16x32_bf16 v[188:191], v[156:159], v[120:123], v[188:191]
    v_mfma_f32_16x16x32_bf16 v[188:191], v[160:163], v[132:135], v[188:191]
    v_mfma_f32_16x16x32_bf16 v[188:191], v[164:167], v[144:147], v[188:191]
    v_mfma_f32_16x16x32_bf16 v[192:195], v[152:155], v[112:115], v[228:231]
    s_nop 1
    v_exp_f32 v248, v184
    v_exp_f32 v249, v185
    v_mfma_f32_16x16x32_bf16 v[192:195], v[156:159], v[124:127], v[192:195]
    v_exp_f32 v250, v186
    v_mfma_f32_16x16x32_bf16 v[192:195], v[160:163], v[136:139], v[192:195]
    v_exp_f32 v251, v187
    v_cvt_pk_bf16_f32 v208, v248, v249
    v_mfma_f32_16x16x32_bf16 v[192:195], v[164:167], v[148:151], v[192:195]
    v_cvt_pk_bf16_f32 v209, v250, v251
    s_waitcnt lgkmcnt(0)
    v_mfma_f32_16x16x32_bf16 v[196:199], v[168:171], v[104:107], v[220:223]
    v_exp_f32 v252, v188
    v_exp_f32 v253, v189
    ds_read_b64_tr_b16 v[152:153], v2 offset:25344
    v_mfma_f32_16x16x32_bf16 v[196:199], v[172:175], v[116:119], v[196:199]
    v_exp_f32 v254, v190
    ds_read_b64_tr_b16 v[154:155], v2 offset:25600
    v_mfma_f32_16x16x32_bf16 v[196:199], v[176:179], v[128:131], v[196:199]
    v_exp_f32 v255, v191
    v_cvt_pk_bf16_f32 v212, v252, v253
    ds_read_b64_tr_b16 v[156:157], v2 offset:25376
    v_mfma_f32_16x16x32_bf16 v[196:199], v[180:183], v[140:143], v[196:199]
    v_cvt_pk_bf16_f32 v213, v254, v255
    ds_read_b64_tr_b16 v[158:159], v2 offset:25632
    v_mfma_f32_16x16x32_bf16 v[200:203], v[168:171], v[108:111], v[224:227]
    v_exp_f32 v248, v192
    v_exp_f32 v249, v193
    ds_read_b64_tr_b16 v[160:161], v2 offset:25408
    v_mfma_f32_16x16x32_bf16 v[200:203], v[172:175], v[120:123], v[200:203]
    v_exp_f32 v250, v194
    ds_read_b64_tr_b16 v[162:163], v2 offset:25664
    v_mfma_f32_16x16x32_bf16 v[200:203], v[176:179], v[132:135], v[200:203]
    v_exp_f32 v251, v195
    v_cvt_pk_bf16_f32 v216, v248, v249
    ds_read_b64_tr_b16 v[164:165], v2 offset:25440
    v_mfma_f32_16x16x32_bf16 v[200:203], v[180:183], v[144:147], v[200:203]
    v_cvt_pk_bf16_f32 v217, v250, v251
    ds_read_b64_tr_b16 v[166:167], v2 offset:25696
    v_mfma_f32_16x16x32_bf16 v[204:207], v[168:171], v[112:115], v[228:231]
    v_exp_f32 v252, v196
    v_exp_f32 v253, v197
    v_exp_f32 v254, v198
    v_mfma_f32_16x16x32_bf16 v[204:207], v[172:175], v[124:127], v[204:207]
    v_exp_f32 v255, v199
    v_cvt_pk_bf16_f32 v210, v252, v253
    v_cvt_pk_bf16_f32 v211, v254, v255
    v_mfma_f32_16x16x32_bf16 v[204:207], v[176:179], v[136:139], v[204:207]
    v_or3_b32 v248, v208, v209, v210
    v_bitop3_b32 v248, v248, v211, s7 bitop3:0xa8
    v_cmp_le_u32 vcc, s1, v248
    v_mfma_f32_16x16x32_bf16 v[204:207], v[180:183], v[148:151], v[204:207]
    s_waitcnt lgkmcnt(0)
    s_cbranch_vccnz L_stub_51
L_ok_50:
    v_mfma_f32_16x16x32_bf16 v[232:235], v[244:247], v[208:211], v[232:235]
    v_exp_f32 v248, v200
    v_exp_f32 v249, v201
    v_exp_f32 v250, v202
    v_mfma_f32_16x16x32_bf16 v[8:11], v[152:155], v[208:211], v[8:11]
    v_exp_f32 v251, v203
    v_cvt_pk_bf16_f32 v214, v248, v249
    v_mfma_f32_16x16x32_bf16 v[20:23], v[156:159], v[208:211], v[20:23]
    v_cvt_pk_bf16_f32 v215, v250, v251
    v_or3_b32 v252, v212, v213, v214
    v_mfma_f32_16x16x32_bf16 v[32:35], v[160:163], v[208:211], v[32:35]
    v_bitop3_b32 v252, v252, v215, s7 bitop3:0xa8
    v_cmp_le_u32 vcc, s1, v252
    v_mfma_f32_16x16x32_bf16 v[44:47], v[164:167], v[208:211], v[44:47]
    s_cbranch_vccnz L_stub_53
L_ok_52:
    v_mfma_f32_16x16x32_bf16 v[236:239], v[244:247], v[212:215], v[236:239]
    v_exp_f32 v252, v204
    v_exp_f32 v253, v205
    v_exp_f32 v254, v206
    v_mfma_f32_16x16x32_bf16 v[12:15], v[152:155], v[212:215], v[12:15]
    v_exp_f32 v255, v207
    v_cvt_pk_bf16_f32 v218, v252, v253
    v_mfma_f32_16x16x32_bf16 v[24:27], v[156:159], v[212:215], v[24:27]
    v_cvt_pk_bf16_f32 v219, v254, v255
    v_or3_b32 v248, v216, v217, v218
    v_mfma_f32_16x16x32_bf16 v[36:39], v[160:163], v[212:215], v[36:39]
    v_bitop3_b32 v248, v248, v219, s7 bitop3:0xa8
    v_cmp_le_u32 vcc, s1, v248
    ds_read_b64_tr_b16 v[168:169], v2 offset:25472
    v_mfma_f32_16x16x32_bf16 v[48:51], v[164:167], v[212:215], v[48:51]
    ds_read_b64_tr_b16 v[170:171], v2 offset:25728
    s_cbranch_vccnz L_stub_55
L_ok_54:
    v_mfma_f32_16x16x32_bf16 v[240:243], v[244:247], v[216:219], v[240:243]
    ds_read_b64_tr_b16 v[172:173], v2 offset:25504
    ds_read_b64_tr_b16 v[174:175], v2 offset:25760
    v_mfma_f32_16x16x32_bf16 v[16:19], v[152:155], v[216:219], v[16:19]
    ds_read_b64_tr_b16 v[176:177], v2 offset:25536
    v_mfma_f32_16x16x32_bf16 v[28:31], v[156:159], v[216:219], v[28:31]
    ds_read_b64_tr_b16 v[178:179], v2 offset:25792
    ds_read_b64_tr_b16 v[180:181], v2 offset:25568
    v_mfma_f32_16x16x32_bf16 v[40:43], v[160:163], v[216:219], v[40:43]
    ds_read_b64_tr_b16 v[182:183], v2 offset:25824
    v_mfma_f32_16x16x32_bf16 v[52:55], v[164:167], v[216:219], v[52:55]
    s_waitcnt lgkmcnt(6)
    v_mfma_f32_16x16x32_bf16 v[56:59], v[168:171], v[208:211], v[56:59]
    v_mfma_f32_16x16x32_bf16 v[60:63], v[168:171], v[212:215], v[60:63]
    v_mfma_f32_16x16x32_bf16 v[64:67], v[168:171], v[216:219], v[64:67]
    s_waitcnt lgkmcnt(4)
    v_mfma_f32_16x16x32_bf16 v[68:71], v[172:175], v[208:211], v[68:71]
    v_mfma_f32_16x16x32_bf16 v[72:75], v[172:175], v[212:215], v[72:75]
    v_mfma_f32_16x16x32_bf16 v[76:79], v[172:175], v[216:219], v[76:79]
    s_waitcnt lgkmcnt(2)
    v_mfma_f32_16x16x32_bf16 v[80:83], v[176:179], v[208:211], v[80:83]
    v_mfma_f32_16x16x32_bf16 v[84:87], v[176:179], v[212:215], v[84:87]
    v_mfma_f32_16x16x32_bf16 v[88:91], v[176:179], v[216:219], v[88:91]
    s_waitcnt lgkmcnt(0)
    v_mfma_f32_16x16x32_bf16 v[92:95], v[180:183], v[208:211], v[92:95]
    v_mfma_f32_16x16x32_bf16 v[96:99], v[180:183], v[212:215], v[96:99]
    v_mfma_f32_16x16x32_bf16 v[100:103], v[180:183], v[216:219], v[100:103]
    s_setprio 0
    s_setpc_b64 s[80:81]
L_jit:
    s_cmp_eq_u32 s65, s6
    s_cbranch_scc0 L_jit_r
    v_add_u32 v0, s87, v1
    s_cmp_eq_u32 s66, 0
    s_cbranch_scc0 L_j_56
    ds_write_b128 v0, v[104:107] offset:0
    ds_write_b128 v0, v[108:111] offset:1024
    ds_write_b128 v0, v[112:115] offset:2048
    s_branch L_jit_w
L_j_56:
    s_cmp_eq_u32 s66, 1
    s_cbranch_scc0 L_j_57
    ds_write_b128 v0, v[116:119] offset:0
    ds_write_b128 v0, v[120:123] offset:1024
    ds_write_b128 v0, v[124:127] offset:2048
    s_branch L_jit_w
L_j_57:
    s_cmp_eq_u32 s66, 2
    s_cbranch_scc0 L_j_58
    ds_write_b128 v0, v[128:131] offset:0
    ds_write_b128 v0, v[132:135] offset:1024
    ds_write_b128 v0, v[136:139] offset:2048
    s_branch L_jit_w
L_j_58:
    ds_write_b128 v0, v[140:143] offset:0
    ds_write_b128 v0, v[144:147] offset:1024
    ds_write_b128 v0, v[148:151] offset:2048
L_jit_w:
    s_waitcnt lgkmcnt(0)
L_jit_r:
    s_setpc_b64 s[80:81]
L_stub_45:
    s_call_b64 s[78:79], L_slow0
    s_branch L_ok_44
L_stub_47:
    s_call_b64 s[78:79], L_slow1
    s_branch L_ok_46
L_stub_49:
    s_call_b64 s[78:79], L_slow2
    s_branch L_ok_48
L_stub_51:
    s_call_b64 s[78:79], L_slow0
    s_branch L_ok_50
L_stub_53:
    s_call_b64 s[78:79], L_slow1
    s_branch L_ok_52
L_stub_55:
    s_call_b64 s[78:79], L_slow2
    s_branch L_ok_54
L_slow0:
    v_max3_f32 v248, v184, v185, v186
    v_max3_f32 v249, v187, v196, v197
    v_max3_f32 v248, v248, v198, v199
    v_max_f32 v248, v248, v249
    v_mov_b32 v249, v248
    s_nop 1
    v_permlane32_swap_b32 v249, v248
    v_max_f32 v248, v248, v249
    v_mov_b32 v249, v248
    s_nop 1
    v_permlane16_swap_b32 v249, v248
    v_max_f32 v248, v248, v249
    v_max_f32 v248, s77, v248
    v_add_f32 v248, 0x40e00000, v248
    v_sub_f32 v184, v184, v248
    v_sub_f32 v196, v196, v248
    v_sub_f32 v220, v220, v248
    v_sub_f32 v185, v185, v248
    v_sub_f32 v197, v197, v248
    v_sub_f32 v221, v221, v248
    v_sub_f32 v186, v186, v248
    v_sub_f32 v198, v198, v248
    v_sub_f32 v222, v222, v248
    v_sub_f32 v187, v187, v248
    v_sub_f32 v199, v199, v248
    v_sub_f32 v223, v223, v248
    s_cmp_eq_u32 s1, 0
    s_cbranch_scc1 L_nors_60
    v_sub_f32 v249, 0, v248
    v_exp_f32 v249, v249
    s_nop 0
    v_mul_f32 v232, v232, v249
    v_mul_f32 v233, v233, v249
    v_mul_f32 v234, v234, v249
    v_mul_f32 v235, v235, v249
    v_mul_f32 v8, v8, v249
    v_mul_f32 v9, v9, v249
    v_mul_f32 v10, v10, v249
    v_mul_f32 v11, v11, v249
    v_mul_f32 v20, v20, v249
    v_mul_f32 v21, v21, v249
    v_mul_f32 v22, v22, v249
    v_mul_f32 v23, v23, v249
    v_mul_f32 v32, v32, v249
    v_mul_f32 v33, v33, v249
    v_mul_f32 v34, v34, v249
    v_mul_f32 v35, v35, v249
    v_mul_f32 v44, v44, v249
    v_mul_f32 v45, v45, v249
    v_mul_f32 v46, v46, v249
    v_mul_f32 v47, v47, v249
    v_mul_f32 v56, v56, v249
    v_mul_f32 v57, v57, v249
    v_mul_f32 v58, v58, v249
    v_mul_f32 v59, v59, v249
    v_mul_f32 v68, v68, v249
    v_mul_f32 v69, v69, v249
    v_mul_f32 v70, v70, v249
    v_mul_f32 v71, v71, v249
    v_mul_f32 v80, v80, v249
    v_mul_f32 v81, v81, v249
    v_mul_f32 v82, v82, v249
    v_mul_f32 v83, v83, v249
    v_mul_f32 v92, v92, v249
    v_mul_f32 v93, v93, v249
    v_mul_f32 v94, v94, v249
    v_mul_f32 v95, v95, v249
L_nors_60:
    v_exp_f32 v248, v184
    v_exp_f32 v249, v185
    v_exp_f32 v250, v186
    v_exp_f32 v251, v187
    v_exp_f32 v252, v196
    v_exp_f32 v253, v197
    v_exp_f32 v254, v198
    v_exp_f32 v255, v199
    v_cvt_pk_bf16_f32 v208, v248, v249
    v_cvt_pk_bf16_f32 v209, v250, v251
    v_cvt_pk_bf16_f32 v210, v252, v253
    v_cvt_pk_bf16_f32 v211, v254, v255
    s_nop 1
    s_setpc_b64 s[78:79]
L_slow1:
    v_max3_f32 v248, v188, v189, v190
    v_max3_f32 v249, v191, v200, v201
    v_max3_f32 v248, v248, v202, v203
    v_max_f32 v248, v248, v249
    v_mov_b32 v249, v248
    s_nop 1
    v_permlane32_swap_b32 v249, v248
    v_max_f32 v248, v248, v249
    v_mov_b32 v249, v248
    s_nop 1
    v_permlane16_swap_b32 v249, v248
    v_max_f32 v248, v248, v249
    v_max_f32 v248, s77, v248
    v_add_f32 v248, 0x40e00000, v248
    v_sub_f32 v188, v188, v248
    v_sub_f32 v200, v200, v248
    v_sub_f32 v224, v224, v248
    v_sub_f32 v189, v189, v248
    v_sub_f32 v201, v201, v248
    v_sub_f32 v225, v225, v248
    v_sub_f32 v190, v190, v248
    v_sub_f32 v202, v202, v248
    v_sub_f32 v226, v226, v248
    v_sub_f32 v191, v191, v248
    v_sub_f32 v203, v203, v248
    v_sub_f32 v227, v227, v248
    s_cmp_eq_u32 s1, 0
    s_cbranch_scc1 L_nors_61
    v_sub_f32 v249, 0, v248
    v_exp_f32 v249, v249
    s_nop 0
    v_mul_f32 v236, v236, v249
    v_mul_f32 v237, v237, v249
    v_mul_f32 v238, v238, v249
    v_mul_f32 v239, v239, v249
    v_mul_f32 v12, v12, v249
    v_mul_f32 v13, v13, v249
    v_mul_f32 v14, v14, v249
    v_mul_f32 v15, v15, v249
    v_mul_f32 v24, v24, v249
    v_mul_f32 v25, v25, v249
    v_mul_f32 v26, v26, v249
    v_mul_f32 v27, v27, v249
    v_mul_f32 v36, v36, v249
    v_mul_f32 v37, v37, v249
    v_mul_f32 v38, v38, v249
    v_mul_f32 v39, v39, v249
    v_mul_f32 v48, v48, v249
    v_mul_f32 v49, v49, v249
    v_mul_f32 v50, v50, v249
    v_mul_f32 v51, v51, v249
    v_mul_f32 v60, v60, v249
    v_mul_f32 v61, v61, v249
    v_mul_f32 v62, v62, v249
    v_mul_f32 v63, v63, v249
    v_mul_f32 v72, v72, v249
    v_mul_f32 v73, v73, v249
    v_mul_f32 v74, v74, v249
    v_mul_f32 v75, v75, v249
    v_mul_f32 v84, v84, v249
    v_mul_f32 v85, v85, v249
    v_mul_f32 v86, v86, v249
    v_mul_f32 v87, v87, v249
    v_mul_f32 v96, v96, v249
    v_mul_f32 v97, v97, v249
    v_mul_f32 v98, v98, v249
    v_mul_f32 v99, v99, v249
L_nors_61:
    v_exp_f32 v248, v188
    v_exp_f32 v249, v189
    v_exp_f32 v250, v190
    v_exp_f32 v251, v191
    v_exp_f32 v252, v200
    v_exp_f32 v253, v201
    v_exp_f32 v254, v202
    v_exp_f32 v255, v203
    v_cvt_pk_bf16_f32 v212, v248, v249
    v_cvt_pk_bf16_f32 v213, v250, v251
    v_cvt_pk_bf16_f32 v214, v252, v253
    v_cvt_pk_bf16_f32 v215, v254, v255
    s_nop 1
    s_setpc_b64 s[78:79]
L_slow2:
    v_max3_f32 v248, v192, v193, v194
    v_max3_f32 v249, v195, v204, v205
    v_max3_f32 v248, v248, v206, v207
    v_max_f32 v248, v248, v249
    v_mov_b32 v249, v248
    s_nop 1
    v_permlane32_swap_b32 v249, v248
    v_max_f32 v248, v248, v249
    v_mov_b32 v249, v248
    s_nop 1
    v_permlane16_swap_b32 v249, v248
    v_max_f32 v248, v248, v249
    v_max_f32 v248, s77, v248
    v_add_f32 v248, 0x40e00000, v248
    v_sub_f32 v192, v192, v248
    v_sub_f32 v204, v204, v248
    v_sub_f32 v228, v228, v248
    v_sub_f32 v193, v193, v248
    v_sub_f32 v205, v205, v248
    v_sub_f32 v229, v229, v248
    v_sub_f32 v194, v194, v248
    v_sub_f32 v206, v206, v248
    v_sub_f32 v230, v230, v248
    v_sub_f32 v195, v195, v248
    v_sub_f32 v207, v207, v248
    v_sub_f32 v231, v231, v248
    s_cmp_eq_u32 s1, 0
    s_cbranch_scc1 L_nors_62
    v_sub_f32 v249, 0, v248
    v_exp_f32 v249, v249
    s_nop 0
    v_mul_f32 v240, v240, v249
    v_mul_f32 v241, v241, v249
    v_mul_f32 v242, v242, v249
    v_mul_f32 v243, v243, v249
    v_mul_f32 v16, v16, v249
    v_mul_f32 v17, v17, v249
    v_mul_f32 v18, v18, v249
    v_mul_f32 v19, v19, v249
    v_mul_f32 v28, v28, v249
    v_mul_f32 v29, v29, v249
    v_mul_f32 v30, v30, v249
    v_mul_f32 v31, v31, v249
    v_mul_f32 v40, v40, v249
    v_mul_f32 v41, v41, v249
    v_mul_f32 v42, v42, v249
    v_mul_f32 v43, v43, v249
    v_mul_f32 v52, v52, v249
    v_mul_f32 v53, v53, v249
    v_mul_f32 v54, v54, v249
    v_mul_f32 v55, v55, v249
    v_mul_f32 v64, v64, v249
    v_mul_f32 v65, v65, v249
    v_mul_f32 v66, v66, v249
    v_mul_f32 v67, v67, v249
    v_mul_f32 v76, v76, v249
    v_mul_f32 v77, v77, v249
    v_mul_f32 v78, v78, v249
    v_mul_f32 v79, v79, v249
    v_mul_f32 v88, v88, v249
    v_mul_f32 v89, v89, v249
    v_mul_f32 v90, v90, v249
    v_mul_f32 v91, v91, v249
    v_mul_f32 v100, v100, v249
    v_mul_f32 v101, v101, v249
    v_mul_f32 v102, v102, v249
    v_mul_f32 v103, v103, v249
L_nors_62:
    v_exp_f32 v248, v192
    v_exp_f32 v249, v193
    v_exp_f32 v250, v194
    v_exp_f32 v251, v195
    v_exp_f32 v252, v204
    v_exp_f32 v253, v205
    v_exp_f32 v254, v206
    v_exp_f32 v255, v207
    v_cvt_pk_bf16_f32 v216, v248, v249
    v_cvt_pk_bf16_f32 v217, v250, v251
    v_cvt_pk_bf16_f32 v218, v252, v253
    v_cvt_pk_bf16_f32 v219, v254, v255
    s_mov_b32 s77, 0xc0e00000
    s_mov_b32 s1, 1
    s_nop 1
    s_setpc_b64 s[78:79]
L_code_end:
    s_endpgm
.section .rodata,"a"
.p2align 6
.amdhsa_kernel concat_heads__gqa_block_cached__mha_block_cached__near_ridge_kernel
  .amdhsa_next_free_vgpr 256
  .amdhsa_next_free_sgpr 102
  .amdhsa_accum_offset 256
  .amdhsa_group_segment_fixed_size 0
  .amdhsa_kernarg_size 104
  .amdhsa_user_sgpr_count 2
  .amdhsa_user_sgpr_kernarg_segment_ptr 1
  .amdhsa_system_sgpr_workgroup_id_x 1
.end_amdhsa_kernel
```
